```python
import torch

def _softmax(x, axis=-1):
    return torch.softmax(x, dim=axis)
def _gelu(x):
    return torch.nn.functional.gelu(x, approximate="tanh")
def _silu(x):
    return torch.nn.functional.silu(x)
def _sigmoid(x):
    return torch.sigmoid(x)
def _layernorm(x, axis=-1, eps=1e-5):
    m = x.mean(dim=axis, keepdim=True)
    v = x.var(dim=axis, keepdim=True, unbiased=False)
    return (x - m) / torch.sqrt(v + eps)
def _scatter_add(tgt, idx, src, axis=0):
    return tgt.clone().index_add_(axis, idx, src)
def _segment_sum(src, seg, n):
    out = torch.zeros((n,) + src.shape[1:], dtype=src.dtype)
    return out.index_add_(0, seg, src)
def _pad(x, pw):
    flat = tuple(v for pair in reversed(pw) for v in pair)
    return torch.nn.functional.pad(x, flat)

kernel_name = 'gated_mix__ssm_conv_h3__compressed_kv_cla__prompt'

def setup_inputs():

    _w = (lambda a: (lambda t: t.to(torch.bfloat16) if t.is_floating_point() else t)(torch.as_tensor(a)))
    def _A_setup():
        B, S, D = 1, 2048, 448
        ks = 4
        return {
            "q": _w((lambda *s: torch.randn(*s, dtype=torch.bfloat16) * 0.05)(B, S, D)),
            "k": _w((lambda *s: torch.randn(*s, dtype=torch.bfloat16) * 0.4)(B, S, D)),
            "v": _w((lambda *s: torch.randn(*s, dtype=torch.bfloat16) * 0.4)(B, S, D)),
            "shift_k": _w((lambda *s: torch.randn(*s, dtype=torch.bfloat16) * 0.4)(D, ks) * 0.5),
            "ssm_k": _w((lambda *s: torch.randn(*s, dtype=torch.bfloat16) * 0.8)(D, S) * (1.0 / S ** 0.5)),
            "ssm_D": _w((lambda *s: torch.randn(*s, dtype=torch.bfloat16) * 0.4)(D)),
        }
    _A_in = _A_setup()

    def _B_setup():
        B, H, Sq, Sk, D, M = 1, 16, 2048, 2048, 256, 448
        Dc = 4 * D
        return {
            "x": _w((lambda *s: torch.randn(*s, dtype=torch.bfloat16) * 0.05)(B, Sq, M)),
            "c_kv": _w((lambda *s: torch.randn(*s, dtype=torch.bfloat16) * 0.4)(B, Sk, Dc)),
            "w_q": _w((lambda *s: torch.randn(*s, dtype=torch.bfloat16) * 6.4)(M, H, D) * (M ** -0.5)),
            "w_uk": _w((lambda *s: torch.randn(*s, dtype=torch.bfloat16) * 6.4)(Dc, H, D) * (Dc ** -0.5)),
            "w_uv": _w((lambda *s: torch.randn(*s, dtype=torch.bfloat16) * 0.4)(Dc, H, D) * (Dc ** -0.5)),
            "w_o": _w((lambda *s: torch.randn(*s, dtype=torch.bfloat16) * 0.4)(H, D, M) * ((H * D) ** -0.5)),
        }
    _B_in = _B_setup()

    return {
        "A_q": _A_in["q"],
        "A_k": _A_in["k"],
        "A_v": _A_in["v"],
        "A_shift_k": _A_in["shift_k"],
        "A_ssm_k": _A_in["ssm_k"],
        "A_ssm_D": _A_in["ssm_D"],
        "B_x": _B_in["x"],
        "B_c_kv": _B_in["c_kv"],
        "B_w_q": _B_in["w_q"],
        "B_w_uk": _B_in["w_uk"],
        "B_w_uv": _B_in["w_uv"],
        "B_w_o": _B_in["w_o"],
        "gate_w": _w((lambda *s: torch.randn(*s, dtype=torch.bfloat16) * 0.05)(448) * 16.0),
    }

def reference(A_q, A_k, A_v, A_shift_k, A_ssm_k, A_ssm_D, B_x, B_c_kv, B_w_q, B_w_uk, B_w_uv, B_w_o, gate_w):
    def _A_ref(q, k, v, shift_k, ssm_k, ssm_D):
        B, S, D = q.shape
        ks = shift_k.shape[-1]
        k_pad = _pad(k, ((0, 0), (ks - 1, 0), (0, 0)))
        k_shift = torch.zeros_like(k)
        for t in range(ks):
            k_shift = k_shift + k_pad[:, t:t + S, :] * shift_k[:, ks - 1 - t][None, None, :]
        kv = k_shift * v
        L = 2 * S
        kv_pad = _pad(kv, ((0, 0), (0, S), (0, 0)))
        kf_pad = _pad(ssm_k, ((0, 0), (0, S)))
        kv_f = (lambda x, axes=(-2,-1): torch.fft.rfft2(x.float(), dim=axes))(kv_pad[:, None, :, :], axes=(1, 2))
        kf_f = (lambda x, axes=(-2,-1): torch.fft.rfft2(x.float(), dim=axes))(kf_pad[:, None, :], axes=(1, 2))
        kf_f = (lambda x, *d: x.permute(*d))(kf_f, 1, 2, 0)
        y_f = kv_f * kf_f[None, :, :, :]
        y = (lambda x, s, axes=(-2,-1): torch.fft.irfft2(x, s=s, dim=axes).to(torch.bfloat16))(y_f, (1, L), axes=(1, 2))[:, 0, :S, :]
        y = y + kv * ssm_D[None, None, :]
        return q * y

    def _B_ref(x, c_kv, w_q, w_uk, w_uv, w_o):
        B, Sq, M = x.shape[0], x.shape[1], x.shape[2]
        Sk = c_kv.shape[1]
        H, D = w_q.shape[1], w_q.shape[2]
        q = torch.einsum("bqm,mhd->bhqd", x, w_q)
        k = torch.einsum("bkc,chd->bhkd", c_kv, w_uk)
        v = torch.einsum("bkc,chd->bhkd", c_kv, w_uv)
        scores = torch.einsum("bhqd,bhkd->bhqk", q, k) * (D ** -0.5)
        off = Sk - Sq
        qi = torch.arange(Sq)[:, None]
        kj = torch.arange(Sk)[None, :]
        cmask = kj <= (qi + off)
        scores = torch.where(cmask[None, None], scores, -1e9)
        p = _softmax(scores, axis=-1)
        ctx = torch.einsum("bhqk,bhkd->bhqd", p, v)
        return torch.einsum("bhqd,hdm->bqm", ctx, w_o)

    x = A_q
    g = _sigmoid((x * gate_w).sum(-1, keepdims=True))
    a = _A_ref(x, A_k, A_v, A_shift_k, A_ssm_k, A_ssm_D)
    b = _B_ref(x, B_c_kv, B_w_q, B_w_uk, B_w_uv, B_w_o)
    return g * a + (1 - g) * b
```

```asm
; @launch kernel=proj_kernel grid=(256,1,1) block=(256,1,1) lds=163840
; @launch kernel=attn_kernel grid=(704,1,1) block=(256,1,1) lds=163840
.amdgcn_target "amdgcn-amd-amdhsa--gfx950"
.text
.globl proj_kernel
.p2align 8
.type proj_kernel,@function
proj_kernel:
    s_cmp_ge_u32 s2, 256
    s_cbranch_scc1 L_proj_end
    s_load_dwordx2 s[32:33], s[0:1], 0
    s_load_dwordx2 s[34:35], s[0:1], 56
    s_load_dwordx2 s[36:37], s[0:1], 64
    s_load_dwordx2 s[38:39], s[0:1], 72
    s_load_dwordx2 s[40:41], s[0:1], 80
    s_load_dwordx2 s[42:43], s[0:1], 120
    s_getpc_b64 s[60:61]
L_cpf_proj:
    s_bfe_u32 s62, s2, 0x50003
    s_lshl_b32 s62, s62, 12
    v_lshlrev_b32 v2, 4, v0
    v_add_u32 v2, s62, v2
    v_min_u32 v2, L_end_proj-L_cpf_proj-16, v2
    global_load_dwordx4 v[56:59], v2, s[60:61]
    v_lshrrev_b32 v1, 6, v0
    v_and_b32 v0, 63, v0
    s_nop 0
    v_readfirstlane_b32 s16, v1
    s_and_b32 s25, s2, 7
    s_lshr_b32 s26, s2, 3
    s_and_b32 s22, s26, 7
    s_lshr_b32 s26, s26, 3
    s_lshl_b32 s25, s25, 2
    s_add_u32 s27, s25, s26
    s_lshl_b32 s22, s22, 8
    s_waitcnt lgkmcnt(0)
    s_mov_b32 s4, s34
    s_and_b32 s5, s35, 0xffff
    s_mov_b32 s6, 0x400000
    s_mov_b32 s7, 0x00020000
    s_cmp_ge_u32 s27, 16
    s_cselect_b32 s44, s40, s38
    s_cselect_b32 s45, s41, s39
    s_cselect_b32 s21, 1, 0
    s_mov_b32 s8, s44
    s_and_b32 s9, s45, 0xffff
    s_mov_b32 s10, 0x800000
    s_mov_b32 s11, 0x00020000
    s_and_b32 s23, s27, 15
    s_lshl_b32 s23, s23, 8
    s_lshl_b32 s25, s21, 24
    s_add_u32 s25, s25, 0x1000000
    s_add_u32 s46, s42, s25
    s_addc_u32 s47, s43, 0
    s_mov_b32 s12, s46
    s_and_b32 s13, s47, 0xffff
    s_mov_b32 s14, 0x1000000
    s_mov_b32 s15, 0x00020000
    s_mov_b32 s48, s32
    s_and_b32 s49, s33, 0xffff
    s_mov_b32 s50, 0x1c0000
    s_mov_b32 s51, 0x00020000
    s_mov_b32 s52, s36
    s_and_b32 s53, s37, 0xffff
    s_mov_b32 s54, 0x380000
    s_mov_b32 s55, 0x00020000
    s_mov_b32 s56, s42
    s_and_b32 s57, s43, 0xffff
    s_mov_b32 s58, 0x1000000
    s_mov_b32 s59, 0x00020000
    s_lshl_b32 s24, s27, 7
    s_lshl_b32 s28, s16, 12
    s_lshl_b32 s17, s16, 13
    s_mov_b32 s18, 0
    s_mov_b32 s19, 0
    s_mov_b32 s29, 0
    s_mov_b32 s30, 0
    v_mov_b32 v64, v0
    v_lshrrev_b32 v65, 5, v0
    v_and_b32 v66, 31, v0
    v_lshrrev_b32 v106, 3, v64
    s_lshl_b32 s25, s16, 6
    s_add_u32 s25, s25, s22
    v_add_u32 v106, s25, v106
    v_mul_u32_u24 v106, 2048, v106
    v_and_b32 v107, 7, v64
    v_lshrrev_b32 v108, 4, v64
    v_xor_b32 v109, v107, v108
    v_xor_b32 v110, 4, v109
    v_lshlrev_b32 v109, 4, v109
    v_lshlrev_b32 v110, 4, v110
    v_add_u32 v68, v106, v109
    v_add_u32 v106, 16384, v106
    v_add_u32 v69, v106, v110
    v_add_u32 v106, 16384, v106
    v_add_u32 v70, v106, v109
    v_add_u32 v106, 16384, v106
    v_add_u32 v71, v106, v110
    v_add_u32 v106, 16384, v106
    v_add_u32 v72, v106, v109
    v_add_u32 v106, 16384, v106
    v_add_u32 v73, v106, v110
    v_add_u32 v106, 16384, v106
    v_add_u32 v74, v106, v109
    v_add_u32 v106, 16384, v106
    v_add_u32 v75, v106, v110
    s_lshl_b32 s25, s16, 4
    v_add_u32 v106, s25, v65
    v_lshlrev_b32 v106, 13, v106
    s_lshl_b32 s25, s23, 1
    v_add_u32 v106, s25, v106
    v_lshlrev_b32 v107, 2, v65
    v_xor_b32 v109, v66, v107
    v_xor_b32 v110, 8, v109
    v_lshlrev_b32 v109, 4, v109
    v_lshlrev_b32 v110, 4, v110
    v_add_u32 v76, v106, v109
    v_add_u32 v106, 0x4000, v106
    v_add_u32 v77, v106, v110
    v_add_u32 v106, 0x4000, v106
    v_add_u32 v78, v106, v109
    v_add_u32 v106, 0x4000, v106
    v_add_u32 v79, v106, v110
    v_add_u32 v106, 0x4000, v106
    v_add_u32 v80, v106, v109
    v_add_u32 v106, 0x4000, v106
    v_add_u32 v81, v106, v110
    v_add_u32 v106, 0x4000, v106
    v_add_u32 v82, v106, v109
    v_add_u32 v106, 0x4000, v106
    v_add_u32 v83, v106, v110
    s_lshl_b32 s45, s16, 13
    s_add_u32 m0, s17, 0
    s_nop 0
    buffer_load_dwordx4 v68, s[4:7], s18 offen lds
    s_add_u32 m0, s17, 1024
    s_nop 0
    buffer_load_dwordx4 v69, s[4:7], s18 offen lds
    s_add_u32 m0, s17, 2048
    s_nop 0
    buffer_load_dwordx4 v70, s[4:7], s18 offen lds
    s_add_u32 m0, s17, 3072
    s_nop 0
    buffer_load_dwordx4 v71, s[4:7], s18 offen lds
    s_add_u32 m0, s17, 4096
    s_nop 0
    buffer_load_dwordx4 v72, s[4:7], s18 offen lds
    s_add_u32 m0, s17, 5120
    s_nop 0
    buffer_load_dwordx4 v73, s[4:7], s18 offen lds
    s_add_u32 m0, s17, 6144
    s_nop 0
    buffer_load_dwordx4 v74, s[4:7], s18 offen lds
    s_add_u32 m0, s17, 7168
    s_nop 0
    buffer_load_dwordx4 v75, s[4:7], s18 offen lds
    s_add_u32 s18, s18, 128
    s_add_u32 m0, s17, 32768
    s_nop 0
    buffer_load_dwordx4 v76, s[8:11], s19 offen lds
    s_add_u32 m0, s17, 33792
    s_nop 0
    buffer_load_dwordx4 v77, s[8:11], s19 offen lds
    s_add_u32 m0, s17, 34816
    s_nop 0
    buffer_load_dwordx4 v78, s[8:11], s19 offen lds
    s_add_u32 m0, s17, 35840
    s_nop 0
    buffer_load_dwordx4 v79, s[8:11], s19 offen lds
    s_add_u32 m0, s17, 36864
    s_nop 0
    buffer_load_dwordx4 v80, s[8:11], s19 offen lds
    s_add_u32 m0, s17, 37888
    s_nop 0
    buffer_load_dwordx4 v81, s[8:11], s19 offen lds
    s_add_u32 m0, s17, 38912
    s_nop 0
    buffer_load_dwordx4 v82, s[8:11], s19 offen lds
    s_add_u32 m0, s17, 39936
    s_nop 0
    buffer_load_dwordx4 v83, s[8:11], s19 offen lds
    s_add_u32 s19, s19, 0x80000
    s_xor_b32 s17, s17, 0x10000
    s_add_u32 m0, s17, 0
    s_nop 0
    buffer_load_dwordx4 v68, s[4:7], s18 offen lds
    s_add_u32 m0, s17, 1024
    s_nop 0
    buffer_load_dwordx4 v69, s[4:7], s18 offen lds
    s_add_u32 m0, s17, 2048
    s_nop 0
    buffer_load_dwordx4 v70, s[4:7], s18 offen lds
    s_add_u32 m0, s17, 3072
    s_nop 0
    buffer_load_dwordx4 v71, s[4:7], s18 offen lds
    s_add_u32 m0, s17, 4096
    s_nop 0
    buffer_load_dwordx4 v72, s[4:7], s18 offen lds
    s_add_u32 m0, s17, 5120
    s_nop 0
    buffer_load_dwordx4 v73, s[4:7], s18 offen lds
    s_add_u32 m0, s17, 6144
    s_nop 0
    buffer_load_dwordx4 v74, s[4:7], s18 offen lds
    s_add_u32 m0, s17, 7168
    s_nop 0
    buffer_load_dwordx4 v75, s[4:7], s18 offen lds
    s_add_u32 s18, s18, 128
    v_lshrrev_b32 v106, 3, v64
    s_lshl_b32 s25, s16, 6
    s_add_u32 s25, s25, s22
    v_add_u32 v106, s25, v106
    v_mul_u32_u24 v106, 896, v106
    v_and_b32 v107, 7, v64
    v_lshrrev_b32 v108, 4, v64
    v_xor_b32 v109, v107, v108
    v_xor_b32 v110, 4, v109
    v_lshlrev_b32 v109, 4, v109
    v_lshlrev_b32 v110, 4, v110
    v_add_u32 v92, v106, v109
    v_add_u32 v106, 7168, v106
    v_add_u32 v93, v106, v110
    v_add_u32 v106, 7168, v106
    v_add_u32 v94, v106, v109
    v_add_u32 v106, 7168, v106
    v_add_u32 v95, v106, v110
    v_add_u32 v106, 7168, v106
    v_add_u32 v96, v106, v109
    v_add_u32 v106, 7168, v106
    v_add_u32 v97, v106, v110
    v_add_u32 v106, 7168, v106
    v_add_u32 v98, v106, v109
    v_add_u32 v106, 7168, v106
    v_add_u32 v99, v106, v110
    v_lshrrev_b32 v107, 4, v64
    s_lshl_b32 s25, s16, 4
    v_add_u32 v106, s25, v107
    v_lshlrev_b32 v106, 13, v106
    s_lshl_b32 s25, s24, 1
    v_add_u32 v106, s25, v106
    v_lshlrev_b32 v107, 2, v107
    v_and_b32 v108, 15, v64
    v_xor_b32 v107, v107, v108
    v_lshl_add_u32 v106, v107, 4, v106
    v_add_u32 v100, 0, v106
    v_add_u32 v101, 32768, v106
    v_add_u32 v102, 65536, v106
    v_add_u32 v103, 98304, v106
    s_and_b32 s25, s16, 1
    s_lshr_b32 s26, s16, 1
    s_lshl_b32 s25, s25, 14
    v_lshlrev_b32 v106, 7, v66
    v_add_u32 v106, s25, v106
    v_bfe_u32 v107, v64, 1, 3
    v_xor_b32 v107, v107, v65
    v_xor_b32 v108, 0, v107
    v_lshl_add_u32 v84, v108, 4, v106
    v_xor_b32 v108, 2, v107
    v_lshl_add_u32 v85, v108, 4, v106
    v_xor_b32 v108, 4, v107
    v_lshl_add_u32 v86, v108, 4, v106
    v_xor_b32 v108, 6, v107
    v_lshl_add_u32 v87, v108, 4, v106
    v_bfe_u32 v106, v64, 2, 2
    v_lshl_add_u32 v107, v65, 3, v106
    v_bfe_u32 v108, v64, 4, 1
    v_lshlrev_b32 v109, 5, v108
    v_bfe_u32 v108, v64, 1, 1
    v_lshl_add_u32 v109, v108, 4, v109
    v_and_b32 v108, 1, v64
    v_lshl_add_u32 v109, v108, 3, v109
    v_add_u32 v109, 0x8000, v109
    v_lshl_add_u32 v110, v107, 9, v109
    s_lshl_b32 s25, s26, 8
    v_add_u32 v110, s25, v110
    v_xor_b32 v108, 0, v106
    v_lshl_add_u32 v88, v108, 6, v110
    v_xor_b32 v108, 1, v106
    v_lshl_add_u32 v89, v108, 6, v110
    v_xor_b32 v108, 2, v106
    v_lshl_add_u32 v90, v108, 6, v110
    v_xor_b32 v108, 3, v106
    v_lshl_add_u32 v91, v108, 6, v110
    v_lshl_add_u32 v110, v107, 8, v109
    s_lshl_b32 s26, s26, 1
    v_mov_b32 v111, s26
    v_add_u32 v111, 0, v111
    v_xor_b32 v108, v111, v106
    v_lshl_add_u32 v104, v108, 6, v110
    v_mov_b32 v111, s26
    v_add_u32 v111, 1, v111
    v_xor_b32 v108, v111, v106
    v_lshl_add_u32 v105, v108, 6, v110
    s_load_dwordx2 s[76:77], s[0:1], 88
    s_load_dwordx2 s[78:79], s[0:1], 32
    s_waitcnt lgkmcnt(0)
    s_mov_b32 s60, s76
    s_and_b32 s61, s77, 0xffff
    s_mov_b32 s62, 0x380000
    s_mov_b32 s63, 0x00020000
    s_mov_b32 s64, s78
    s_and_b32 s65, s79, 0xffff
    s_mov_b32 s66, 0x1c0000
    s_mov_b32 s67, 0x00020000
    v_lshlrev_b32 v106, 7, v64
    s_lshl_b32 s25, s16, 13
    v_add_u32 v106, s25, v106
    s_mul_i32 s25, s2, 14336
    v_cmp_gt_u32 vcc, 14336, v106
    s_and_saveexec_b64 s[84:85], vcc
    s_cbranch_execz L_pf0
    buffer_load_dword v0, v106, s[52:55], s25 offen
    buffer_load_dword v1, v106, s[60:63], s25 offen
L_pf0:
    s_mov_b64 exec, s[84:85]
    s_mul_i32 s25, s2, 7168
    v_cmp_gt_u32 vcc, 7168, v106
    s_and_saveexec_b64 s[84:85], vcc
    s_cbranch_execz L_pf1
    buffer_load_dword v2, v106, s[64:67], s25 offen
L_pf1:
    s_mov_b64 exec, s[84:85]
    s_load_dwordx2 s[76:77], s[0:1], 8
    s_load_dwordx2 s[78:79], s[0:1], 16
    s_load_dwordx2 s[80:81], s[0:1], 24
    s_load_dwordx2 s[82:83], s[0:1], 96
    s_waitcnt lgkmcnt(0)
    s_mov_b32 s60, s76
    s_and_b32 s61, s77, 0xffff
    s_mov_b32 s62, 0x1c0000
    s_mov_b32 s63, 0x00020000
    s_mov_b32 s64, s78
    s_and_b32 s65, s79, 0xffff
    s_mov_b32 s66, 0x1c0000
    s_mov_b32 s67, 0x00020000
    s_mov_b32 s68, s80
    s_and_b32 s69, s81, 0xffff
    s_mov_b32 s70, 0xe00
    s_mov_b32 s71, 0x00020000
    s_mov_b32 s88, s82
    s_and_b32 s89, s83, 0xffff
    s_mov_b32 s90, 0x380
    s_mov_b32 s91, 0x00020000
    s_add_u32 s82, s42, 0xae00000
    s_addc_u32 s83, s43, 0
    s_mov_b32 s72, s82
    s_and_b32 s73, s83, 0xffff
    s_mov_b32 s74, 0x1c0000
    s_mov_b32 s75, 0x00020000
    s_add_u32 s82, s42, 0xac00000
    s_addc_u32 s83, s43, 0
    s_mov_b32 s92, s82
    s_and_b32 s93, s83, 0xffff
    s_mov_b32 s94, 0x4000
    s_mov_b32 s95, 0x00020000
    v_mbcnt_lo_u32_b32 v106, -1, 0
    v_mbcnt_hi_u32_b32 v106, -1, v106
    v_cmp_gt_u32 vcc, 56, v106
    s_and_saveexec_b64 s[84:85], vcc
    s_lshl_b32 s25, s2, 3
    s_lshl_b32 s26, s16, 1
    s_add_u32 s86, s25, s26
    v_lshlrev_b32 v107, 4, v106
    s_sub_u32 s25, s86, 3
    s_mul_i32 s25, s25, 896
    v_add_u32 v108, s25, v107
    buffer_load_dwordx4 v[110:113], v108, s[60:63], 0 offen
    s_sub_u32 s25, s86, 2
    s_mul_i32 s25, s25, 896
    v_add_u32 v108, s25, v107
    buffer_load_dwordx4 v[114:117], v108, s[60:63], 0 offen
    s_sub_u32 s25, s86, 1
    s_mul_i32 s25, s25, 896
    v_add_u32 v108, s25, v107
    buffer_load_dwordx4 v[118:121], v108, s[60:63], 0 offen
    s_mul_i32 s25, s86, 896
    buffer_load_dwordx4 v[122:125], v107, s[60:63], s25 offen
    buffer_load_dwordx4 v[126:129], v107, s[60:63], s25 offen offset:896
    buffer_load_dwordx4 v[130:133], v107, s[64:67], s25 offen
    buffer_load_dwordx4 v[134:137], v107, s[64:67], s25 offen offset:896
    v_lshlrev_b32 v108, 6, v106
    buffer_load_dwordx4 v[138:141], v108, s[68:71], 0 offen offset:0
    buffer_load_dwordx4 v[142:145], v108, s[68:71], 0 offen offset:16
    buffer_load_dwordx4 v[146:149], v108, s[68:71], 0 offen offset:32
    buffer_load_dwordx4 v[150:153], v108, s[68:71], 0 offen offset:48
    buffer_load_dwordx4 v[4:7], v107, s[48:51], s25 offen
    buffer_load_dwordx4 v[8:11], v107, s[48:51], s25 offen offset:896
    buffer_load_dwordx4 v[12:15], v107, s[88:91], 0 offen
    s_waitcnt vmcnt(0)
    v_lshlrev_b32 v24, 16, v4
    v_lshlrev_b32 v25, 16, v5
    v_lshlrev_b32 v26, 16, v6
    v_lshlrev_b32 v27, 16, v7
    v_lshlrev_b32 v28, 16, v8
    v_lshlrev_b32 v29, 16, v9
    v_lshlrev_b32 v30, 16, v10
    v_lshlrev_b32 v31, 16, v11
    v_and_b32 v32, 0xffff0000, v4
    v_and_b32 v33, 0xffff0000, v5
    v_and_b32 v34, 0xffff0000, v6
    v_and_b32 v35, 0xffff0000, v7
    v_and_b32 v36, 0xffff0000, v8
    v_and_b32 v37, 0xffff0000, v9
    v_and_b32 v38, 0xffff0000, v10
    v_and_b32 v39, 0xffff0000, v11
    v_lshlrev_b32 v40, 16, v12
    v_lshlrev_b32 v41, 16, v13
    v_lshlrev_b32 v42, 16, v14
    v_lshlrev_b32 v43, 16, v15
    v_and_b32 v48, 0xffff0000, v12
    v_and_b32 v49, 0xffff0000, v13
    v_and_b32 v50, 0xffff0000, v14
    v_and_b32 v51, 0xffff0000, v15
    v_mul_f32 v24, v24, v40
    v_mul_f32 v25, v25, v41
    v_mul_f32 v26, v26, v42
    v_mul_f32 v27, v27, v43
    v_mul_f32 v28, v28, v40
    v_mul_f32 v29, v29, v41
    v_mul_f32 v30, v30, v42
    v_mul_f32 v31, v31, v43
    v_mul_f32 v32, v32, v48
    v_mul_f32 v33, v33, v49
    v_mul_f32 v34, v34, v50
    v_mul_f32 v35, v35, v51
    v_mul_f32 v36, v36, v48
    v_mul_f32 v37, v37, v49
    v_mul_f32 v38, v38, v50
    v_mul_f32 v39, v39, v51
    v_cvt_pk_bf16_f32 v56, v24, v32
    v_cvt_pk_bf16_f32 v57, v25, v33
    v_cvt_pk_bf16_f32 v58, v26, v34
    v_cvt_pk_bf16_f32 v59, v27, v35
    v_cvt_pk_bf16_f32 v60, v28, v36
    v_cvt_pk_bf16_f32 v61, v29, v37
    v_cvt_pk_bf16_f32 v62, v30, v38
    v_cvt_pk_bf16_f32 v63, v31, v39
    v_lshlrev_b32 v24, 16, v56
    v_lshlrev_b32 v25, 16, v57
    v_lshlrev_b32 v26, 16, v58
    v_lshlrev_b32 v27, 16, v59
    v_lshlrev_b32 v28, 16, v60
    v_lshlrev_b32 v29, 16, v61
    v_lshlrev_b32 v30, 16, v62
    v_lshlrev_b32 v31, 16, v63
    v_and_b32 v32, 0xffff0000, v56
    v_and_b32 v33, 0xffff0000, v57
    v_and_b32 v34, 0xffff0000, v58
    v_and_b32 v35, 0xffff0000, v59
    v_and_b32 v36, 0xffff0000, v60
    v_and_b32 v37, 0xffff0000, v61
    v_and_b32 v38, 0xffff0000, v62
    v_and_b32 v39, 0xffff0000, v63
    v_add_f32 v24, v24, v32
    v_add_f32 v25, v25, v33
    v_add_f32 v26, v26, v34
    v_add_f32 v27, v27, v35
    v_add_f32 v28, v28, v36
    v_add_f32 v29, v29, v37
    v_add_f32 v30, v30, v38
    v_add_f32 v31, v31, v39
    v_add_f32 v32, v24, v25
    v_add_f32 v33, v26, v27
    v_add_f32 v34, v28, v29
    v_add_f32 v35, v30, v31
    v_add_f32 v16, v32, v33
    v_add_f32 v17, v34, v35
    v_lshlrev_b32 v154, 16, v110
    v_and_b32 v155, 0xffff0000, v110
    v_lshlrev_b32 v156, 16, v111
    v_and_b32 v157, 0xffff0000, v111
    v_lshlrev_b32 v158, 16, v112
    v_and_b32 v159, 0xffff0000, v112
    v_lshlrev_b32 v160, 16, v113
    v_and_b32 v161, 0xffff0000, v113
    v_lshlrev_b32 v162, 16, v114
    v_and_b32 v163, 0xffff0000, v114
    v_lshlrev_b32 v164, 16, v115
    v_and_b32 v165, 0xffff0000, v115
    v_lshlrev_b32 v166, 16, v116
    v_and_b32 v167, 0xffff0000, v116
    v_lshlrev_b32 v168, 16, v117
    v_and_b32 v169, 0xffff0000, v117
    v_lshlrev_b32 v170, 16, v118
    v_and_b32 v171, 0xffff0000, v118
    v_lshlrev_b32 v172, 16, v119
    v_and_b32 v173, 0xffff0000, v119
    v_lshlrev_b32 v174, 16, v120
    v_and_b32 v175, 0xffff0000, v120
    v_lshlrev_b32 v176, 16, v121
    v_and_b32 v177, 0xffff0000, v121
    v_lshlrev_b32 v178, 16, v122
    v_and_b32 v179, 0xffff0000, v122
    v_lshlrev_b32 v180, 16, v123
    v_and_b32 v181, 0xffff0000, v123
    v_lshlrev_b32 v182, 16, v124
    v_and_b32 v183, 0xffff0000, v124
    v_lshlrev_b32 v184, 16, v125
    v_and_b32 v185, 0xffff0000, v125
    v_lshlrev_b32 v186, 16, v126
    v_and_b32 v187, 0xffff0000, v126
    v_lshlrev_b32 v188, 16, v127
    v_and_b32 v189, 0xffff0000, v127
    v_lshlrev_b32 v190, 16, v128
    v_and_b32 v191, 0xffff0000, v128
    v_lshlrev_b32 v192, 16, v129
    v_and_b32 v193, 0xffff0000, v129
    v_lshlrev_b32 v194, 16, v130
    v_and_b32 v195, 0xffff0000, v130
    v_lshlrev_b32 v196, 16, v131
    v_and_b32 v197, 0xffff0000, v131
    v_lshlrev_b32 v198, 16, v132
    v_and_b32 v199, 0xffff0000, v132
    v_lshlrev_b32 v200, 16, v133
    v_and_b32 v201, 0xffff0000, v133
    v_lshlrev_b32 v202, 16, v134
    v_and_b32 v203, 0xffff0000, v134
    v_lshlrev_b32 v204, 16, v135
    v_and_b32 v205, 0xffff0000, v135
    v_lshlrev_b32 v206, 16, v136
    v_and_b32 v207, 0xffff0000, v136
    v_lshlrev_b32 v208, 16, v137
    v_and_b32 v209, 0xffff0000, v137
    v_lshlrev_b32 v210, 16, v138
    v_and_b32 v211, 0xffff0000, v138
    v_lshlrev_b32 v212, 16, v139
    v_and_b32 v213, 0xffff0000, v139
    v_lshlrev_b32 v214, 16, v140
    v_and_b32 v215, 0xffff0000, v140
    v_lshlrev_b32 v216, 16, v141
    v_and_b32 v217, 0xffff0000, v141
    v_lshlrev_b32 v218, 16, v142
    v_and_b32 v219, 0xffff0000, v142
    v_lshlrev_b32 v220, 16, v143
    v_and_b32 v221, 0xffff0000, v143
    v_lshlrev_b32 v222, 16, v144
    v_and_b32 v223, 0xffff0000, v144
    v_lshlrev_b32 v224, 16, v145
    v_and_b32 v225, 0xffff0000, v145
    v_lshlrev_b32 v226, 16, v146
    v_and_b32 v227, 0xffff0000, v146
    v_lshlrev_b32 v228, 16, v147
    v_and_b32 v229, 0xffff0000, v147
    v_lshlrev_b32 v230, 16, v148
    v_and_b32 v231, 0xffff0000, v148
    v_lshlrev_b32 v232, 16, v149
    v_and_b32 v233, 0xffff0000, v149
    v_lshlrev_b32 v234, 16, v150
    v_and_b32 v235, 0xffff0000, v150
    v_lshlrev_b32 v236, 16, v151
    v_and_b32 v237, 0xffff0000, v151
    v_lshlrev_b32 v238, 16, v152
    v_and_b32 v239, 0xffff0000, v152
    v_lshlrev_b32 v240, 16, v153
    v_and_b32 v241, 0xffff0000, v153
    v_mul_f32 v24, v154, v213
    v_mul_f32 v25, v155, v217
    v_mul_f32 v26, v156, v221
    v_mul_f32 v27, v157, v225
    v_mul_f32 v28, v158, v229
    v_mul_f32 v29, v159, v233
    v_mul_f32 v30, v160, v237
    v_mul_f32 v31, v161, v241
    v_mul_f32 v32, v162, v213
    v_mul_f32 v33, v163, v217
    v_mul_f32 v34, v164, v221
    v_mul_f32 v35, v165, v225
    v_mul_f32 v36, v166, v229
    v_mul_f32 v37, v167, v233
    v_mul_f32 v38, v168, v237
    v_mul_f32 v39, v169, v241
    v_cvt_pk_bf16_f32 v56, v24, v32
    v_cvt_pk_bf16_f32 v57, v25, v33
    v_cvt_pk_bf16_f32 v58, v26, v34
    v_cvt_pk_bf16_f32 v59, v27, v35
    v_cvt_pk_bf16_f32 v60, v28, v36
    v_cvt_pk_bf16_f32 v61, v29, v37
    v_cvt_pk_bf16_f32 v62, v30, v38
    v_cvt_pk_bf16_f32 v63, v31, v39
    v_lshlrev_b32 v24, 16, v56
    v_lshlrev_b32 v25, 16, v57
    v_lshlrev_b32 v26, 16, v58
    v_lshlrev_b32 v27, 16, v59
    v_lshlrev_b32 v28, 16, v60
    v_lshlrev_b32 v29, 16, v61
    v_lshlrev_b32 v30, 16, v62
    v_lshlrev_b32 v31, 16, v63
    v_and_b32 v32, 0xffff0000, v56
    v_and_b32 v33, 0xffff0000, v57
    v_and_b32 v34, 0xffff0000, v58
    v_and_b32 v35, 0xffff0000, v59
    v_and_b32 v36, 0xffff0000, v60
    v_and_b32 v37, 0xffff0000, v61
    v_and_b32 v38, 0xffff0000, v62
    v_and_b32 v39, 0xffff0000, v63
    v_mov_b32 v40, v24
    v_mov_b32 v41, v25
    v_mov_b32 v42, v26
    v_mov_b32 v43, v27
    v_mov_b32 v44, v28
    v_mov_b32 v45, v29
    v_mov_b32 v46, v30
    v_mov_b32 v47, v31
    v_mov_b32 v48, v32
    v_mov_b32 v49, v33
    v_mov_b32 v50, v34
    v_mov_b32 v51, v35
    v_mov_b32 v52, v36
    v_mov_b32 v53, v37
    v_mov_b32 v54, v38
    v_mov_b32 v55, v39
    v_mul_f32 v24, v162, v212
    v_mul_f32 v25, v163, v216
    v_mul_f32 v26, v164, v220
    v_mul_f32 v27, v165, v224
    v_mul_f32 v28, v166, v228
    v_mul_f32 v29, v167, v232
    v_mul_f32 v30, v168, v236
    v_mul_f32 v31, v169, v240
    v_mul_f32 v32, v170, v212
    v_mul_f32 v33, v171, v216
    v_mul_f32 v34, v172, v220
    v_mul_f32 v35, v173, v224
    v_mul_f32 v36, v174, v228
    v_mul_f32 v37, v175, v232
    v_mul_f32 v38, v176, v236
    v_mul_f32 v39, v177, v240
    v_cvt_pk_bf16_f32 v56, v24, v32
    v_cvt_pk_bf16_f32 v57, v25, v33
    v_cvt_pk_bf16_f32 v58, v26, v34
    v_cvt_pk_bf16_f32 v59, v27, v35
    v_cvt_pk_bf16_f32 v60, v28, v36
    v_cvt_pk_bf16_f32 v61, v29, v37
    v_cvt_pk_bf16_f32 v62, v30, v38
    v_cvt_pk_bf16_f32 v63, v31, v39
    v_lshlrev_b32 v24, 16, v56
    v_lshlrev_b32 v25, 16, v57
    v_lshlrev_b32 v26, 16, v58
    v_lshlrev_b32 v27, 16, v59
    v_lshlrev_b32 v28, 16, v60
    v_lshlrev_b32 v29, 16, v61
    v_lshlrev_b32 v30, 16, v62
    v_lshlrev_b32 v31, 16, v63
    v_and_b32 v32, 0xffff0000, v56
    v_and_b32 v33, 0xffff0000, v57
    v_and_b32 v34, 0xffff0000, v58
    v_and_b32 v35, 0xffff0000, v59
    v_and_b32 v36, 0xffff0000, v60
    v_and_b32 v37, 0xffff0000, v61
    v_and_b32 v38, 0xffff0000, v62
    v_and_b32 v39, 0xffff0000, v63
    v_add_f32 v24, v40, v24
    v_add_f32 v25, v41, v25
    v_add_f32 v26, v42, v26
    v_add_f32 v27, v43, v27
    v_add_f32 v28, v44, v28
    v_add_f32 v29, v45, v29
    v_add_f32 v30, v46, v30
    v_add_f32 v31, v47, v31
    v_add_f32 v32, v48, v32
    v_add_f32 v33, v49, v33
    v_add_f32 v34, v50, v34
    v_add_f32 v35, v51, v35
    v_add_f32 v36, v52, v36
    v_add_f32 v37, v53, v37
    v_add_f32 v38, v54, v38
    v_add_f32 v39, v55, v39
    v_cvt_pk_bf16_f32 v56, v24, v32
    v_cvt_pk_bf16_f32 v57, v25, v33
    v_cvt_pk_bf16_f32 v58, v26, v34
    v_cvt_pk_bf16_f32 v59, v27, v35
    v_cvt_pk_bf16_f32 v60, v28, v36
    v_cvt_pk_bf16_f32 v61, v29, v37
    v_cvt_pk_bf16_f32 v62, v30, v38
    v_cvt_pk_bf16_f32 v63, v31, v39
    v_lshlrev_b32 v24, 16, v56
    v_lshlrev_b32 v25, 16, v57
    v_lshlrev_b32 v26, 16, v58
    v_lshlrev_b32 v27, 16, v59
    v_lshlrev_b32 v28, 16, v60
    v_lshlrev_b32 v29, 16, v61
    v_lshlrev_b32 v30, 16, v62
    v_lshlrev_b32 v31, 16, v63
    v_and_b32 v32, 0xffff0000, v56
    v_and_b32 v33, 0xffff0000, v57
    v_and_b32 v34, 0xffff0000, v58
    v_and_b32 v35, 0xffff0000, v59
    v_and_b32 v36, 0xffff0000, v60
    v_and_b32 v37, 0xffff0000, v61
    v_and_b32 v38, 0xffff0000, v62
    v_and_b32 v39, 0xffff0000, v63
    v_mov_b32 v40, v24
    v_mov_b32 v41, v25
    v_mov_b32 v42, v26
    v_mov_b32 v43, v27
    v_mov_b32 v44, v28
    v_mov_b32 v45, v29
    v_mov_b32 v46, v30
    v_mov_b32 v47, v31
    v_mov_b32 v48, v32
    v_mov_b32 v49, v33
    v_mov_b32 v50, v34
    v_mov_b32 v51, v35
    v_mov_b32 v52, v36
    v_mov_b32 v53, v37
    v_mov_b32 v54, v38
    v_mov_b32 v55, v39
    v_mul_f32 v24, v170, v211
    v_mul_f32 v25, v171, v215
    v_mul_f32 v26, v172, v219
    v_mul_f32 v27, v173, v223
    v_mul_f32 v28, v174, v227
    v_mul_f32 v29, v175, v231
    v_mul_f32 v30, v176, v235
    v_mul_f32 v31, v177, v239
    v_mul_f32 v32, v178, v211
    v_mul_f32 v33, v179, v215
    v_mul_f32 v34, v180, v219
    v_mul_f32 v35, v181, v223
    v_mul_f32 v36, v182, v227
    v_mul_f32 v37, v183, v231
    v_mul_f32 v38, v184, v235
    v_mul_f32 v39, v185, v239
    v_cvt_pk_bf16_f32 v56, v24, v32
    v_cvt_pk_bf16_f32 v57, v25, v33
    v_cvt_pk_bf16_f32 v58, v26, v34
    v_cvt_pk_bf16_f32 v59, v27, v35
    v_cvt_pk_bf16_f32 v60, v28, v36
    v_cvt_pk_bf16_f32 v61, v29, v37
    v_cvt_pk_bf16_f32 v62, v30, v38
    v_cvt_pk_bf16_f32 v63, v31, v39
    v_lshlrev_b32 v24, 16, v56
    v_lshlrev_b32 v25, 16, v57
    v_lshlrev_b32 v26, 16, v58
    v_lshlrev_b32 v27, 16, v59
    v_lshlrev_b32 v28, 16, v60
    v_lshlrev_b32 v29, 16, v61
    v_lshlrev_b32 v30, 16, v62
    v_lshlrev_b32 v31, 16, v63
    v_and_b32 v32, 0xffff0000, v56
    v_and_b32 v33, 0xffff0000, v57
    v_and_b32 v34, 0xffff0000, v58
    v_and_b32 v35, 0xffff0000, v59
    v_and_b32 v36, 0xffff0000, v60
    v_and_b32 v37, 0xffff0000, v61
    v_and_b32 v38, 0xffff0000, v62
    v_and_b32 v39, 0xffff0000, v63
    v_add_f32 v24, v40, v24
    v_add_f32 v25, v41, v25
    v_add_f32 v26, v42, v26
    v_add_f32 v27, v43, v27
    v_add_f32 v28, v44, v28
    v_add_f32 v29, v45, v29
    v_add_f32 v30, v46, v30
    v_add_f32 v31, v47, v31
    v_add_f32 v32, v48, v32
    v_add_f32 v33, v49, v33
    v_add_f32 v34, v50, v34
    v_add_f32 v35, v51, v35
    v_add_f32 v36, v52, v36
    v_add_f32 v37, v53, v37
    v_add_f32 v38, v54, v38
    v_add_f32 v39, v55, v39
    v_cvt_pk_bf16_f32 v56, v24, v32
    v_cvt_pk_bf16_f32 v57, v25, v33
    v_cvt_pk_bf16_f32 v58, v26, v34
    v_cvt_pk_bf16_f32 v59, v27, v35
    v_cvt_pk_bf16_f32 v60, v28, v36
    v_cvt_pk_bf16_f32 v61, v29, v37
    v_cvt_pk_bf16_f32 v62, v30, v38
    v_cvt_pk_bf16_f32 v63, v31, v39
    v_lshlrev_b32 v24, 16, v56
    v_lshlrev_b32 v25, 16, v57
    v_lshlrev_b32 v26, 16, v58
    v_lshlrev_b32 v27, 16, v59
    v_lshlrev_b32 v28, 16, v60
    v_lshlrev_b32 v29, 16, v61
    v_lshlrev_b32 v30, 16, v62
    v_lshlrev_b32 v31, 16, v63
    v_and_b32 v32, 0xffff0000, v56
    v_and_b32 v33, 0xffff0000, v57
    v_and_b32 v34, 0xffff0000, v58
    v_and_b32 v35, 0xffff0000, v59
    v_and_b32 v36, 0xffff0000, v60
    v_and_b32 v37, 0xffff0000, v61
    v_and_b32 v38, 0xffff0000, v62
    v_and_b32 v39, 0xffff0000, v63
    v_mov_b32 v40, v24
    v_mov_b32 v41, v25
    v_mov_b32 v42, v26
    v_mov_b32 v43, v27
    v_mov_b32 v44, v28
    v_mov_b32 v45, v29
    v_mov_b32 v46, v30
    v_mov_b32 v47, v31
    v_mov_b32 v48, v32
    v_mov_b32 v49, v33
    v_mov_b32 v50, v34
    v_mov_b32 v51, v35
    v_mov_b32 v52, v36
    v_mov_b32 v53, v37
    v_mov_b32 v54, v38
    v_mov_b32 v55, v39
    v_mul_f32 v24, v178, v210
    v_mul_f32 v25, v179, v214
    v_mul_f32 v26, v180, v218
    v_mul_f32 v27, v181, v222
    v_mul_f32 v28, v182, v226
    v_mul_f32 v29, v183, v230
    v_mul_f32 v30, v184, v234
    v_mul_f32 v31, v185, v238
    v_mul_f32 v32, v186, v210
    v_mul_f32 v33, v187, v214
    v_mul_f32 v34, v188, v218
    v_mul_f32 v35, v189, v222
    v_mul_f32 v36, v190, v226
    v_mul_f32 v37, v191, v230
    v_mul_f32 v38, v192, v234
    v_mul_f32 v39, v193, v238
    v_cvt_pk_bf16_f32 v56, v24, v32
    v_cvt_pk_bf16_f32 v57, v25, v33
    v_cvt_pk_bf16_f32 v58, v26, v34
    v_cvt_pk_bf16_f32 v59, v27, v35
    v_cvt_pk_bf16_f32 v60, v28, v36
    v_cvt_pk_bf16_f32 v61, v29, v37
    v_cvt_pk_bf16_f32 v62, v30, v38
    v_cvt_pk_bf16_f32 v63, v31, v39
    v_lshlrev_b32 v24, 16, v56
    v_lshlrev_b32 v25, 16, v57
    v_lshlrev_b32 v26, 16, v58
    v_lshlrev_b32 v27, 16, v59
    v_lshlrev_b32 v28, 16, v60
    v_lshlrev_b32 v29, 16, v61
    v_lshlrev_b32 v30, 16, v62
    v_lshlrev_b32 v31, 16, v63
    v_and_b32 v32, 0xffff0000, v56
    v_and_b32 v33, 0xffff0000, v57
    v_and_b32 v34, 0xffff0000, v58
    v_and_b32 v35, 0xffff0000, v59
    v_and_b32 v36, 0xffff0000, v60
    v_and_b32 v37, 0xffff0000, v61
    v_and_b32 v38, 0xffff0000, v62
    v_and_b32 v39, 0xffff0000, v63
    v_add_f32 v24, v40, v24
    v_add_f32 v25, v41, v25
    v_add_f32 v26, v42, v26
    v_add_f32 v27, v43, v27
    v_add_f32 v28, v44, v28
    v_add_f32 v29, v45, v29
    v_add_f32 v30, v46, v30
    v_add_f32 v31, v47, v31
    v_add_f32 v32, v48, v32
    v_add_f32 v33, v49, v33
    v_add_f32 v34, v50, v34
    v_add_f32 v35, v51, v35
    v_add_f32 v36, v52, v36
    v_add_f32 v37, v53, v37
    v_add_f32 v38, v54, v38
    v_add_f32 v39, v55, v39
    v_cvt_pk_bf16_f32 v56, v24, v32
    v_cvt_pk_bf16_f32 v57, v25, v33
    v_cvt_pk_bf16_f32 v58, v26, v34
    v_cvt_pk_bf16_f32 v59, v27, v35
    v_cvt_pk_bf16_f32 v60, v28, v36
    v_cvt_pk_bf16_f32 v61, v29, v37
    v_cvt_pk_bf16_f32 v62, v30, v38
    v_cvt_pk_bf16_f32 v63, v31, v39
    v_lshlrev_b32 v24, 16, v56
    v_lshlrev_b32 v25, 16, v57
    v_lshlrev_b32 v26, 16, v58
    v_lshlrev_b32 v27, 16, v59
    v_lshlrev_b32 v28, 16, v60
    v_lshlrev_b32 v29, 16, v61
    v_lshlrev_b32 v30, 16, v62
    v_lshlrev_b32 v31, 16, v63
    v_and_b32 v32, 0xffff0000, v56
    v_and_b32 v33, 0xffff0000, v57
    v_and_b32 v34, 0xffff0000, v58
    v_and_b32 v35, 0xffff0000, v59
    v_and_b32 v36, 0xffff0000, v60
    v_and_b32 v37, 0xffff0000, v61
    v_and_b32 v38, 0xffff0000, v62
    v_and_b32 v39, 0xffff0000, v63
    v_mul_f32 v24, v24, v194
    v_mul_f32 v25, v25, v195
    v_mul_f32 v26, v26, v196
    v_mul_f32 v27, v27, v197
    v_mul_f32 v28, v28, v198
    v_mul_f32 v29, v29, v199
    v_mul_f32 v30, v30, v200
    v_mul_f32 v31, v31, v201
    v_mul_f32 v32, v32, v202
    v_mul_f32 v33, v33, v203
    v_mul_f32 v34, v34, v204
    v_mul_f32 v35, v35, v205
    v_mul_f32 v36, v36, v206
    v_mul_f32 v37, v37, v207
    v_mul_f32 v38, v38, v208
    v_mul_f32 v39, v39, v209
    v_cvt_pk_bf16_f32 v248, v24, v32
    v_cvt_pk_bf16_f32 v249, v25, v33
    v_cvt_pk_bf16_f32 v250, v26, v34
    v_cvt_pk_bf16_f32 v251, v27, v35
    v_cvt_pk_bf16_f32 v252, v28, v36
    v_cvt_pk_bf16_f32 v253, v29, v37
    v_cvt_pk_bf16_f32 v254, v30, v38
    v_cvt_pk_bf16_f32 v255, v31, v39
    v_lshlrev_b32 v108, 15, v106
    s_lshl_b32 s25, s86, 1
    s_add_u32 s26, s25, 0
    buffer_store_dword v248, v108, s[72:75], s26 offen
    s_add_u32 s26, s25, 4096
    buffer_store_dword v249, v108, s[72:75], s26 offen
    s_add_u32 s26, s25, 8192
    buffer_store_dword v250, v108, s[72:75], s26 offen
    s_add_u32 s26, s25, 12288
    buffer_store_dword v251, v108, s[72:75], s26 offen
    s_add_u32 s26, s25, 16384
    buffer_store_dword v252, v108, s[72:75], s26 offen
    s_add_u32 s26, s25, 20480
    buffer_store_dword v253, v108, s[72:75], s26 offen
    s_add_u32 s26, s25, 24576
    buffer_store_dword v254, v108, s[72:75], s26 offen
    s_add_u32 s26, s25, 28672
    buffer_store_dword v255, v108, s[72:75], s26 offen
    s_mov_b64 exec, s[84:85]
    v_cmp_gt_u32 vcc, 56, v106
    s_nop 1
    v_cndmask_b32 v16, 0, v16, vcc
    v_cndmask_b32 v17, 0, v17, vcc
    ds_swizzle_b32 v18, v16 offset:0x41f
    ds_swizzle_b32 v19, v17 offset:0x41f
    s_waitcnt lgkmcnt(0)
    v_add_f32 v16, v16, v18
    v_add_f32 v17, v17, v19
    ds_swizzle_b32 v18, v16 offset:0x81f
    ds_swizzle_b32 v19, v17 offset:0x81f
    s_waitcnt lgkmcnt(0)
    v_add_f32 v16, v16, v18
    v_add_f32 v17, v17, v19
    ds_swizzle_b32 v18, v16 offset:0x101f
    ds_swizzle_b32 v19, v17 offset:0x101f
    s_waitcnt lgkmcnt(0)
    v_add_f32 v16, v16, v18
    v_add_f32 v17, v17, v19
    ds_swizzle_b32 v18, v16 offset:0x201f
    ds_swizzle_b32 v19, v17 offset:0x201f
    s_waitcnt lgkmcnt(0)
    v_add_f32 v16, v16, v18
    v_add_f32 v17, v17, v19
    ds_swizzle_b32 v18, v16 offset:0x401f
    ds_swizzle_b32 v19, v17 offset:0x401f
    s_waitcnt lgkmcnt(0)
    v_add_f32 v16, v16, v18
    v_add_f32 v17, v17, v19
    v_mov_b32 v18, v16
    v_mov_b32 v19, v17
    s_nop 1
    v_permlane32_swap_b32 v18, v16
    v_permlane32_swap_b32 v19, v17
    v_add_f32 v16, v16, v18
    v_add_f32 v17, v17, v19
    v_cmp_eq_u32 vcc, 1, v106
    s_nop 1
    v_cndmask_b32 v24, v16, v17, vcc
    v_cvt_pk_bf16_f32 v56, v24, v24
    v_lshlrev_b32 v24, 16, v56
    v_mul_f32 v24, 0xbfb8aa3b, v24
    v_exp_f32 v24, v24
    s_nop 0
    v_add_f32 v24, 1.0, v24
    v_rcp_f32 v24, v24
    s_nop 0
    v_cvt_pk_bf16_f32 v56, v24, v24
    v_lshlrev_b32 v40, 16, v56
    v_sub_f32 v24, 1.0, v40
    v_cvt_pk_bf16_f32 v56, v24, v24
    v_lshlrev_b32 v41, 16, v56
    v_lshlrev_b32 v108, 3, v106
    s_lshl_b32 s25, s86, 3
    v_cmp_gt_u32 vcc, 2, v106
    s_and_saveexec_b64 s[84:85], vcc
    buffer_store_dwordx2 v[40:41], v108, s[92:95], s25 offen
    s_mov_b64 exec, s[84:85]
    s_waitcnt vmcnt(9)
    s_barrier
    ds_read_b128 v[0:3], v84 offset:0
    ds_read_b64_tr_b16 v[16:17], v88 offset:0
    ds_read_b64_tr_b16 v[18:19], v88 offset:2048
    ds_read_b64_tr_b16 v[20:21], v89 offset:0
    ds_read_b64_tr_b16 v[22:23], v89 offset:2048
    ds_read_b128 v[4:7], v84 offset:4096
    ds_read_b64_tr_b16 v[24:25], v90 offset:0
    ds_read_b64_tr_b16 v[26:27], v90 offset:2048
    ds_read_b64_tr_b16 v[28:29], v91 offset:0
    ds_read_b64_tr_b16 v[30:31], v91 offset:2048
    ds_read_b128 v[8:11], v84 offset:8192
    ds_read_b128 v[12:15], v84 offset:12288
    s_cmp_eq_u32 s21, 1
    s_cbranch_scc1 L_proj_m1
    s_waitcnt lgkmcnt(0)
    v_mfma_f32_32x32x16_bf16 a[0:15], v[16:19], v[0:3], 0
    s_add_u32 m0, s17, 32768
    ds_read_b128 v[32:35], v85 offset:0
    buffer_load_dwordx4 v76, s[8:11], s19 offen lds
    v_mfma_f32_32x32x16_bf16 a[16:31], v[20:23], v[0:3], 0
    s_add_u32 m0, s17, 33792
    ds_read_b64_tr_b16 v[48:49], v88 offset:8192
    buffer_load_dwordx4 v77, s[8:11], s19 offen lds
    v_mfma_f32_32x32x16_bf16 a[32:47], v[24:27], v[0:3], 0
    ds_read_b64_tr_b16 v[50:51], v88 offset:10240
    v_mfma_f32_32x32x16_bf16 a[48:63], v[28:31], v[0:3], 0
    s_add_u32 m0, s17, 34816
    ds_read_b64_tr_b16 v[52:53], v89 offset:8192
    buffer_load_dwordx4 v78, s[8:11], s19 offen lds
    v_mfma_f32_32x32x16_bf16 a[64:79], v[16:19], v[4:7], 0
    ds_read_b64_tr_b16 v[54:55], v89 offset:10240
    v_mfma_f32_32x32x16_bf16 a[80:95], v[20:23], v[4:7], 0
    s_add_u32 m0, s17, 35840
    ds_read_b128 v[36:39], v85 offset:4096
    buffer_load_dwordx4 v79, s[8:11], s19 offen lds
    v_mfma_f32_32x32x16_bf16 a[96:111], v[24:27], v[4:7], 0
    ds_read_b64_tr_b16 v[56:57], v90 offset:8192
    v_mfma_f32_32x32x16_bf16 a[112:127], v[28:31], v[4:7], 0
    s_add_u32 m0, s17, 36864
    ds_read_b64_tr_b16 v[58:59], v90 offset:10240
    buffer_load_dwordx4 v80, s[8:11], s19 offen lds
    v_mfma_f32_32x32x16_bf16 a[128:143], v[16:19], v[8:11], 0
    s_add_u32 m0, s17, 37888
    ds_read_b64_tr_b16 v[60:61], v91 offset:8192
    buffer_load_dwordx4 v81, s[8:11], s19 offen lds
    v_mfma_f32_32x32x16_bf16 a[144:159], v[20:23], v[8:11], 0
    ds_read_b64_tr_b16 v[62:63], v91 offset:10240
    v_mfma_f32_32x32x16_bf16 a[160:175], v[24:27], v[8:11], 0
    s_add_u32 m0, s17, 38912
    ds_read_b128 v[40:43], v85 offset:8192
    buffer_load_dwordx4 v82, s[8:11], s19 offen lds
    v_mfma_f32_32x32x16_bf16 a[176:191], v[28:31], v[8:11], 0
    ds_read_b128 v[44:47], v85 offset:12288
    s_add_u32 m0, s17, 39936
    v_mfma_f32_32x32x16_bf16 a[192:207], v[16:19], v[12:15], 0
    buffer_load_dwordx4 v83, s[8:11], s19 offen lds
    v_mfma_f32_32x32x16_bf16 a[208:223], v[20:23], v[12:15], 0
    v_mfma_f32_32x32x16_bf16 a[224:239], v[24:27], v[12:15], 0
    s_add_u32 s19, s19, 0x80000
    s_xor_b32 s17, s17, 0x10000
    v_mfma_f32_32x32x16_bf16 a[240:255], v[28:31], v[12:15], 0
    s_waitcnt lgkmcnt(0)
    v_mfma_f32_32x32x16_bf16 a[0:15], v[48:51], v[32:35], a[0:15]
    ds_read_b128 v[0:3], v86 offset:0
    v_mfma_f32_32x32x16_bf16 a[16:31], v[52:55], v[32:35], a[16:31]
    ds_read_b64_tr_b16 v[16:17], v88 offset:16384
    v_mfma_f32_32x32x16_bf16 a[32:47], v[56:59], v[32:35], a[32:47]
    ds_read_b64_tr_b16 v[18:19], v88 offset:18432
    v_mfma_f32_32x32x16_bf16 a[48:63], v[60:63], v[32:35], a[48:63]
    ds_read_b64_tr_b16 v[20:21], v89 offset:16384
    v_mfma_f32_32x32x16_bf16 a[64:79], v[48:51], v[36:39], a[64:79]
    ds_read_b64_tr_b16 v[22:23], v89 offset:18432
    v_mfma_f32_32x32x16_bf16 a[80:95], v[52:55], v[36:39], a[80:95]
    ds_read_b128 v[4:7], v86 offset:4096
    v_mfma_f32_32x32x16_bf16 a[96:111], v[56:59], v[36:39], a[96:111]
    ds_read_b64_tr_b16 v[24:25], v90 offset:16384
    v_mfma_f32_32x32x16_bf16 a[112:127], v[60:63], v[36:39], a[112:127]
    ds_read_b64_tr_b16 v[26:27], v90 offset:18432
    v_mfma_f32_32x32x16_bf16 a[128:143], v[48:51], v[40:43], a[128:143]
    ds_read_b64_tr_b16 v[28:29], v91 offset:16384
    v_mfma_f32_32x32x16_bf16 a[144:159], v[52:55], v[40:43], a[144:159]
    ds_read_b64_tr_b16 v[30:31], v91 offset:18432
    v_mfma_f32_32x32x16_bf16 a[160:175], v[56:59], v[40:43], a[160:175]
    ds_read_b128 v[8:11], v86 offset:8192
    v_mfma_f32_32x32x16_bf16 a[176:191], v[60:63], v[40:43], a[176:191]
    ds_read_b128 v[12:15], v86 offset:12288
    v_mfma_f32_32x32x16_bf16 a[192:207], v[48:51], v[44:47], a[192:207]
    v_mfma_f32_32x32x16_bf16 a[208:223], v[52:55], v[44:47], a[208:223]
    v_mfma_f32_32x32x16_bf16 a[224:239], v[56:59], v[44:47], a[224:239]
    v_mfma_f32_32x32x16_bf16 a[240:255], v[60:63], v[44:47], a[240:255]
    s_waitcnt lgkmcnt(0)
    v_mfma_f32_32x32x16_bf16 a[0:15], v[16:19], v[0:3], a[0:15]
    ds_read_b128 v[32:35], v87 offset:0
    v_mfma_f32_32x32x16_bf16 a[16:31], v[20:23], v[0:3], a[16:31]
    ds_read_b64_tr_b16 v[48:49], v88 offset:24576
    v_mfma_f32_32x32x16_bf16 a[32:47], v[24:27], v[0:3], a[32:47]
    ds_read_b64_tr_b16 v[50:51], v88 offset:26624
    v_mfma_f32_32x32x16_bf16 a[48:63], v[28:31], v[0:3], a[48:63]
    ds_read_b64_tr_b16 v[52:53], v89 offset:24576
    v_mfma_f32_32x32x16_bf16 a[64:79], v[16:19], v[4:7], a[64:79]
    ds_read_b64_tr_b16 v[54:55], v89 offset:26624
    v_mfma_f32_32x32x16_bf16 a[80:95], v[20:23], v[4:7], a[80:95]
    ds_read_b128 v[36:39], v87 offset:4096
    v_mfma_f32_32x32x16_bf16 a[96:111], v[24:27], v[4:7], a[96:111]
    ds_read_b64_tr_b16 v[56:57], v90 offset:24576
    v_mfma_f32_32x32x16_bf16 a[112:127], v[28:31], v[4:7], a[112:127]
    ds_read_b64_tr_b16 v[58:59], v90 offset:26624
    v_mfma_f32_32x32x16_bf16 a[128:143], v[16:19], v[8:11], a[128:143]
    ds_read_b64_tr_b16 v[60:61], v91 offset:24576
    v_mfma_f32_32x32x16_bf16 a[144:159], v[20:23], v[8:11], a[144:159]
    ds_read_b64_tr_b16 v[62:63], v91 offset:26624
    v_mfma_f32_32x32x16_bf16 a[160:175], v[24:27], v[8:11], a[160:175]
    ds_read_b128 v[40:43], v87 offset:8192
    v_mfma_f32_32x32x16_bf16 a[176:191], v[28:31], v[8:11], a[176:191]
    ds_read_b128 v[44:47], v87 offset:12288
    v_mfma_f32_32x32x16_bf16 a[192:207], v[16:19], v[12:15], a[192:207]
    v_mfma_f32_32x32x16_bf16 a[208:223], v[20:23], v[12:15], a[208:223]
    v_mfma_f32_32x32x16_bf16 a[224:239], v[24:27], v[12:15], a[224:239]
    v_mfma_f32_32x32x16_bf16 a[240:255], v[28:31], v[12:15], a[240:255]
    s_waitcnt lgkmcnt(0)
    s_waitcnt vmcnt(0)
    s_barrier
    v_mfma_f32_32x32x16_bf16 a[0:15], v[48:51], v[32:35], a[0:15]
    v_xor_b32 v84, 0x10000, v84
    s_add_u32 m0, s17, 0
    v_xor_b32 v85, 0x10000, v85
    buffer_load_dwordx4 v68, s[4:7], s18 offen lds
    v_mfma_f32_32x32x16_bf16 a[16:31], v[52:55], v[32:35], a[16:31]
    s_add_u32 m0, s17, 1024
    v_xor_b32 v86, 0x10000, v86
    buffer_load_dwordx4 v69, s[4:7], s18 offen lds
    v_mfma_f32_32x32x16_bf16 a[32:47], v[56:59], v[32:35], a[32:47]
    v_xor_b32 v87, 0x10000, v87
    v_mfma_f32_32x32x16_bf16 a[48:63], v[60:63], v[32:35], a[48:63]
    s_add_u32 m0, s17, 2048
    v_xor_b32 v88, 0x10000, v88
    buffer_load_dwordx4 v70, s[4:7], s18 offen lds
    v_mfma_f32_32x32x16_bf16 a[64:79], v[48:51], v[36:39], a[64:79]
    v_xor_b32 v89, 0x10000, v89
    v_xor_b32 v90, 0x10000, v90
    v_mfma_f32_32x32x16_bf16 a[80:95], v[52:55], v[36:39], a[80:95]
    s_add_u32 m0, s17, 3072
    v_xor_b32 v91, 0x10000, v91
    buffer_load_dwordx4 v71, s[4:7], s18 offen lds
    v_mfma_f32_32x32x16_bf16 a[96:111], v[56:59], v[36:39], a[96:111]
    ds_read_b128 v[0:3], v84 offset:0
    v_mfma_f32_32x32x16_bf16 a[112:127], v[60:63], v[36:39], a[112:127]
    s_add_u32 m0, s17, 4096
    ds_read_b64_tr_b16 v[16:17], v88 offset:0
    buffer_load_dwordx4 v72, s[4:7], s18 offen lds
    v_mfma_f32_32x32x16_bf16 a[128:143], v[48:51], v[40:43], a[128:143]
    ds_read_b64_tr_b16 v[18:19], v88 offset:2048
    s_add_u32 m0, s17, 5120
    ds_read_b64_tr_b16 v[20:21], v89 offset:0
    buffer_load_dwordx4 v73, s[4:7], s18 offen lds
    v_mfma_f32_32x32x16_bf16 a[144:159], v[52:55], v[40:43], a[144:159]
    ds_read_b64_tr_b16 v[22:23], v89 offset:2048
    v_mfma_f32_32x32x16_bf16 a[160:175], v[56:59], v[40:43], a[160:175]
    s_add_u32 m0, s17, 6144
    ds_read_b128 v[4:7], v84 offset:4096
    buffer_load_dwordx4 v74, s[4:7], s18 offen lds
    v_mfma_f32_32x32x16_bf16 a[176:191], v[60:63], v[40:43], a[176:191]
    ds_read_b64_tr_b16 v[24:25], v90 offset:0
    v_mfma_f32_32x32x16_bf16 a[192:207], v[48:51], v[44:47], a[192:207]
    ds_read_b64_tr_b16 v[26:27], v90 offset:2048
    s_add_u32 m0, s17, 7168
    ds_read_b64_tr_b16 v[28:29], v91 offset:0
    buffer_load_dwordx4 v75, s[4:7], s18 offen lds
    v_mfma_f32_32x32x16_bf16 a[208:223], v[52:55], v[44:47], a[208:223]
    ds_read_b64_tr_b16 v[30:31], v91 offset:2048
    v_mfma_f32_32x32x16_bf16 a[224:239], v[56:59], v[44:47], a[224:239]
    ds_read_b128 v[8:11], v84 offset:8192
    s_add_u32 s18, s18, 128
    v_mfma_f32_32x32x16_bf16 a[240:255], v[60:63], v[44:47], a[240:255]
    ds_read_b128 v[12:15], v84 offset:12288
    s_mov_b32 s20, 13
L_proj_loop0:
    s_waitcnt lgkmcnt(0)
    v_mfma_f32_32x32x16_bf16 a[0:15], v[16:19], v[0:3], a[0:15]
    s_add_u32 m0, s17, 32768
    ds_read_b128 v[32:35], v85 offset:0
    buffer_load_dwordx4 v76, s[8:11], s19 offen lds
    v_mfma_f32_32x32x16_bf16 a[16:31], v[20:23], v[0:3], a[16:31]
    s_add_u32 m0, s17, 33792
    ds_read_b64_tr_b16 v[48:49], v88 offset:8192
    buffer_load_dwordx4 v77, s[8:11], s19 offen lds
    v_mfma_f32_32x32x16_bf16 a[32:47], v[24:27], v[0:3], a[32:47]
    ds_read_b64_tr_b16 v[50:51], v88 offset:10240
    v_mfma_f32_32x32x16_bf16 a[48:63], v[28:31], v[0:3], a[48:63]
    s_add_u32 m0, s17, 34816
    ds_read_b64_tr_b16 v[52:53], v89 offset:8192
    buffer_load_dwordx4 v78, s[8:11], s19 offen lds
    v_mfma_f32_32x32x16_bf16 a[64:79], v[16:19], v[4:7], a[64:79]
    ds_read_b64_tr_b16 v[54:55], v89 offset:10240
    v_mfma_f32_32x32x16_bf16 a[80:95], v[20:23], v[4:7], a[80:95]
    s_add_u32 m0, s17, 35840
    ds_read_b128 v[36:39], v85 offset:4096
    buffer_load_dwordx4 v79, s[8:11], s19 offen lds
    v_mfma_f32_32x32x16_bf16 a[96:111], v[24:27], v[4:7], a[96:111]
    ds_read_b64_tr_b16 v[56:57], v90 offset:8192
    v_mfma_f32_32x32x16_bf16 a[112:127], v[28:31], v[4:7], a[112:127]
    s_add_u32 m0, s17, 36864
    ds_read_b64_tr_b16 v[58:59], v90 offset:10240
    buffer_load_dwordx4 v80, s[8:11], s19 offen lds
    v_mfma_f32_32x32x16_bf16 a[128:143], v[16:19], v[8:11], a[128:143]
    s_add_u32 m0, s17, 37888
    ds_read_b64_tr_b16 v[60:61], v91 offset:8192
    buffer_load_dwordx4 v81, s[8:11], s19 offen lds
    v_mfma_f32_32x32x16_bf16 a[144:159], v[20:23], v[8:11], a[144:159]
    ds_read_b64_tr_b16 v[62:63], v91 offset:10240
    v_mfma_f32_32x32x16_bf16 a[160:175], v[24:27], v[8:11], a[160:175]
    s_add_u32 m0, s17, 38912
    ds_read_b128 v[40:43], v85 offset:8192
    buffer_load_dwordx4 v82, s[8:11], s19 offen lds
    v_mfma_f32_32x32x16_bf16 a[176:191], v[28:31], v[8:11], a[176:191]
    ds_read_b128 v[44:47], v85 offset:12288
    s_add_u32 m0, s17, 39936
    v_mfma_f32_32x32x16_bf16 a[192:207], v[16:19], v[12:15], a[192:207]
    buffer_load_dwordx4 v83, s[8:11], s19 offen lds
    v_mfma_f32_32x32x16_bf16 a[208:223], v[20:23], v[12:15], a[208:223]
    v_mfma_f32_32x32x16_bf16 a[224:239], v[24:27], v[12:15], a[224:239]
    s_add_u32 s19, s19, 0x80000
    s_xor_b32 s17, s17, 0x10000
    v_mfma_f32_32x32x16_bf16 a[240:255], v[28:31], v[12:15], a[240:255]
    s_waitcnt lgkmcnt(0)
    v_mfma_f32_32x32x16_bf16 a[0:15], v[48:51], v[32:35], a[0:15]
    ds_read_b128 v[0:3], v86 offset:0
    v_mfma_f32_32x32x16_bf16 a[16:31], v[52:55], v[32:35], a[16:31]
    ds_read_b64_tr_b16 v[16:17], v88 offset:16384
    v_mfma_f32_32x32x16_bf16 a[32:47], v[56:59], v[32:35], a[32:47]
    ds_read_b64_tr_b16 v[18:19], v88 offset:18432
    v_mfma_f32_32x32x16_bf16 a[48:63], v[60:63], v[32:35], a[48:63]
    ds_read_b64_tr_b16 v[20:21], v89 offset:16384
    v_mfma_f32_32x32x16_bf16 a[64:79], v[48:51], v[36:39], a[64:79]
    ds_read_b64_tr_b16 v[22:23], v89 offset:18432
    v_mfma_f32_32x32x16_bf16 a[80:95], v[52:55], v[36:39], a[80:95]
    ds_read_b128 v[4:7], v86 offset:4096
    v_mfma_f32_32x32x16_bf16 a[96:111], v[56:59], v[36:39], a[96:111]
    ds_read_b64_tr_b16 v[24:25], v90 offset:16384
    v_mfma_f32_32x32x16_bf16 a[112:127], v[60:63], v[36:39], a[112:127]
    ds_read_b64_tr_b16 v[26:27], v90 offset:18432
    v_mfma_f32_32x32x16_bf16 a[128:143], v[48:51], v[40:43], a[128:143]
    ds_read_b64_tr_b16 v[28:29], v91 offset:16384
    v_mfma_f32_32x32x16_bf16 a[144:159], v[52:55], v[40:43], a[144:159]
    ds_read_b64_tr_b16 v[30:31], v91 offset:18432
    v_mfma_f32_32x32x16_bf16 a[160:175], v[56:59], v[40:43], a[160:175]
    ds_read_b128 v[8:11], v86 offset:8192
    v_mfma_f32_32x32x16_bf16 a[176:191], v[60:63], v[40:43], a[176:191]
    ds_read_b128 v[12:15], v86 offset:12288
    v_mfma_f32_32x32x16_bf16 a[192:207], v[48:51], v[44:47], a[192:207]
    v_mfma_f32_32x32x16_bf16 a[208:223], v[52:55], v[44:47], a[208:223]
    v_mfma_f32_32x32x16_bf16 a[224:239], v[56:59], v[44:47], a[224:239]
    v_mfma_f32_32x32x16_bf16 a[240:255], v[60:63], v[44:47], a[240:255]
    s_waitcnt lgkmcnt(0)
    v_mfma_f32_32x32x16_bf16 a[0:15], v[16:19], v[0:3], a[0:15]
    ds_read_b128 v[32:35], v87 offset:0
    v_mfma_f32_32x32x16_bf16 a[16:31], v[20:23], v[0:3], a[16:31]
    ds_read_b64_tr_b16 v[48:49], v88 offset:24576
    v_mfma_f32_32x32x16_bf16 a[32:47], v[24:27], v[0:3], a[32:47]
    ds_read_b64_tr_b16 v[50:51], v88 offset:26624
    v_mfma_f32_32x32x16_bf16 a[48:63], v[28:31], v[0:3], a[48:63]
    ds_read_b64_tr_b16 v[52:53], v89 offset:24576
    v_mfma_f32_32x32x16_bf16 a[64:79], v[16:19], v[4:7], a[64:79]
    ds_read_b64_tr_b16 v[54:55], v89 offset:26624
    v_mfma_f32_32x32x16_bf16 a[80:95], v[20:23], v[4:7], a[80:95]
    ds_read_b128 v[36:39], v87 offset:4096
    v_mfma_f32_32x32x16_bf16 a[96:111], v[24:27], v[4:7], a[96:111]
    ds_read_b64_tr_b16 v[56:57], v90 offset:24576
    v_mfma_f32_32x32x16_bf16 a[112:127], v[28:31], v[4:7], a[112:127]
    ds_read_b64_tr_b16 v[58:59], v90 offset:26624
    v_mfma_f32_32x32x16_bf16 a[128:143], v[16:19], v[8:11], a[128:143]
    ds_read_b64_tr_b16 v[60:61], v91 offset:24576
    v_mfma_f32_32x32x16_bf16 a[144:159], v[20:23], v[8:11], a[144:159]
    ds_read_b64_tr_b16 v[62:63], v91 offset:26624
    v_mfma_f32_32x32x16_bf16 a[160:175], v[24:27], v[8:11], a[160:175]
    ds_read_b128 v[40:43], v87 offset:8192
    v_mfma_f32_32x32x16_bf16 a[176:191], v[28:31], v[8:11], a[176:191]
    ds_read_b128 v[44:47], v87 offset:12288
    v_mfma_f32_32x32x16_bf16 a[192:207], v[16:19], v[12:15], a[192:207]
    v_mfma_f32_32x32x16_bf16 a[208:223], v[20:23], v[12:15], a[208:223]
    v_mfma_f32_32x32x16_bf16 a[224:239], v[24:27], v[12:15], a[224:239]
    v_mfma_f32_32x32x16_bf16 a[240:255], v[28:31], v[12:15], a[240:255]
    s_waitcnt lgkmcnt(0)
    s_waitcnt vmcnt(0)
    s_barrier
    v_mfma_f32_32x32x16_bf16 a[0:15], v[48:51], v[32:35], a[0:15]
    v_xor_b32 v84, 0x10000, v84
    s_add_u32 m0, s17, 0
    v_xor_b32 v85, 0x10000, v85
    buffer_load_dwordx4 v68, s[4:7], s18 offen lds
    v_mfma_f32_32x32x16_bf16 a[16:31], v[52:55], v[32:35], a[16:31]
    s_add_u32 m0, s17, 1024
    v_xor_b32 v86, 0x10000, v86
    buffer_load_dwordx4 v69, s[4:7], s18 offen lds
    v_mfma_f32_32x32x16_bf16 a[32:47], v[56:59], v[32:35], a[32:47]
    v_xor_b32 v87, 0x10000, v87
    v_mfma_f32_32x32x16_bf16 a[48:63], v[60:63], v[32:35], a[48:63]
    s_add_u32 m0, s17, 2048
    v_xor_b32 v88, 0x10000, v88
    buffer_load_dwordx4 v70, s[4:7], s18 offen lds
    v_mfma_f32_32x32x16_bf16 a[64:79], v[48:51], v[36:39], a[64:79]
    v_xor_b32 v89, 0x10000, v89
    v_xor_b32 v90, 0x10000, v90
    v_mfma_f32_32x32x16_bf16 a[80:95], v[52:55], v[36:39], a[80:95]
    s_add_u32 m0, s17, 3072
    v_xor_b32 v91, 0x10000, v91
    buffer_load_dwordx4 v71, s[4:7], s18 offen lds
    v_mfma_f32_32x32x16_bf16 a[96:111], v[56:59], v[36:39], a[96:111]
    ds_read_b128 v[0:3], v84 offset:0
    v_mfma_f32_32x32x16_bf16 a[112:127], v[60:63], v[36:39], a[112:127]
    s_add_u32 m0, s17, 4096
    ds_read_b64_tr_b16 v[16:17], v88 offset:0
    buffer_load_dwordx4 v72, s[4:7], s18 offen lds
    v_mfma_f32_32x32x16_bf16 a[128:143], v[48:51], v[40:43], a[128:143]
    ds_read_b64_tr_b16 v[18:19], v88 offset:2048
    s_add_u32 m0, s17, 5120
    ds_read_b64_tr_b16 v[20:21], v89 offset:0
    buffer_load_dwordx4 v73, s[4:7], s18 offen lds
    v_mfma_f32_32x32x16_bf16 a[144:159], v[52:55], v[40:43], a[144:159]
    ds_read_b64_tr_b16 v[22:23], v89 offset:2048
    v_mfma_f32_32x32x16_bf16 a[160:175], v[56:59], v[40:43], a[160:175]
    s_add_u32 m0, s17, 6144
    ds_read_b128 v[4:7], v84 offset:4096
    buffer_load_dwordx4 v74, s[4:7], s18 offen lds
    v_mfma_f32_32x32x16_bf16 a[176:191], v[60:63], v[40:43], a[176:191]
    ds_read_b64_tr_b16 v[24:25], v90 offset:0
    v_mfma_f32_32x32x16_bf16 a[192:207], v[48:51], v[44:47], a[192:207]
    ds_read_b64_tr_b16 v[26:27], v90 offset:2048
    s_add_u32 m0, s17, 7168
    ds_read_b64_tr_b16 v[28:29], v91 offset:0
    buffer_load_dwordx4 v75, s[4:7], s18 offen lds
    v_mfma_f32_32x32x16_bf16 a[208:223], v[52:55], v[44:47], a[208:223]
    ds_read_b64_tr_b16 v[30:31], v91 offset:2048
    v_mfma_f32_32x32x16_bf16 a[224:239], v[56:59], v[44:47], a[224:239]
    ds_read_b128 v[8:11], v84 offset:8192
    s_add_u32 s18, s18, 128
    v_mfma_f32_32x32x16_bf16 a[240:255], v[60:63], v[44:47], a[240:255]
    ds_read_b128 v[12:15], v84 offset:12288
    s_sub_u32 s20, s20, 1
    s_cmp_lg_u32 s20, 0
    s_cbranch_scc1 L_proj_loop0
    s_waitcnt lgkmcnt(0)
    v_mfma_f32_32x32x16_bf16 a[0:15], v[16:19], v[0:3], a[0:15]
    s_add_u32 m0, s17, 32768
    ds_read_b128 v[32:35], v85 offset:0
    buffer_load_dwordx4 v76, s[8:11], s19 offen lds
    v_mfma_f32_32x32x16_bf16 a[16:31], v[20:23], v[0:3], a[16:31]
    s_add_u32 m0, s17, 33792
    ds_read_b64_tr_b16 v[48:49], v88 offset:8192
    buffer_load_dwordx4 v77, s[8:11], s19 offen lds
    v_mfma_f32_32x32x16_bf16 a[32:47], v[24:27], v[0:3], a[32:47]
    ds_read_b64_tr_b16 v[50:51], v88 offset:10240
    v_mfma_f32_32x32x16_bf16 a[48:63], v[28:31], v[0:3], a[48:63]
    s_add_u32 m0, s17, 34816
    ds_read_b64_tr_b16 v[52:53], v89 offset:8192
    buffer_load_dwordx4 v78, s[8:11], s19 offen lds
    v_mfma_f32_32x32x16_bf16 a[64:79], v[16:19], v[4:7], a[64:79]
    ds_read_b64_tr_b16 v[54:55], v89 offset:10240
    v_mfma_f32_32x32x16_bf16 a[80:95], v[20:23], v[4:7], a[80:95]
    s_add_u32 m0, s17, 35840
    ds_read_b128 v[36:39], v85 offset:4096
    buffer_load_dwordx4 v79, s[8:11], s19 offen lds
    v_mfma_f32_32x32x16_bf16 a[96:111], v[24:27], v[4:7], a[96:111]
    ds_read_b64_tr_b16 v[56:57], v90 offset:8192
    v_mfma_f32_32x32x16_bf16 a[112:127], v[28:31], v[4:7], a[112:127]
    s_add_u32 m0, s17, 36864
    ds_read_b64_tr_b16 v[58:59], v90 offset:10240
    buffer_load_dwordx4 v80, s[8:11], s19 offen lds
    v_mfma_f32_32x32x16_bf16 a[128:143], v[16:19], v[8:11], a[128:143]
    s_add_u32 m0, s17, 37888
    ds_read_b64_tr_b16 v[60:61], v91 offset:8192
    buffer_load_dwordx4 v81, s[8:11], s19 offen lds
    v_mfma_f32_32x32x16_bf16 a[144:159], v[20:23], v[8:11], a[144:159]
    ds_read_b64_tr_b16 v[62:63], v91 offset:10240
    v_mfma_f32_32x32x16_bf16 a[160:175], v[24:27], v[8:11], a[160:175]
    s_add_u32 m0, s17, 38912
    ds_read_b128 v[40:43], v85 offset:8192
    buffer_load_dwordx4 v82, s[8:11], s19 offen lds
    v_mfma_f32_32x32x16_bf16 a[176:191], v[28:31], v[8:11], a[176:191]
    ds_read_b128 v[44:47], v85 offset:12288
    s_add_u32 m0, s17, 39936
    v_mfma_f32_32x32x16_bf16 a[192:207], v[16:19], v[12:15], a[192:207]
    buffer_load_dwordx4 v83, s[8:11], s19 offen lds
    v_mfma_f32_32x32x16_bf16 a[208:223], v[20:23], v[12:15], a[208:223]
    v_mfma_f32_32x32x16_bf16 a[224:239], v[24:27], v[12:15], a[224:239]
    s_add_u32 s19, s19, 0x80000
    s_xor_b32 s17, s17, 0x10000
    v_mfma_f32_32x32x16_bf16 a[240:255], v[28:31], v[12:15], a[240:255]
    s_waitcnt lgkmcnt(0)
    v_mfma_f32_32x32x16_bf16 a[0:15], v[48:51], v[32:35], a[0:15]
    ds_read_b128 v[0:3], v86 offset:0
    v_mfma_f32_32x32x16_bf16 a[16:31], v[52:55], v[32:35], a[16:31]
    ds_read_b64_tr_b16 v[16:17], v88 offset:16384
    v_mfma_f32_32x32x16_bf16 a[32:47], v[56:59], v[32:35], a[32:47]
    ds_read_b64_tr_b16 v[18:19], v88 offset:18432
    v_mfma_f32_32x32x16_bf16 a[48:63], v[60:63], v[32:35], a[48:63]
    ds_read_b64_tr_b16 v[20:21], v89 offset:16384
    v_mfma_f32_32x32x16_bf16 a[64:79], v[48:51], v[36:39], a[64:79]
    ds_read_b64_tr_b16 v[22:23], v89 offset:18432
    v_mfma_f32_32x32x16_bf16 a[80:95], v[52:55], v[36:39], a[80:95]
    ds_read_b128 v[4:7], v86 offset:4096
    v_mfma_f32_32x32x16_bf16 a[96:111], v[56:59], v[36:39], a[96:111]
    ds_read_b64_tr_b16 v[24:25], v90 offset:16384
    v_mfma_f32_32x32x16_bf16 a[112:127], v[60:63], v[36:39], a[112:127]
    ds_read_b64_tr_b16 v[26:27], v90 offset:18432
    v_mfma_f32_32x32x16_bf16 a[128:143], v[48:51], v[40:43], a[128:143]
    ds_read_b64_tr_b16 v[28:29], v91 offset:16384
    v_mfma_f32_32x32x16_bf16 a[144:159], v[52:55], v[40:43], a[144:159]
    ds_read_b64_tr_b16 v[30:31], v91 offset:18432
    v_mfma_f32_32x32x16_bf16 a[160:175], v[56:59], v[40:43], a[160:175]
    ds_read_b128 v[8:11], v86 offset:8192
    v_mfma_f32_32x32x16_bf16 a[176:191], v[60:63], v[40:43], a[176:191]
    ds_read_b128 v[12:15], v86 offset:12288
    v_mfma_f32_32x32x16_bf16 a[192:207], v[48:51], v[44:47], a[192:207]
    v_mfma_f32_32x32x16_bf16 a[208:223], v[52:55], v[44:47], a[208:223]
    v_mfma_f32_32x32x16_bf16 a[224:239], v[56:59], v[44:47], a[224:239]
    v_mfma_f32_32x32x16_bf16 a[240:255], v[60:63], v[44:47], a[240:255]
    s_waitcnt lgkmcnt(0)
    v_mfma_f32_32x32x16_bf16 a[0:15], v[16:19], v[0:3], a[0:15]
    ds_read_b128 v[32:35], v87 offset:0
    v_mfma_f32_32x32x16_bf16 a[16:31], v[20:23], v[0:3], a[16:31]
    ds_read_b64_tr_b16 v[48:49], v88 offset:24576
    v_mfma_f32_32x32x16_bf16 a[32:47], v[24:27], v[0:3], a[32:47]
    ds_read_b64_tr_b16 v[50:51], v88 offset:26624
    v_mfma_f32_32x32x16_bf16 a[48:63], v[28:31], v[0:3], a[48:63]
    ds_read_b64_tr_b16 v[52:53], v89 offset:24576
    v_mfma_f32_32x32x16_bf16 a[64:79], v[16:19], v[4:7], a[64:79]
    ds_read_b64_tr_b16 v[54:55], v89 offset:26624
    v_mfma_f32_32x32x16_bf16 a[80:95], v[20:23], v[4:7], a[80:95]
    ds_read_b128 v[36:39], v87 offset:4096
    v_mfma_f32_32x32x16_bf16 a[96:111], v[24:27], v[4:7], a[96:111]
    ds_read_b64_tr_b16 v[56:57], v90 offset:24576
    v_mfma_f32_32x32x16_bf16 a[112:127], v[28:31], v[4:7], a[112:127]
    ds_read_b64_tr_b16 v[58:59], v90 offset:26624
    v_mfma_f32_32x32x16_bf16 a[128:143], v[16:19], v[8:11], a[128:143]
    ds_read_b64_tr_b16 v[60:61], v91 offset:24576
    v_mfma_f32_32x32x16_bf16 a[144:159], v[20:23], v[8:11], a[144:159]
    ds_read_b64_tr_b16 v[62:63], v91 offset:26624
    v_mfma_f32_32x32x16_bf16 a[160:175], v[24:27], v[8:11], a[160:175]
    ds_read_b128 v[40:43], v87 offset:8192
    v_mfma_f32_32x32x16_bf16 a[176:191], v[28:31], v[8:11], a[176:191]
    ds_read_b128 v[44:47], v87 offset:12288
    v_mfma_f32_32x32x16_bf16 a[192:207], v[16:19], v[12:15], a[192:207]
    v_mfma_f32_32x32x16_bf16 a[208:223], v[20:23], v[12:15], a[208:223]
    v_mfma_f32_32x32x16_bf16 a[224:239], v[24:27], v[12:15], a[224:239]
    v_mfma_f32_32x32x16_bf16 a[240:255], v[28:31], v[12:15], a[240:255]
    s_waitcnt lgkmcnt(0)
    s_waitcnt vmcnt(0)
    s_barrier
    v_mfma_f32_32x32x16_bf16 a[0:15], v[48:51], v[32:35], a[0:15]
    v_xor_b32 v84, 0x10000, v84
    s_add_u32 m0, s45, 0
    v_xor_b32 v85, 0x10000, v85
    buffer_load_dwordx4 v92, s[48:51], s29 offen lds
    v_mfma_f32_32x32x16_bf16 a[16:31], v[52:55], v[32:35], a[16:31]
    s_add_u32 m0, s45, 1024
    v_xor_b32 v86, 0x10000, v86
    buffer_load_dwordx4 v93, s[48:51], s29 offen lds
    v_mfma_f32_32x32x16_bf16 a[32:47], v[56:59], v[32:35], a[32:47]
    v_xor_b32 v87, 0x10000, v87
    v_mfma_f32_32x32x16_bf16 a[48:63], v[60:63], v[32:35], a[48:63]
    s_add_u32 m0, s45, 2048
    v_xor_b32 v88, 0x10000, v88
    buffer_load_dwordx4 v94, s[48:51], s29 offen lds
    v_mfma_f32_32x32x16_bf16 a[64:79], v[48:51], v[36:39], a[64:79]
    v_xor_b32 v89, 0x10000, v89
    v_xor_b32 v90, 0x10000, v90
    v_mfma_f32_32x32x16_bf16 a[80:95], v[52:55], v[36:39], a[80:95]
    s_add_u32 m0, s45, 3072
    v_xor_b32 v91, 0x10000, v91
    buffer_load_dwordx4 v95, s[48:51], s29 offen lds
    v_mfma_f32_32x32x16_bf16 a[96:111], v[56:59], v[36:39], a[96:111]
    ds_read_b128 v[0:3], v84 offset:0
    v_mfma_f32_32x32x16_bf16 a[112:127], v[60:63], v[36:39], a[112:127]
    s_add_u32 m0, s45, 4096
    ds_read_b64_tr_b16 v[16:17], v88 offset:0
    buffer_load_dwordx4 v96, s[48:51], s29 offen lds
    v_mfma_f32_32x32x16_bf16 a[128:143], v[48:51], v[40:43], a[128:143]
    ds_read_b64_tr_b16 v[18:19], v88 offset:2048
    s_add_u32 m0, s45, 5120
    ds_read_b64_tr_b16 v[20:21], v89 offset:0
    buffer_load_dwordx4 v97, s[48:51], s29 offen lds
    v_mfma_f32_32x32x16_bf16 a[144:159], v[52:55], v[40:43], a[144:159]
    ds_read_b64_tr_b16 v[22:23], v89 offset:2048
    v_mfma_f32_32x32x16_bf16 a[160:175], v[56:59], v[40:43], a[160:175]
    s_add_u32 m0, s45, 6144
    ds_read_b128 v[4:7], v84 offset:4096
    buffer_load_dwordx4 v98, s[48:51], s29 offen lds
    v_mfma_f32_32x32x16_bf16 a[176:191], v[60:63], v[40:43], a[176:191]
    ds_read_b64_tr_b16 v[24:25], v90 offset:0
    v_mfma_f32_32x32x16_bf16 a[192:207], v[48:51], v[44:47], a[192:207]
    ds_read_b64_tr_b16 v[26:27], v90 offset:2048
    s_add_u32 m0, s45, 7168
    ds_read_b64_tr_b16 v[28:29], v91 offset:0
    buffer_load_dwordx4 v99, s[48:51], s29 offen lds
    v_mfma_f32_32x32x16_bf16 a[208:223], v[52:55], v[44:47], a[208:223]
    ds_read_b64_tr_b16 v[30:31], v91 offset:2048
    v_mfma_f32_32x32x16_bf16 a[224:239], v[56:59], v[44:47], a[224:239]
    ds_read_b128 v[8:11], v84 offset:8192
    s_add_u32 s29, s29, 128
    v_mfma_f32_32x32x16_bf16 a[240:255], v[60:63], v[44:47], a[240:255]
    ds_read_b128 v[12:15], v84 offset:12288
    s_waitcnt lgkmcnt(0)
    v_mfma_f32_32x32x16_bf16 a[0:15], v[16:19], v[0:3], a[0:15]
    s_add_u32 m0, s28, 32768
    ds_read_b128 v[32:35], v85 offset:0
    buffer_load_dwordx4 v100, s[52:55], s30 offen lds
    v_mfma_f32_32x32x16_bf16 a[16:31], v[20:23], v[0:3], a[16:31]
    ds_read_b64_tr_b16 v[48:49], v88 offset:8192
    v_mfma_f32_32x32x16_bf16 a[32:47], v[24:27], v[0:3], a[32:47]
    ds_read_b64_tr_b16 v[50:51], v88 offset:10240
    v_mfma_f32_32x32x16_bf16 a[48:63], v[28:31], v[0:3], a[48:63]
    s_add_u32 m0, s28, 33792
    ds_read_b64_tr_b16 v[52:53], v89 offset:8192
    buffer_load_dwordx4 v101, s[52:55], s30 offen lds
    v_mfma_f32_32x32x16_bf16 a[64:79], v[16:19], v[4:7], a[64:79]
    ds_read_b64_tr_b16 v[54:55], v89 offset:10240
    v_mfma_f32_32x32x16_bf16 a[80:95], v[20:23], v[4:7], a[80:95]
    ds_read_b128 v[36:39], v85 offset:4096
    v_mfma_f32_32x32x16_bf16 a[96:111], v[24:27], v[4:7], a[96:111]
    s_add_u32 m0, s28, 34816
    ds_read_b64_tr_b16 v[56:57], v90 offset:8192
    buffer_load_dwordx4 v102, s[52:55], s30 offen lds
    v_mfma_f32_32x32x16_bf16 a[112:127], v[28:31], v[4:7], a[112:127]
    ds_read_b64_tr_b16 v[58:59], v90 offset:10240
    v_mfma_f32_32x32x16_bf16 a[128:143], v[16:19], v[8:11], a[128:143]
    ds_read_b64_tr_b16 v[60:61], v91 offset:8192
    v_mfma_f32_32x32x16_bf16 a[144:159], v[20:23], v[8:11], a[144:159]
    s_add_u32 m0, s28, 35840
    ds_read_b64_tr_b16 v[62:63], v91 offset:10240
    buffer_load_dwordx4 v103, s[52:55], s30 offen lds
    v_mfma_f32_32x32x16_bf16 a[160:175], v[24:27], v[8:11], a[160:175]
    ds_read_b128 v[40:43], v85 offset:8192
    v_mfma_f32_32x32x16_bf16 a[176:191], v[28:31], v[8:11], a[176:191]
    ds_read_b128 v[44:47], v85 offset:12288
    v_mfma_f32_32x32x16_bf16 a[192:207], v[16:19], v[12:15], a[192:207]
    s_add_u32 s30, s30, 0x80000
    v_mfma_f32_32x32x16_bf16 a[208:223], v[20:23], v[12:15], a[208:223]
    v_mfma_f32_32x32x16_bf16 a[224:239], v[24:27], v[12:15], a[224:239]
    v_mfma_f32_32x32x16_bf16 a[240:255], v[28:31], v[12:15], a[240:255]
    s_waitcnt lgkmcnt(0)
    v_mfma_f32_32x32x16_bf16 a[0:15], v[48:51], v[32:35], a[0:15]
    ds_read_b128 v[0:3], v86 offset:0
    v_mfma_f32_32x32x16_bf16 a[16:31], v[52:55], v[32:35], a[16:31]
    ds_read_b64_tr_b16 v[16:17], v88 offset:16384
    v_mfma_f32_32x32x16_bf16 a[32:47], v[56:59], v[32:35], a[32:47]
    ds_read_b64_tr_b16 v[18:19], v88 offset:18432
    v_mfma_f32_32x32x16_bf16 a[48:63], v[60:63], v[32:35], a[48:63]
    ds_read_b64_tr_b16 v[20:21], v89 offset:16384
    v_mfma_f32_32x32x16_bf16 a[64:79], v[48:51], v[36:39], a[64:79]
    ds_read_b64_tr_b16 v[22:23], v89 offset:18432
    v_mfma_f32_32x32x16_bf16 a[80:95], v[52:55], v[36:39], a[80:95]
    ds_read_b128 v[4:7], v86 offset:4096
    v_mfma_f32_32x32x16_bf16 a[96:111], v[56:59], v[36:39], a[96:111]
    ds_read_b64_tr_b16 v[24:25], v90 offset:16384
    v_mfma_f32_32x32x16_bf16 a[112:127], v[60:63], v[36:39], a[112:127]
    ds_read_b64_tr_b16 v[26:27], v90 offset:18432
    v_mfma_f32_32x32x16_bf16 a[128:143], v[48:51], v[40:43], a[128:143]
    ds_read_b64_tr_b16 v[28:29], v91 offset:16384
    v_mfma_f32_32x32x16_bf16 a[144:159], v[52:55], v[40:43], a[144:159]
    ds_read_b64_tr_b16 v[30:31], v91 offset:18432
    v_mfma_f32_32x32x16_bf16 a[160:175], v[56:59], v[40:43], a[160:175]
    ds_read_b128 v[8:11], v86 offset:8192
    v_mfma_f32_32x32x16_bf16 a[176:191], v[60:63], v[40:43], a[176:191]
    ds_read_b128 v[12:15], v86 offset:12288
    v_mfma_f32_32x32x16_bf16 a[192:207], v[48:51], v[44:47], a[192:207]
    v_mfma_f32_32x32x16_bf16 a[208:223], v[52:55], v[44:47], a[208:223]
    v_mfma_f32_32x32x16_bf16 a[224:239], v[56:59], v[44:47], a[224:239]
    v_mfma_f32_32x32x16_bf16 a[240:255], v[60:63], v[44:47], a[240:255]
    s_waitcnt lgkmcnt(0)
    v_mfma_f32_32x32x16_bf16 a[0:15], v[16:19], v[0:3], a[0:15]
    ds_read_b128 v[32:35], v87 offset:0
    v_mfma_f32_32x32x16_bf16 a[16:31], v[20:23], v[0:3], a[16:31]
    ds_read_b64_tr_b16 v[48:49], v88 offset:24576
    v_mfma_f32_32x32x16_bf16 a[32:47], v[24:27], v[0:3], a[32:47]
    ds_read_b64_tr_b16 v[50:51], v88 offset:26624
    v_mfma_f32_32x32x16_bf16 a[48:63], v[28:31], v[0:3], a[48:63]
    ds_read_b64_tr_b16 v[52:53], v89 offset:24576
    v_mfma_f32_32x32x16_bf16 a[64:79], v[16:19], v[4:7], a[64:79]
    ds_read_b64_tr_b16 v[54:55], v89 offset:26624
    v_mfma_f32_32x32x16_bf16 a[80:95], v[20:23], v[4:7], a[80:95]
    ds_read_b128 v[36:39], v87 offset:4096
    v_mfma_f32_32x32x16_bf16 a[96:111], v[24:27], v[4:7], a[96:111]
    ds_read_b64_tr_b16 v[56:57], v90 offset:24576
    v_mfma_f32_32x32x16_bf16 a[112:127], v[28:31], v[4:7], a[112:127]
    ds_read_b64_tr_b16 v[58:59], v90 offset:26624
    v_mfma_f32_32x32x16_bf16 a[128:143], v[16:19], v[8:11], a[128:143]
    ds_read_b64_tr_b16 v[60:61], v91 offset:24576
    v_mfma_f32_32x32x16_bf16 a[144:159], v[20:23], v[8:11], a[144:159]
    ds_read_b64_tr_b16 v[62:63], v91 offset:26624
    v_mfma_f32_32x32x16_bf16 a[160:175], v[24:27], v[8:11], a[160:175]
    ds_read_b128 v[40:43], v87 offset:8192
    v_mfma_f32_32x32x16_bf16 a[176:191], v[28:31], v[8:11], a[176:191]
    ds_read_b128 v[44:47], v87 offset:12288
    v_mfma_f32_32x32x16_bf16 a[192:207], v[16:19], v[12:15], a[192:207]
    v_mfma_f32_32x32x16_bf16 a[208:223], v[20:23], v[12:15], a[208:223]
    v_mfma_f32_32x32x16_bf16 a[224:239], v[24:27], v[12:15], a[224:239]
    v_mfma_f32_32x32x16_bf16 a[240:255], v[28:31], v[12:15], a[240:255]
    s_waitcnt lgkmcnt(0)
    s_waitcnt vmcnt(0)
    s_barrier
    v_mfma_f32_32x32x16_bf16 a[0:15], v[48:51], v[32:35], a[0:15]
    s_add_u32 m0, s45, 49152
    v_xor_b32 v84, 0x10000, v84
    buffer_load_dwordx4 v92, s[48:51], s29 offen lds
    v_mfma_f32_32x32x16_bf16 a[16:31], v[52:55], v[32:35], a[16:31]
    s_add_u32 m0, s45, 50176
    v_xor_b32 v85, 0x10000, v85
    buffer_load_dwordx4 v93, s[48:51], s29 offen lds
    v_mfma_f32_32x32x16_bf16 a[32:47], v[56:59], v[32:35], a[32:47]
    s_add_u32 m0, s45, 51200
    v_xor_b32 v86, 0x10000, v86
    buffer_load_dwordx4 v94, s[48:51], s29 offen lds
    v_mfma_f32_32x32x16_bf16 a[48:63], v[60:63], v[32:35], a[48:63]
    s_add_u32 m0, s45, 52224
    v_xor_b32 v87, 0x10000, v87
    buffer_load_dwordx4 v95, s[48:51], s29 offen lds
    v_mfma_f32_32x32x16_bf16 a[64:79], v[48:51], v[36:39], a[64:79]
    s_add_u32 m0, s45, 53248
    ds_read_b128 v[0:3], v84 offset:0
    buffer_load_dwordx4 v96, s[48:51], s29 offen lds
    v_mfma_f32_32x32x16_bf16 a[80:95], v[52:55], v[36:39], a[80:95]
    s_add_u32 m0, s45, 54272
    ds_read_b64_tr_b16 v[16:17], v104 offset:0
    buffer_load_dwordx4 v97, s[48:51], s29 offen lds
    v_mfma_f32_32x32x16_bf16 a[96:111], v[56:59], v[36:39], a[96:111]
    s_add_u32 m0, s45, 55296
    ds_read_b64_tr_b16 v[18:19], v104 offset:1024
    buffer_load_dwordx4 v98, s[48:51], s29 offen lds
    v_mfma_f32_32x32x16_bf16 a[112:127], v[60:63], v[36:39], a[112:127]
    ds_read_b64_tr_b16 v[20:21], v105 offset:0
    v_mfma_f32_32x32x16_bf16 a[128:143], v[48:51], v[40:43], a[128:143]
    s_add_u32 m0, s45, 56320
    ds_read_b64_tr_b16 v[22:23], v105 offset:1024
    buffer_load_dwordx4 v99, s[48:51], s29 offen lds
    v_mfma_f32_32x32x16_bf16 a[144:159], v[52:55], v[40:43], a[144:159]
    ds_read_b128 v[4:7], v84 offset:4096
    s_add_u32 s29, s29, 128
    v_mfma_f32_32x32x16_bf16 a[160:175], v[56:59], v[40:43], a[160:175]
    s_add_u32 m0, s28, 81920
    ds_read_b128 v[8:11], v84 offset:8192
    buffer_load_dwordx4 v100, s[52:55], s30 offen lds
    v_mfma_f32_32x32x16_bf16 a[176:191], v[60:63], v[40:43], a[176:191]
    s_add_u32 m0, s28, 82944
    ds_read_b128 v[12:15], v84 offset:12288
    buffer_load_dwordx4 v101, s[52:55], s30 offen lds
    s_add_u32 m0, s28, 83968
    v_mfma_f32_32x32x16_bf16 a[192:207], v[48:51], v[44:47], a[192:207]
    buffer_load_dwordx4 v102, s[52:55], s30 offen lds
    s_add_u32 m0, s28, 84992
    v_mfma_f32_32x32x16_bf16 a[208:223], v[52:55], v[44:47], a[208:223]
    buffer_load_dwordx4 v103, s[52:55], s30 offen lds
    v_mfma_f32_32x32x16_bf16 a[224:239], v[56:59], v[44:47], a[224:239]
    s_add_u32 s30, s30, 0x80000
    v_mfma_f32_32x32x16_bf16 a[240:255], v[60:63], v[44:47], a[240:255]
    s_waitcnt lgkmcnt(0)
    v_mfma_f32_32x32x16_bf16 v[128:143], v[16:19], v[0:3], 0
    s_add_u32 m0, s45, 98304
    ds_read_b128 v[32:35], v85 offset:0
    buffer_load_dwordx4 v92, s[48:51], s29 offen lds
    s_add_u32 m0, s45, 99328
    s_nop 0
    buffer_load_dwordx4 v93, s[48:51], s29 offen lds
    s_and_b32 s25, s16, 1
    s_lshr_b32 s26, s16, 1
    s_lshl_b32 s25, s25, 7
    v_mfma_f32_32x32x16_bf16 v[144:159], v[20:23], v[0:3], 0
    s_add_u32 m0, s45, 100352
    ds_read_b64_tr_b16 v[48:49], v104 offset:4096
    buffer_load_dwordx4 v94, s[48:51], s29 offen lds
    s_lshl_b32 s26, s26, 7
    s_add_u32 s25, s25, s22
    s_add_u32 s26, s26, s23
    v_mfma_f32_32x32x16_bf16 v[160:175], v[16:19], v[4:7], 0
    s_add_u32 m0, s45, 101376
    ds_read_b64_tr_b16 v[50:51], v104 offset:5120
    buffer_load_dwordx4 v95, s[48:51], s29 offen lds
    s_add_u32 s31, s28, 147456
    v_and_b32 v88, 7, v66
    v_lshlrev_b32 v88, 4, v88
    v_mfma_f32_32x32x16_bf16 v[176:191], v[20:23], v[4:7], 0
    s_add_u32 m0, s45, 102400
    ds_read_b64_tr_b16 v[52:53], v105 offset:4096
    buffer_load_dwordx4 v96, s[48:51], s29 offen lds
    v_lshl_add_u32 v88, v66, 7, v88
    v_lshl_add_u32 v88, v65, 3, v88
    v_add_u32 v88, s31, v88
    v_mfma_f32_32x32x16_bf16 v[192:207], v[16:19], v[8:11], 0
    s_add_u32 m0, s45, 103424
    ds_read_b64_tr_b16 v[54:55], v105 offset:5120
    buffer_load_dwordx4 v97, s[48:51], s29 offen lds
    v_lshrrev_b32 v89, 3, v64
    v_and_b32 v90, 7, v64
    v_xor_b32 v91, v89, v90
    v_mfma_f32_32x32x16_bf16 v[208:223], v[20:23], v[8:11], 0
    s_add_u32 m0, s45, 104448
    ds_read_b128 v[36:39], v85 offset:4096
    buffer_load_dwordx4 v98, s[48:51], s29 offen lds
    v_lshlrev_b32 v91, 4, v91
    v_lshl_add_u32 v91, v89, 7, v91
    v_add_u32 v89, s25, v89
    v_mfma_f32_32x32x16_bf16 v[224:239], v[16:19], v[12:15], 0
    s_add_u32 m0, s45, 105472
    ds_read_b128 v[40:43], v85 offset:8192
    buffer_load_dwordx4 v99, s[48:51], s29 offen lds
    v_lshlrev_b32 v89, 13, v89
    v_lshl_add_u32 v90, v90, 4, v89
    s_lshl_b32 s26, s26, 1
    v_mfma_f32_32x32x16_bf16 v[240:255], v[20:23], v[12:15], 0
    ds_read_b128 v[44:47], v85 offset:12288
    s_add_u32 s29, s29, 128
    v_add_u32 v90, s26, v90
    v_add_u32 v89, s31, v91
    s_waitcnt lgkmcnt(0)
    v_mfma_f32_32x32x16_bf16 v[128:143], v[48:51], v[32:35], v[128:143]
    s_add_u32 m0, s28, 131072
    ds_read_b128 v[0:3], v86 offset:0
    buffer_load_dwordx4 v100, s[52:55], s30 offen lds
    v_accvgpr_read_b32 v68, a0
    v_accvgpr_read_b32 v69, a1
    v_accvgpr_read_b32 v70, a2
    v_accvgpr_read_b32 v71, a3
    v_mfma_f32_32x32x16_bf16 v[144:159], v[52:55], v[32:35], v[144:159]
    s_add_u32 m0, s28, 132096
    ds_read_b64_tr_b16 v[16:17], v104 offset:8192
    buffer_load_dwordx4 v101, s[52:55], s30 offen lds
    v_cvt_pk_bf16_f32 v72, v68, v69
    v_cvt_pk_bf16_f32 v73, v70, v71
    v_xor_b32 v68, 0, v88
    ds_write_b64 v68, v[72:73]
    v_mfma_f32_32x32x16_bf16 v[160:175], v[48:51], v[36:39], v[160:175]
    ds_read_b64_tr_b16 v[18:19], v104 offset:9216
    v_accvgpr_read_b32 v74, a4
    v_accvgpr_read_b32 v75, a5
    v_accvgpr_read_b32 v76, a6
    v_accvgpr_read_b32 v77, a7
    v_mfma_f32_32x32x16_bf16 v[176:191], v[52:55], v[36:39], v[176:191]
    s_add_u32 m0, s28, 133120
    ds_read_b64_tr_b16 v[20:21], v105 offset:8192
    buffer_load_dwordx4 v102, s[52:55], s30 offen lds
    v_cvt_pk_bf16_f32 v78, v74, v75
    v_cvt_pk_bf16_f32 v79, v76, v77
    v_xor_b32 v74, 16, v88
    ds_write_b64 v74, v[78:79]
    v_mfma_f32_32x32x16_bf16 v[192:207], v[48:51], v[40:43], v[192:207]
    s_add_u32 m0, s28, 134144
    ds_read_b64_tr_b16 v[22:23], v105 offset:9216
    buffer_load_dwordx4 v103, s[52:55], s30 offen lds
    v_accvgpr_read_b32 v122, a8
    v_accvgpr_read_b32 v123, a9
    v_accvgpr_read_b32 v124, a10
    v_accvgpr_read_b32 v125, a11
    v_mfma_f32_32x32x16_bf16 v[208:223], v[52:55], v[40:43], v[208:223]
    ds_read_b128 v[4:7], v86 offset:4096
    v_cvt_pk_bf16_f32 v126, v122, v123
    v_cvt_pk_bf16_f32 v127, v124, v125
    v_xor_b32 v122, 32, v88
    ds_write_b64 v122, v[126:127]
    v_mfma_f32_32x32x16_bf16 v[224:239], v[48:51], v[44:47], v[224:239]
    ds_read_b128 v[8:11], v86 offset:8192
    s_add_u32 s30, s30, 0x80000
    v_accvgpr_read_b32 v68, a12
    v_accvgpr_read_b32 v69, a13
    v_accvgpr_read_b32 v70, a14
    v_accvgpr_read_b32 v71, a15
    v_mfma_f32_32x32x16_bf16 v[240:255], v[52:55], v[44:47], v[240:255]
    ds_read_b128 v[12:15], v86 offset:12288
    v_cvt_pk_bf16_f32 v72, v68, v69
    v_cvt_pk_bf16_f32 v73, v70, v71
    v_xor_b32 v68, 48, v88
    ds_write_b64 v68, v[72:73]
    s_waitcnt lgkmcnt(0)
    v_mfma_f32_32x32x16_bf16 v[128:143], v[16:19], v[0:3], v[128:143]
    ds_read_b128 v[32:35], v87 offset:0
    v_accvgpr_read_b32 v74, a16
    v_accvgpr_read_b32 v75, a17
    v_accvgpr_read_b32 v76, a18
    v_accvgpr_read_b32 v77, a19
    v_mfma_f32_32x32x16_bf16 v[144:159], v[20:23], v[0:3], v[144:159]
    ds_read_b64_tr_b16 v[48:49], v104 offset:12288
    v_cvt_pk_bf16_f32 v78, v74, v75
    v_cvt_pk_bf16_f32 v79, v76, v77
    v_xor_b32 v74, 64, v88
    ds_write_b64 v74, v[78:79]
    v_mfma_f32_32x32x16_bf16 v[160:175], v[16:19], v[4:7], v[160:175]
    ds_read_b64_tr_b16 v[50:51], v104 offset:13312
    v_accvgpr_read_b32 v122, a20
    v_accvgpr_read_b32 v123, a21
    v_accvgpr_read_b32 v124, a22
    v_accvgpr_read_b32 v125, a23
    v_mfma_f32_32x32x16_bf16 v[176:191], v[20:23], v[4:7], v[176:191]
    ds_read_b64_tr_b16 v[52:53], v105 offset:12288
    v_cvt_pk_bf16_f32 v126, v122, v123
    v_cvt_pk_bf16_f32 v127, v124, v125
    v_xor_b32 v122, 80, v88
    ds_write_b64 v122, v[126:127]
    v_mfma_f32_32x32x16_bf16 v[192:207], v[16:19], v[8:11], v[192:207]
    ds_read_b64_tr_b16 v[54:55], v105 offset:13312
    v_accvgpr_read_b32 v68, a24
    v_accvgpr_read_b32 v69, a25
    v_accvgpr_read_b32 v70, a26
    v_accvgpr_read_b32 v71, a27
    v_mfma_f32_32x32x16_bf16 v[208:223], v[20:23], v[8:11], v[208:223]
    ds_read_b128 v[36:39], v87 offset:4096
    v_cvt_pk_bf16_f32 v72, v68, v69
    v_cvt_pk_bf16_f32 v73, v70, v71
    v_xor_b32 v68, 96, v88
    ds_write_b64 v68, v[72:73]
    v_mfma_f32_32x32x16_bf16 v[224:239], v[16:19], v[12:15], v[224:239]
    ds_read_b128 v[40:43], v87 offset:8192
    v_accvgpr_read_b32 v74, a28
    v_accvgpr_read_b32 v75, a29
    v_accvgpr_read_b32 v76, a30
    v_accvgpr_read_b32 v77, a31
    v_mfma_f32_32x32x16_bf16 v[240:255], v[20:23], v[12:15], v[240:255]
    ds_read_b128 v[44:47], v87 offset:12288
    v_cvt_pk_bf16_f32 v78, v74, v75
    v_cvt_pk_bf16_f32 v79, v76, v77
    v_xor_b32 v74, 112, v88
    ds_write_b64 v74, v[78:79]
    s_waitcnt lgkmcnt(0)
    s_waitcnt vmcnt(12)
    s_barrier
    v_mfma_f32_32x32x16_bf16 v[128:143], v[48:51], v[32:35], v[128:143]
    v_add_u32 v84, 0xc000, v84
    s_add_u32 m0, s45, 0
    v_add_u32 v85, 0xc000, v85
    buffer_load_dwordx4 v92, s[48:51], s29 offen lds
    s_add_u32 m0, s45, 1024
    s_nop 0
    buffer_load_dwordx4 v93, s[48:51], s29 offen lds
    ds_read_b128 v[106:109], v89 offset:0
    v_mfma_f32_32x32x16_bf16 v[144:159], v[52:55], v[32:35], v[144:159]
    v_add_u32 v86, 0xc000, v86
    s_add_u32 m0, s45, 2048
    v_add_u32 v87, 0xc000, v87
    buffer_load_dwordx4 v94, s[48:51], s29 offen lds
    v_mfma_f32_32x32x16_bf16 v[160:175], v[48:51], v[36:39], v[160:175]
    v_add_u32 v104, 0xc000, v104
    s_add_u32 m0, s45, 3072
    v_add_u32 v105, 0xc000, v105
    buffer_load_dwordx4 v95, s[48:51], s29 offen lds
    ds_read_b128 v[110:113], v89 offset:1024
    v_mfma_f32_32x32x16_bf16 v[176:191], v[52:55], v[36:39], v[176:191]
    s_add_u32 m0, s45, 4096
    ds_read_b128 v[0:3], v84 offset:0
    buffer_load_dwordx4 v96, s[48:51], s29 offen lds
    v_mfma_f32_32x32x16_bf16 v[192:207], v[48:51], v[40:43], v[192:207]
    ds_read_b64_tr_b16 v[16:17], v104 offset:0
    s_add_u32 m0, s45, 5120
    ds_read_b64_tr_b16 v[18:19], v104 offset:1024
    buffer_load_dwordx4 v97, s[48:51], s29 offen lds
    ds_read_b128 v[114:117], v89 offset:2048
    v_mfma_f32_32x32x16_bf16 v[208:223], v[52:55], v[40:43], v[208:223]
    ds_read_b64_tr_b16 v[20:21], v105 offset:0
    s_add_u32 m0, s45, 6144
    ds_read_b64_tr_b16 v[22:23], v105 offset:1024
    buffer_load_dwordx4 v98, s[48:51], s29 offen lds
    v_mfma_f32_32x32x16_bf16 v[224:239], v[48:51], v[44:47], v[224:239]
    ds_read_b128 v[4:7], v84 offset:4096
    s_add_u32 m0, s45, 7168
    ds_read_b128 v[8:11], v84 offset:8192
    buffer_load_dwordx4 v99, s[48:51], s29 offen lds
    ds_read_b128 v[118:121], v89 offset:3072
    v_mfma_f32_32x32x16_bf16 v[240:255], v[52:55], v[44:47], v[240:255]
    ds_read_b128 v[12:15], v84 offset:12288
    s_add_u32 s29, s29, 128
    s_waitcnt lgkmcnt(0)
    v_mfma_f32_32x32x16_bf16 v[128:143], v[16:19], v[0:3], v[128:143]
    s_add_u32 m0, s28, 32768
    ds_read_b128 v[32:35], v85 offset:0
    buffer_load_dwordx4 v100, s[52:55], s30 offen lds
    s_mov_b32 s20, 0
    buffer_store_dwordx4 v[106:109], v90, s[12:15], s20 offen sc1
    s_mov_b32 s20, 65536
    buffer_store_dwordx4 v[110:113], v90, s[12:15], s20 offen sc1
    s_mov_b32 s20, 131072
    v_mfma_f32_32x32x16_bf16 v[144:159], v[20:23], v[0:3], v[144:159]
    s_add_u32 m0, s28, 33792
    ds_read_b64_tr_b16 v[48:49], v104 offset:4096
    buffer_load_dwordx4 v101, s[52:55], s30 offen lds
    buffer_store_dwordx4 v[114:117], v90, s[12:15], s20 offen sc1
    s_mov_b32 s20, 196608
    buffer_store_dwordx4 v[118:121], v90, s[12:15], s20 offen sc1
    v_accvgpr_read_b32 v122, a32
    v_accvgpr_read_b32 v123, a33
    v_mfma_f32_32x32x16_bf16 v[160:175], v[16:19], v[4:7], v[160:175]
    ds_read_b64_tr_b16 v[50:51], v104 offset:5120
    v_accvgpr_read_b32 v124, a34
    v_accvgpr_read_b32 v125, a35
    v_cvt_pk_bf16_f32 v126, v122, v123
    v_cvt_pk_bf16_f32 v127, v124, v125
    v_xor_b32 v122, 0, v88
    v_mfma_f32_32x32x16_bf16 v[176:191], v[20:23], v[4:7], v[176:191]
    s_add_u32 m0, s28, 34816
    ds_read_b64_tr_b16 v[52:53], v105 offset:4096
    buffer_load_dwordx4 v102, s[52:55], s30 offen lds
    ds_write_b64 v122, v[126:127]
    v_accvgpr_read_b32 v68, a36
    v_accvgpr_read_b32 v69, a37
    v_accvgpr_read_b32 v70, a38
    v_accvgpr_read_b32 v71, a39
    v_mfma_f32_32x32x16_bf16 v[192:207], v[16:19], v[8:11], v[192:207]
    s_add_u32 m0, s28, 35840
    ds_read_b64_tr_b16 v[54:55], v105 offset:5120
    buffer_load_dwordx4 v103, s[52:55], s30 offen lds
    v_cvt_pk_bf16_f32 v72, v68, v69
    v_cvt_pk_bf16_f32 v73, v70, v71
    v_xor_b32 v68, 16, v88
    ds_write_b64 v68, v[72:73]
    v_accvgpr_read_b32 v74, a40
    v_mfma_f32_32x32x16_bf16 v[208:223], v[20:23], v[8:11], v[208:223]
    ds_read_b128 v[36:39], v85 offset:4096
    v_accvgpr_read_b32 v75, a41
    v_accvgpr_read_b32 v76, a42
    v_accvgpr_read_b32 v77, a43
    v_cvt_pk_bf16_f32 v78, v74, v75
    v_cvt_pk_bf16_f32 v79, v76, v77
    v_mfma_f32_32x32x16_bf16 v[224:239], v[16:19], v[12:15], v[224:239]
    ds_read_b128 v[40:43], v85 offset:8192
    s_add_u32 s30, s30, 0x80000
    v_xor_b32 v74, 32, v88
    ds_write_b64 v74, v[78:79]
    v_accvgpr_read_b32 v122, a44
    v_accvgpr_read_b32 v123, a45
    v_accvgpr_read_b32 v124, a46
    v_mfma_f32_32x32x16_bf16 v[240:255], v[20:23], v[12:15], v[240:255]
    ds_read_b128 v[44:47], v85 offset:12288
    v_accvgpr_read_b32 v125, a47
    v_cvt_pk_bf16_f32 v126, v122, v123
    v_cvt_pk_bf16_f32 v127, v124, v125
    v_xor_b32 v122, 48, v88
    ds_write_b64 v122, v[126:127]
    s_waitcnt lgkmcnt(0)
    v_mfma_f32_32x32x16_bf16 v[128:143], v[48:51], v[32:35], v[128:143]
    ds_read_b128 v[0:3], v86 offset:0
    v_accvgpr_read_b32 v68, a48
    v_accvgpr_read_b32 v69, a49
    v_accvgpr_read_b32 v70, a50
    v_accvgpr_read_b32 v71, a51
    v_mfma_f32_32x32x16_bf16 v[144:159], v[52:55], v[32:35], v[144:159]
    ds_read_b64_tr_b16 v[16:17], v104 offset:8192
    v_cvt_pk_bf16_f32 v72, v68, v69
    v_cvt_pk_bf16_f32 v73, v70, v71
    v_xor_b32 v68, 64, v88
    ds_write_b64 v68, v[72:73]
    v_mfma_f32_32x32x16_bf16 v[160:175], v[48:51], v[36:39], v[160:175]
    ds_read_b64_tr_b16 v[18:19], v104 offset:9216
    v_accvgpr_read_b32 v74, a52
    v_accvgpr_read_b32 v75, a53
    v_accvgpr_read_b32 v76, a54
    v_accvgpr_read_b32 v77, a55
    v_mfma_f32_32x32x16_bf16 v[176:191], v[52:55], v[36:39], v[176:191]
    ds_read_b64_tr_b16 v[20:21], v105 offset:8192
    v_cvt_pk_bf16_f32 v78, v74, v75
    v_cvt_pk_bf16_f32 v79, v76, v77
    v_xor_b32 v74, 80, v88
    ds_write_b64 v74, v[78:79]
    v_mfma_f32_32x32x16_bf16 v[192:207], v[48:51], v[40:43], v[192:207]
    ds_read_b64_tr_b16 v[22:23], v105 offset:9216
    v_accvgpr_read_b32 v122, a56
    v_accvgpr_read_b32 v123, a57
    v_accvgpr_read_b32 v124, a58
    v_accvgpr_read_b32 v125, a59
    v_mfma_f32_32x32x16_bf16 v[208:223], v[52:55], v[40:43], v[208:223]
    ds_read_b128 v[4:7], v86 offset:4096
    v_cvt_pk_bf16_f32 v126, v122, v123
    v_cvt_pk_bf16_f32 v127, v124, v125
    v_xor_b32 v122, 96, v88
    ds_write_b64 v122, v[126:127]
    v_mfma_f32_32x32x16_bf16 v[224:239], v[48:51], v[44:47], v[224:239]
    ds_read_b128 v[8:11], v86 offset:8192
    v_accvgpr_read_b32 v68, a60
    v_accvgpr_read_b32 v69, a61
    v_accvgpr_read_b32 v70, a62
    v_accvgpr_read_b32 v71, a63
    v_mfma_f32_32x32x16_bf16 v[240:255], v[52:55], v[44:47], v[240:255]
    ds_read_b128 v[12:15], v86 offset:12288
    v_cvt_pk_bf16_f32 v72, v68, v69
    v_cvt_pk_bf16_f32 v73, v70, v71
    v_xor_b32 v68, 112, v88
    ds_write_b64 v68, v[72:73]
    s_waitcnt lgkmcnt(0)
    v_mfma_f32_32x32x16_bf16 v[128:143], v[16:19], v[0:3], v[128:143]
    ds_read_b128 v[32:35], v87 offset:0
    ds_read_b128 v[106:109], v89 offset:0
    v_mfma_f32_32x32x16_bf16 v[144:159], v[20:23], v[0:3], v[144:159]
    ds_read_b64_tr_b16 v[48:49], v104 offset:12288
    v_mfma_f32_32x32x16_bf16 v[160:175], v[16:19], v[4:7], v[160:175]
    ds_read_b64_tr_b16 v[50:51], v104 offset:13312
    ds_read_b128 v[110:113], v89 offset:1024
    v_mfma_f32_32x32x16_bf16 v[176:191], v[20:23], v[4:7], v[176:191]
    ds_read_b64_tr_b16 v[52:53], v105 offset:12288
    v_mfma_f32_32x32x16_bf16 v[192:207], v[16:19], v[8:11], v[192:207]
    ds_read_b64_tr_b16 v[54:55], v105 offset:13312
    ds_read_b128 v[114:117], v89 offset:2048
    v_mfma_f32_32x32x16_bf16 v[208:223], v[20:23], v[8:11], v[208:223]
    ds_read_b128 v[36:39], v87 offset:4096
    v_mfma_f32_32x32x16_bf16 v[224:239], v[16:19], v[12:15], v[224:239]
    ds_read_b128 v[40:43], v87 offset:8192
    ds_read_b128 v[118:121], v89 offset:3072
    v_mfma_f32_32x32x16_bf16 v[240:255], v[20:23], v[12:15], v[240:255]
    ds_read_b128 v[44:47], v87 offset:12288
    s_waitcnt lgkmcnt(0)
    s_waitcnt vmcnt(16)
    s_barrier
    v_mfma_f32_32x32x16_bf16 v[128:143], v[48:51], v[32:35], v[128:143]
    v_add_u32 v84, 0xc000, v84
    s_add_u32 m0, s45, 49152
    v_add_u32 v85, 0xc000, v85
    buffer_load_dwordx4 v92, s[48:51], s29 offen lds
    s_add_u32 m0, s45, 50176
    s_nop 0
    buffer_load_dwordx4 v93, s[48:51], s29 offen lds
    s_mov_b32 s20, 128
    buffer_store_dwordx4 v[106:109], v90, s[12:15], s20 offen sc1
    s_mov_b32 s20, 65664
    buffer_store_dwordx4 v[110:113], v90, s[12:15], s20 offen sc1
    s_mov_b32 s20, 131200
    v_mfma_f32_32x32x16_bf16 v[144:159], v[52:55], v[32:35], v[144:159]
    v_add_u32 v86, 0xc000, v86
    s_add_u32 m0, s45, 51200
    v_add_u32 v87, 0xc000, v87
    buffer_load_dwordx4 v94, s[48:51], s29 offen lds
    buffer_store_dwordx4 v[114:117], v90, s[12:15], s20 offen sc1
    s_mov_b32 s20, 196736
    buffer_store_dwordx4 v[118:121], v90, s[12:15], s20 offen sc1
    v_accvgpr_read_b32 v74, a64
    v_accvgpr_read_b32 v75, a65
    v_mfma_f32_32x32x16_bf16 v[160:175], v[48:51], v[36:39], v[160:175]
    v_add_u32 v104, 0xc000, v104
    s_add_u32 m0, s45, 52224
    v_add_u32 v105, 0xc000, v105
    buffer_load_dwordx4 v95, s[48:51], s29 offen lds
    v_accvgpr_read_b32 v76, a66
    v_accvgpr_read_b32 v77, a67
    v_cvt_pk_bf16_f32 v78, v74, v75
    v_cvt_pk_bf16_f32 v79, v76, v77
    v_xor_b32 v74, 0, v88
    v_mfma_f32_32x32x16_bf16 v[176:191], v[52:55], v[36:39], v[176:191]
    s_add_u32 m0, s45, 53248
    ds_read_b128 v[0:3], v84 offset:0
    buffer_load_dwordx4 v96, s[48:51], s29 offen lds
    ds_write_b64 v74, v[78:79]
    v_accvgpr_read_b32 v122, a68
    v_accvgpr_read_b32 v123, a69
    v_accvgpr_read_b32 v124, a70
    v_accvgpr_read_b32 v125, a71
    v_mfma_f32_32x32x16_bf16 v[192:207], v[48:51], v[40:43], v[192:207]
    ds_read_b64_tr_b16 v[16:17], v104 offset:0
    s_add_u32 m0, s45, 54272
    ds_read_b64_tr_b16 v[18:19], v104 offset:1024
    buffer_load_dwordx4 v97, s[48:51], s29 offen lds
    v_cvt_pk_bf16_f32 v126, v122, v123
    v_cvt_pk_bf16_f32 v127, v124, v125
    v_xor_b32 v122, 16, v88
    ds_write_b64 v122, v[126:127]
    v_accvgpr_read_b32 v68, a72
    v_mfma_f32_32x32x16_bf16 v[208:223], v[52:55], v[40:43], v[208:223]
    ds_read_b64_tr_b16 v[20:21], v105 offset:0
    s_add_u32 m0, s45, 55296
    ds_read_b64_tr_b16 v[22:23], v105 offset:1024
    buffer_load_dwordx4 v98, s[48:51], s29 offen lds
    v_accvgpr_read_b32 v69, a73
    v_accvgpr_read_b32 v70, a74
    v_accvgpr_read_b32 v71, a75
    v_cvt_pk_bf16_f32 v72, v68, v69
    v_cvt_pk_bf16_f32 v73, v70, v71
    v_mfma_f32_32x32x16_bf16 v[224:239], v[48:51], v[44:47], v[224:239]
    ds_read_b128 v[4:7], v84 offset:4096
    s_add_u32 m0, s45, 56320
    ds_read_b128 v[8:11], v84 offset:8192
    buffer_load_dwordx4 v99, s[48:51], s29 offen lds
    v_xor_b32 v68, 32, v88
    ds_write_b64 v68, v[72:73]
    v_accvgpr_read_b32 v74, a76
    v_accvgpr_read_b32 v75, a77
    v_accvgpr_read_b32 v76, a78
    v_mfma_f32_32x32x16_bf16 v[240:255], v[52:55], v[44:47], v[240:255]
    ds_read_b128 v[12:15], v84 offset:12288
    s_add_u32 s29, s29, 128
    v_accvgpr_read_b32 v77, a79
    v_cvt_pk_bf16_f32 v78, v74, v75
    v_cvt_pk_bf16_f32 v79, v76, v77
    v_xor_b32 v74, 48, v88
    ds_write_b64 v74, v[78:79]
    s_waitcnt lgkmcnt(0)
    v_mfma_f32_32x32x16_bf16 v[128:143], v[16:19], v[0:3], v[128:143]
    s_add_u32 m0, s28, 81920
    ds_read_b128 v[32:35], v85 offset:0
    buffer_load_dwordx4 v100, s[52:55], s30 offen lds
    v_accvgpr_read_b32 v122, a80
    v_accvgpr_read_b32 v123, a81
    v_accvgpr_read_b32 v124, a82
    v_accvgpr_read_b32 v125, a83
    v_mfma_f32_32x32x16_bf16 v[144:159], v[20:23], v[0:3], v[144:159]
    s_add_u32 m0, s28, 82944
    ds_read_b64_tr_b16 v[48:49], v104 offset:4096
    buffer_load_dwordx4 v101, s[52:55], s30 offen lds
    v_cvt_pk_bf16_f32 v126, v122, v123
    v_cvt_pk_bf16_f32 v127, v124, v125
    v_xor_b32 v122, 64, v88
    ds_write_b64 v122, v[126:127]
    v_mfma_f32_32x32x16_bf16 v[160:175], v[16:19], v[4:7], v[160:175]
    ds_read_b64_tr_b16 v[50:51], v104 offset:5120
    v_accvgpr_read_b32 v68, a84
    v_accvgpr_read_b32 v69, a85
    v_accvgpr_read_b32 v70, a86
    v_accvgpr_read_b32 v71, a87
    v_mfma_f32_32x32x16_bf16 v[176:191], v[20:23], v[4:7], v[176:191]
    s_add_u32 m0, s28, 83968
    ds_read_b64_tr_b16 v[52:53], v105 offset:4096
    buffer_load_dwordx4 v102, s[52:55], s30 offen lds
    v_cvt_pk_bf16_f32 v72, v68, v69
    v_cvt_pk_bf16_f32 v73, v70, v71
    v_xor_b32 v68, 80, v88
    ds_write_b64 v68, v[72:73]
    v_mfma_f32_32x32x16_bf16 v[192:207], v[16:19], v[8:11], v[192:207]
    s_add_u32 m0, s28, 84992
    ds_read_b64_tr_b16 v[54:55], v105 offset:5120
    buffer_load_dwordx4 v103, s[52:55], s30 offen lds
    v_accvgpr_read_b32 v74, a88
    v_accvgpr_read_b32 v75, a89
    v_accvgpr_read_b32 v76, a90
    v_accvgpr_read_b32 v77, a91
    v_mfma_f32_32x32x16_bf16 v[208:223], v[20:23], v[8:11], v[208:223]
    ds_read_b128 v[36:39], v85 offset:4096
    v_cvt_pk_bf16_f32 v78, v74, v75
    v_cvt_pk_bf16_f32 v79, v76, v77
    v_xor_b32 v74, 96, v88
    ds_write_b64 v74, v[78:79]
    v_mfma_f32_32x32x16_bf16 v[224:239], v[16:19], v[12:15], v[224:239]
    ds_read_b128 v[40:43], v85 offset:8192
    s_add_u32 s30, s30, 0x80000
    v_accvgpr_read_b32 v122, a92
    v_accvgpr_read_b32 v123, a93
    v_accvgpr_read_b32 v124, a94
    v_accvgpr_read_b32 v125, a95
    v_mfma_f32_32x32x16_bf16 v[240:255], v[20:23], v[12:15], v[240:255]
    ds_read_b128 v[44:47], v85 offset:12288
    v_cvt_pk_bf16_f32 v126, v122, v123
    v_cvt_pk_bf16_f32 v127, v124, v125
    v_xor_b32 v122, 112, v88
    ds_write_b64 v122, v[126:127]
    s_waitcnt lgkmcnt(0)
    v_mfma_f32_32x32x16_bf16 v[128:143], v[48:51], v[32:35], v[128:143]
    ds_read_b128 v[0:3], v86 offset:0
    ds_read_b128 v[106:109], v89 offset:0
    v_mfma_f32_32x32x16_bf16 v[144:159], v[52:55], v[32:35], v[144:159]
    ds_read_b64_tr_b16 v[16:17], v104 offset:8192
    v_mfma_f32_32x32x16_bf16 v[160:175], v[48:51], v[36:39], v[160:175]
    ds_read_b64_tr_b16 v[18:19], v104 offset:9216
    ds_read_b128 v[110:113], v89 offset:1024
    v_mfma_f32_32x32x16_bf16 v[176:191], v[52:55], v[36:39], v[176:191]
    ds_read_b64_tr_b16 v[20:21], v105 offset:8192
    v_mfma_f32_32x32x16_bf16 v[192:207], v[48:51], v[40:43], v[192:207]
    ds_read_b64_tr_b16 v[22:23], v105 offset:9216
    ds_read_b128 v[114:117], v89 offset:2048
    v_mfma_f32_32x32x16_bf16 v[208:223], v[52:55], v[40:43], v[208:223]
    ds_read_b128 v[4:7], v86 offset:4096
    v_mfma_f32_32x32x16_bf16 v[224:239], v[48:51], v[44:47], v[224:239]
    ds_read_b128 v[8:11], v86 offset:8192
    ds_read_b128 v[118:121], v89 offset:3072
    v_mfma_f32_32x32x16_bf16 v[240:255], v[52:55], v[44:47], v[240:255]
    ds_read_b128 v[12:15], v86 offset:12288
    s_waitcnt lgkmcnt(0)
    v_mfma_f32_32x32x16_bf16 v[128:143], v[16:19], v[0:3], v[128:143]
    ds_read_b128 v[32:35], v87 offset:0
    s_mov_b32 s20, 262144
    buffer_store_dwordx4 v[106:109], v90, s[12:15], s20 offen sc1
    s_mov_b32 s20, 327680
    buffer_store_dwordx4 v[110:113], v90, s[12:15], s20 offen sc1
    s_mov_b32 s20, 393216
    v_mfma_f32_32x32x16_bf16 v[144:159], v[20:23], v[0:3], v[144:159]
    ds_read_b64_tr_b16 v[48:49], v104 offset:12288
    buffer_store_dwordx4 v[114:117], v90, s[12:15], s20 offen sc1
    s_mov_b32 s20, 458752
    buffer_store_dwordx4 v[118:121], v90, s[12:15], s20 offen sc1
    v_accvgpr_read_b32 v68, a96
    v_accvgpr_read_b32 v69, a97
    v_mfma_f32_32x32x16_bf16 v[160:175], v[16:19], v[4:7], v[160:175]
    ds_read_b64_tr_b16 v[50:51], v104 offset:13312
    v_accvgpr_read_b32 v70, a98
    v_accvgpr_read_b32 v71, a99
    v_cvt_pk_bf16_f32 v72, v68, v69
    v_cvt_pk_bf16_f32 v73, v70, v71
    v_xor_b32 v68, 0, v88
    v_mfma_f32_32x32x16_bf16 v[176:191], v[20:23], v[4:7], v[176:191]
    ds_read_b64_tr_b16 v[52:53], v105 offset:12288
    ds_write_b64 v68, v[72:73]
    v_accvgpr_read_b32 v74, a100
    v_accvgpr_read_b32 v75, a101
    v_accvgpr_read_b32 v76, a102
    v_accvgpr_read_b32 v77, a103
    v_mfma_f32_32x32x16_bf16 v[192:207], v[16:19], v[8:11], v[192:207]
    ds_read_b64_tr_b16 v[54:55], v105 offset:13312
    v_cvt_pk_bf16_f32 v78, v74, v75
    v_cvt_pk_bf16_f32 v79, v76, v77
    v_xor_b32 v74, 16, v88
    ds_write_b64 v74, v[78:79]
    v_accvgpr_read_b32 v122, a104
    v_mfma_f32_32x32x16_bf16 v[208:223], v[20:23], v[8:11], v[208:223]
    ds_read_b128 v[36:39], v87 offset:4096
    v_accvgpr_read_b32 v123, a105
    v_accvgpr_read_b32 v124, a106
    v_accvgpr_read_b32 v125, a107
    v_cvt_pk_bf16_f32 v126, v122, v123
    v_cvt_pk_bf16_f32 v127, v124, v125
    v_mfma_f32_32x32x16_bf16 v[224:239], v[16:19], v[12:15], v[224:239]
    ds_read_b128 v[40:43], v87 offset:8192
    v_xor_b32 v122, 32, v88
    ds_write_b64 v122, v[126:127]
    v_accvgpr_read_b32 v68, a108
    v_accvgpr_read_b32 v69, a109
    v_accvgpr_read_b32 v70, a110
    v_mfma_f32_32x32x16_bf16 v[240:255], v[20:23], v[12:15], v[240:255]
    ds_read_b128 v[44:47], v87 offset:12288
    v_accvgpr_read_b32 v71, a111
    v_cvt_pk_bf16_f32 v72, v68, v69
    v_cvt_pk_bf16_f32 v73, v70, v71
    v_xor_b32 v68, 48, v88
    ds_write_b64 v68, v[72:73]
    s_waitcnt lgkmcnt(0)
    s_waitcnt vmcnt(20)
    s_barrier
    v_mfma_f32_32x32x16_bf16 v[128:143], v[48:51], v[32:35], v[128:143]
    v_add_u32 v84, 0xfffe8000, v84
    s_add_u32 m0, s45, 98304
    v_add_u32 v85, 0xfffe8000, v85
    buffer_load_dwordx4 v92, s[48:51], s29 offen lds
    s_add_u32 m0, s45, 99328
    s_nop 0
    buffer_load_dwordx4 v93, s[48:51], s29 offen lds
    v_accvgpr_read_b32 v74, a112
    v_accvgpr_read_b32 v75, a113
    v_accvgpr_read_b32 v76, a114
    v_accvgpr_read_b32 v77, a115
    v_mfma_f32_32x32x16_bf16 v[144:159], v[52:55], v[32:35], v[144:159]
    v_add_u32 v86, 0xfffe8000, v86
    s_add_u32 m0, s45, 100352
    v_add_u32 v87, 0xfffe8000, v87
    buffer_load_dwordx4 v94, s[48:51], s29 offen lds
    v_cvt_pk_bf16_f32 v78, v74, v75
    v_cvt_pk_bf16_f32 v79, v76, v77
    v_xor_b32 v74, 64, v88
    ds_write_b64 v74, v[78:79]
    v_mfma_f32_32x32x16_bf16 v[160:175], v[48:51], v[36:39], v[160:175]
    v_add_u32 v104, 0xfffe8000, v104
    s_add_u32 m0, s45, 101376
    v_add_u32 v105, 0xfffe8000, v105
    buffer_load_dwordx4 v95, s[48:51], s29 offen lds
    v_accvgpr_read_b32 v122, a116
    v_accvgpr_read_b32 v123, a117
    v_accvgpr_read_b32 v124, a118
    v_accvgpr_read_b32 v125, a119
    v_mfma_f32_32x32x16_bf16 v[176:191], v[52:55], v[36:39], v[176:191]
    s_add_u32 m0, s45, 102400
    ds_read_b128 v[0:3], v84 offset:0
    buffer_load_dwordx4 v96, s[48:51], s29 offen lds
    v_cvt_pk_bf16_f32 v126, v122, v123
    v_cvt_pk_bf16_f32 v127, v124, v125
    v_xor_b32 v122, 80, v88
    ds_write_b64 v122, v[126:127]
    v_mfma_f32_32x32x16_bf16 v[192:207], v[48:51], v[40:43], v[192:207]
    ds_read_b64_tr_b16 v[16:17], v104 offset:0
    s_add_u32 m0, s45, 103424
    ds_read_b64_tr_b16 v[18:19], v104 offset:1024
    buffer_load_dwordx4 v97, s[48:51], s29 offen lds
    v_accvgpr_read_b32 v68, a120
    v_accvgpr_read_b32 v69, a121
    v_accvgpr_read_b32 v70, a122
    v_accvgpr_read_b32 v71, a123
    v_mfma_f32_32x32x16_bf16 v[208:223], v[52:55], v[40:43], v[208:223]
    ds_read_b64_tr_b16 v[20:21], v105 offset:0
    s_add_u32 m0, s45, 104448
    ds_read_b64_tr_b16 v[22:23], v105 offset:1024
    buffer_load_dwordx4 v98, s[48:51], s29 offen lds
    v_cvt_pk_bf16_f32 v72, v68, v69
    v_cvt_pk_bf16_f32 v73, v70, v71
    v_xor_b32 v68, 96, v88
    ds_write_b64 v68, v[72:73]
    v_mfma_f32_32x32x16_bf16 v[224:239], v[48:51], v[44:47], v[224:239]
    ds_read_b128 v[4:7], v84 offset:4096
    s_add_u32 m0, s45, 105472
    ds_read_b128 v[8:11], v84 offset:8192
    buffer_load_dwordx4 v99, s[48:51], s29 offen lds
    v_accvgpr_read_b32 v74, a124
    v_accvgpr_read_b32 v75, a125
    v_accvgpr_read_b32 v76, a126
    v_accvgpr_read_b32 v77, a127
    v_mfma_f32_32x32x16_bf16 v[240:255], v[52:55], v[44:47], v[240:255]
    ds_read_b128 v[12:15], v84 offset:12288
    s_add_u32 s29, s29, 128
    v_cvt_pk_bf16_f32 v78, v74, v75
    v_cvt_pk_bf16_f32 v79, v76, v77
    v_xor_b32 v74, 112, v88
    ds_write_b64 v74, v[78:79]
    s_waitcnt lgkmcnt(0)
    v_mfma_f32_32x32x16_bf16 v[128:143], v[16:19], v[0:3], v[128:143]
    s_add_u32 m0, s28, 131072
    ds_read_b128 v[32:35], v85 offset:0
    buffer_load_dwordx4 v100, s[52:55], s30 offen lds
    ds_read_b128 v[106:109], v89 offset:0
    v_mfma_f32_32x32x16_bf16 v[144:159], v[20:23], v[0:3], v[144:159]
    s_add_u32 m0, s28, 132096
    ds_read_b64_tr_b16 v[48:49], v104 offset:4096
    buffer_load_dwordx4 v101, s[52:55], s30 offen lds
    v_mfma_f32_32x32x16_bf16 v[160:175], v[16:19], v[4:7], v[160:175]
    ds_read_b64_tr_b16 v[50:51], v104 offset:5120
    ds_read_b128 v[110:113], v89 offset:1024
    v_mfma_f32_32x32x16_bf16 v[176:191], v[20:23], v[4:7], v[176:191]
    s_add_u32 m0, s28, 133120
    ds_read_b64_tr_b16 v[52:53], v105 offset:4096
    buffer_load_dwordx4 v102, s[52:55], s30 offen lds
    v_mfma_f32_32x32x16_bf16 v[192:207], v[16:19], v[8:11], v[192:207]
    s_add_u32 m0, s28, 134144
    ds_read_b64_tr_b16 v[54:55], v105 offset:5120
    buffer_load_dwordx4 v103, s[52:55], s30 offen lds
    ds_read_b128 v[114:117], v89 offset:2048
    v_mfma_f32_32x32x16_bf16 v[208:223], v[20:23], v[8:11], v[208:223]
    ds_read_b128 v[36:39], v85 offset:4096
    v_mfma_f32_32x32x16_bf16 v[224:239], v[16:19], v[12:15], v[224:239]
    ds_read_b128 v[40:43], v85 offset:8192
    s_add_u32 s30, s30, 0x80000
    ds_read_b128 v[118:121], v89 offset:3072
    v_mfma_f32_32x32x16_bf16 v[240:255], v[20:23], v[12:15], v[240:255]
    ds_read_b128 v[44:47], v85 offset:12288
    s_waitcnt lgkmcnt(0)
    v_mfma_f32_32x32x16_bf16 v[128:143], v[48:51], v[32:35], v[128:143]
    ds_read_b128 v[0:3], v86 offset:0
    s_mov_b32 s20, 262272
    buffer_store_dwordx4 v[106:109], v90, s[12:15], s20 offen sc1
    s_mov_b32 s20, 327808
    buffer_store_dwordx4 v[110:113], v90, s[12:15], s20 offen sc1
    s_mov_b32 s20, 393344
    v_mfma_f32_32x32x16_bf16 v[144:159], v[52:55], v[32:35], v[144:159]
    ds_read_b64_tr_b16 v[16:17], v104 offset:8192
    buffer_store_dwordx4 v[114:117], v90, s[12:15], s20 offen sc1
    s_mov_b32 s20, 458880
    buffer_store_dwordx4 v[118:121], v90, s[12:15], s20 offen sc1
    v_accvgpr_read_b32 v122, a128
    v_accvgpr_read_b32 v123, a129
    v_mfma_f32_32x32x16_bf16 v[160:175], v[48:51], v[36:39], v[160:175]
    ds_read_b64_tr_b16 v[18:19], v104 offset:9216
    v_accvgpr_read_b32 v124, a130
    v_accvgpr_read_b32 v125, a131
    v_cvt_pk_bf16_f32 v126, v122, v123
    v_cvt_pk_bf16_f32 v127, v124, v125
    v_xor_b32 v122, 0, v88
    v_mfma_f32_32x32x16_bf16 v[176:191], v[52:55], v[36:39], v[176:191]
    ds_read_b64_tr_b16 v[20:21], v105 offset:8192
    ds_write_b64 v122, v[126:127]
    v_accvgpr_read_b32 v68, a132
    v_accvgpr_read_b32 v69, a133
    v_accvgpr_read_b32 v70, a134
    v_accvgpr_read_b32 v71, a135
    v_mfma_f32_32x32x16_bf16 v[192:207], v[48:51], v[40:43], v[192:207]
    ds_read_b64_tr_b16 v[22:23], v105 offset:9216
    v_cvt_pk_bf16_f32 v72, v68, v69
    v_cvt_pk_bf16_f32 v73, v70, v71
    v_xor_b32 v68, 16, v88
    ds_write_b64 v68, v[72:73]
    v_accvgpr_read_b32 v74, a136
    v_mfma_f32_32x32x16_bf16 v[208:223], v[52:55], v[40:43], v[208:223]
    ds_read_b128 v[4:7], v86 offset:4096
    v_accvgpr_read_b32 v75, a137
    v_accvgpr_read_b32 v76, a138
    v_accvgpr_read_b32 v77, a139
    v_cvt_pk_bf16_f32 v78, v74, v75
    v_cvt_pk_bf16_f32 v79, v76, v77
    v_mfma_f32_32x32x16_bf16 v[224:239], v[48:51], v[44:47], v[224:239]
    ds_read_b128 v[8:11], v86 offset:8192
    v_xor_b32 v74, 32, v88
    ds_write_b64 v74, v[78:79]
    v_accvgpr_read_b32 v122, a140
    v_accvgpr_read_b32 v123, a141
    v_accvgpr_read_b32 v124, a142
    v_mfma_f32_32x32x16_bf16 v[240:255], v[52:55], v[44:47], v[240:255]
    ds_read_b128 v[12:15], v86 offset:12288
    v_accvgpr_read_b32 v125, a143
    v_cvt_pk_bf16_f32 v126, v122, v123
    v_cvt_pk_bf16_f32 v127, v124, v125
    v_xor_b32 v122, 48, v88
    ds_write_b64 v122, v[126:127]
    s_waitcnt lgkmcnt(0)
    v_mfma_f32_32x32x16_bf16 v[128:143], v[16:19], v[0:3], v[128:143]
    ds_read_b128 v[32:35], v87 offset:0
    v_accvgpr_read_b32 v68, a144
    v_accvgpr_read_b32 v69, a145
    v_accvgpr_read_b32 v70, a146
    v_accvgpr_read_b32 v71, a147
    v_mfma_f32_32x32x16_bf16 v[144:159], v[20:23], v[0:3], v[144:159]
    ds_read_b64_tr_b16 v[48:49], v104 offset:12288
    v_cvt_pk_bf16_f32 v72, v68, v69
    v_cvt_pk_bf16_f32 v73, v70, v71
    v_xor_b32 v68, 64, v88
    ds_write_b64 v68, v[72:73]
    v_mfma_f32_32x32x16_bf16 v[160:175], v[16:19], v[4:7], v[160:175]
    ds_read_b64_tr_b16 v[50:51], v104 offset:13312
    v_accvgpr_read_b32 v74, a148
    v_accvgpr_read_b32 v75, a149
    v_accvgpr_read_b32 v76, a150
    v_accvgpr_read_b32 v77, a151
    v_mfma_f32_32x32x16_bf16 v[176:191], v[20:23], v[4:7], v[176:191]
    ds_read_b64_tr_b16 v[52:53], v105 offset:12288
    v_cvt_pk_bf16_f32 v78, v74, v75
    v_cvt_pk_bf16_f32 v79, v76, v77
    v_xor_b32 v74, 80, v88
    ds_write_b64 v74, v[78:79]
    v_mfma_f32_32x32x16_bf16 v[192:207], v[16:19], v[8:11], v[192:207]
    ds_read_b64_tr_b16 v[54:55], v105 offset:13312
    v_accvgpr_read_b32 v122, a152
    v_accvgpr_read_b32 v123, a153
    v_accvgpr_read_b32 v124, a154
    v_accvgpr_read_b32 v125, a155
    v_mfma_f32_32x32x16_bf16 v[208:223], v[20:23], v[8:11], v[208:223]
    ds_read_b128 v[36:39], v87 offset:4096
    v_cvt_pk_bf16_f32 v126, v122, v123
    v_cvt_pk_bf16_f32 v127, v124, v125
    v_xor_b32 v122, 96, v88
    ds_write_b64 v122, v[126:127]
    v_mfma_f32_32x32x16_bf16 v[224:239], v[16:19], v[12:15], v[224:239]
    ds_read_b128 v[40:43], v87 offset:8192
    v_accvgpr_read_b32 v68, a156
    v_accvgpr_read_b32 v69, a157
    v_accvgpr_read_b32 v70, a158
    v_accvgpr_read_b32 v71, a159
    v_mfma_f32_32x32x16_bf16 v[240:255], v[20:23], v[12:15], v[240:255]
    ds_read_b128 v[44:47], v87 offset:12288
    v_cvt_pk_bf16_f32 v72, v68, v69
    v_cvt_pk_bf16_f32 v73, v70, v71
    v_xor_b32 v68, 112, v88
    ds_write_b64 v68, v[72:73]
    s_waitcnt lgkmcnt(0)
    s_waitcnt vmcnt(20)
    s_barrier
    v_mfma_f32_32x32x16_bf16 v[128:143], v[48:51], v[32:35], v[128:143]
    v_add_u32 v84, 0xc000, v84
    s_add_u32 m0, s45, 0
    v_add_u32 v85, 0xc000, v85
    buffer_load_dwordx4 v92, s[48:51], s29 offen lds
    s_add_u32 m0, s45, 1024
    s_nop 0
    buffer_load_dwordx4 v93, s[48:51], s29 offen lds
    ds_read_b128 v[106:109], v89 offset:0
    v_mfma_f32_32x32x16_bf16 v[144:159], v[52:55], v[32:35], v[144:159]
    v_add_u32 v86, 0xc000, v86
    s_add_u32 m0, s45, 2048
    v_add_u32 v87, 0xc000, v87
    buffer_load_dwordx4 v94, s[48:51], s29 offen lds
    v_mfma_f32_32x32x16_bf16 v[160:175], v[48:51], v[36:39], v[160:175]
    v_add_u32 v104, 0xc000, v104
    s_add_u32 m0, s45, 3072
    v_add_u32 v105, 0xc000, v105
    buffer_load_dwordx4 v95, s[48:51], s29 offen lds
    ds_read_b128 v[110:113], v89 offset:1024
    v_mfma_f32_32x32x16_bf16 v[176:191], v[52:55], v[36:39], v[176:191]
    s_add_u32 m0, s45, 4096
    ds_read_b128 v[0:3], v84 offset:0
    buffer_load_dwordx4 v96, s[48:51], s29 offen lds
    v_mfma_f32_32x32x16_bf16 v[192:207], v[48:51], v[40:43], v[192:207]
    ds_read_b64_tr_b16 v[16:17], v104 offset:0
    s_add_u32 m0, s45, 5120
    ds_read_b64_tr_b16 v[18:19], v104 offset:1024
    buffer_load_dwordx4 v97, s[48:51], s29 offen lds
    ds_read_b128 v[114:117], v89 offset:2048
    v_mfma_f32_32x32x16_bf16 v[208:223], v[52:55], v[40:43], v[208:223]
    ds_read_b64_tr_b16 v[20:21], v105 offset:0
    s_add_u32 m0, s45, 6144
    ds_read_b64_tr_b16 v[22:23], v105 offset:1024
    buffer_load_dwordx4 v98, s[48:51], s29 offen lds
    v_mfma_f32_32x32x16_bf16 v[224:239], v[48:51], v[44:47], v[224:239]
    ds_read_b128 v[4:7], v84 offset:4096
    s_add_u32 m0, s45, 7168
    ds_read_b128 v[8:11], v84 offset:8192
    buffer_load_dwordx4 v99, s[48:51], s29 offen lds
    ds_read_b128 v[118:121], v89 offset:3072
    v_mfma_f32_32x32x16_bf16 v[240:255], v[52:55], v[44:47], v[240:255]
    ds_read_b128 v[12:15], v84 offset:12288
    s_add_u32 s29, s29, 128
    s_waitcnt lgkmcnt(0)
    v_mfma_f32_32x32x16_bf16 v[128:143], v[16:19], v[0:3], v[128:143]
    s_add_u32 m0, s28, 32768
    ds_read_b128 v[32:35], v85 offset:0
    buffer_load_dwordx4 v100, s[52:55], s30 offen lds
    s_mov_b32 s20, 524288
    buffer_store_dwordx4 v[106:109], v90, s[12:15], s20 offen sc1
    s_mov_b32 s20, 589824
    buffer_store_dwordx4 v[110:113], v90, s[12:15], s20 offen sc1
    s_mov_b32 s20, 655360
    v_mfma_f32_32x32x16_bf16 v[144:159], v[20:23], v[0:3], v[144:159]
    s_add_u32 m0, s28, 33792
    ds_read_b64_tr_b16 v[48:49], v104 offset:4096
    buffer_load_dwordx4 v101, s[52:55], s30 offen lds
    buffer_store_dwordx4 v[114:117], v90, s[12:15], s20 offen sc1
    s_mov_b32 s20, 720896
    buffer_store_dwordx4 v[118:121], v90, s[12:15], s20 offen sc1
    v_accvgpr_read_b32 v74, a160
    v_accvgpr_read_b32 v75, a161
    v_mfma_f32_32x32x16_bf16 v[160:175], v[16:19], v[4:7], v[160:175]
    ds_read_b64_tr_b16 v[50:51], v104 offset:5120
    v_accvgpr_read_b32 v76, a162
    v_accvgpr_read_b32 v77, a163
    v_cvt_pk_bf16_f32 v78, v74, v75
    v_cvt_pk_bf16_f32 v79, v76, v77
    v_xor_b32 v74, 0, v88
    v_mfma_f32_32x32x16_bf16 v[176:191], v[20:23], v[4:7], v[176:191]
    s_add_u32 m0, s28, 34816
    ds_read_b64_tr_b16 v[52:53], v105 offset:4096
    buffer_load_dwordx4 v102, s[52:55], s30 offen lds
    ds_write_b64 v74, v[78:79]
    v_accvgpr_read_b32 v122, a164
    v_accvgpr_read_b32 v123, a165
    v_accvgpr_read_b32 v124, a166
    v_accvgpr_read_b32 v125, a167
    v_mfma_f32_32x32x16_bf16 v[192:207], v[16:19], v[8:11], v[192:207]
    s_add_u32 m0, s28, 35840
    ds_read_b64_tr_b16 v[54:55], v105 offset:5120
    buffer_load_dwordx4 v103, s[52:55], s30 offen lds
    v_cvt_pk_bf16_f32 v126, v122, v123
    v_cvt_pk_bf16_f32 v127, v124, v125
    v_xor_b32 v122, 16, v88
    ds_write_b64 v122, v[126:127]
    v_accvgpr_read_b32 v68, a168
    v_mfma_f32_32x32x16_bf16 v[208:223], v[20:23], v[8:11], v[208:223]
    ds_read_b128 v[36:39], v85 offset:4096
    v_accvgpr_read_b32 v69, a169
    v_accvgpr_read_b32 v70, a170
    v_accvgpr_read_b32 v71, a171
    v_cvt_pk_bf16_f32 v72, v68, v69
    v_cvt_pk_bf16_f32 v73, v70, v71
    v_mfma_f32_32x32x16_bf16 v[224:239], v[16:19], v[12:15], v[224:239]
    ds_read_b128 v[40:43], v85 offset:8192
    s_add_u32 s30, s30, 0x80000
    v_xor_b32 v68, 32, v88
    ds_write_b64 v68, v[72:73]
    v_accvgpr_read_b32 v74, a172
    v_accvgpr_read_b32 v75, a173
    v_accvgpr_read_b32 v76, a174
    v_mfma_f32_32x32x16_bf16 v[240:255], v[20:23], v[12:15], v[240:255]
    ds_read_b128 v[44:47], v85 offset:12288
    v_accvgpr_read_b32 v77, a175
    v_cvt_pk_bf16_f32 v78, v74, v75
    v_cvt_pk_bf16_f32 v79, v76, v77
    v_xor_b32 v74, 48, v88
    ds_write_b64 v74, v[78:79]
    s_waitcnt lgkmcnt(0)
    v_mfma_f32_32x32x16_bf16 v[128:143], v[48:51], v[32:35], v[128:143]
    ds_read_b128 v[0:3], v86 offset:0
    v_accvgpr_read_b32 v122, a176
    v_accvgpr_read_b32 v123, a177
    v_accvgpr_read_b32 v124, a178
    v_accvgpr_read_b32 v125, a179
    v_mfma_f32_32x32x16_bf16 v[144:159], v[52:55], v[32:35], v[144:159]
    ds_read_b64_tr_b16 v[16:17], v104 offset:8192
    v_cvt_pk_bf16_f32 v126, v122, v123
    v_cvt_pk_bf16_f32 v127, v124, v125
    v_xor_b32 v122, 64, v88
    ds_write_b64 v122, v[126:127]
    v_mfma_f32_32x32x16_bf16 v[160:175], v[48:51], v[36:39], v[160:175]
    ds_read_b64_tr_b16 v[18:19], v104 offset:9216
    v_accvgpr_read_b32 v68, a180
    v_accvgpr_read_b32 v69, a181
    v_accvgpr_read_b32 v70, a182
    v_accvgpr_read_b32 v71, a183
    v_mfma_f32_32x32x16_bf16 v[176:191], v[52:55], v[36:39], v[176:191]
    ds_read_b64_tr_b16 v[20:21], v105 offset:8192
    v_cvt_pk_bf16_f32 v72, v68, v69
    v_cvt_pk_bf16_f32 v73, v70, v71
    v_xor_b32 v68, 80, v88
    ds_write_b64 v68, v[72:73]
    v_mfma_f32_32x32x16_bf16 v[192:207], v[48:51], v[40:43], v[192:207]
    ds_read_b64_tr_b16 v[22:23], v105 offset:9216
    v_accvgpr_read_b32 v74, a184
    v_accvgpr_read_b32 v75, a185
    v_accvgpr_read_b32 v76, a186
    v_accvgpr_read_b32 v77, a187
    v_mfma_f32_32x32x16_bf16 v[208:223], v[52:55], v[40:43], v[208:223]
    ds_read_b128 v[4:7], v86 offset:4096
    v_cvt_pk_bf16_f32 v78, v74, v75
    v_cvt_pk_bf16_f32 v79, v76, v77
    v_xor_b32 v74, 96, v88
    ds_write_b64 v74, v[78:79]
    v_mfma_f32_32x32x16_bf16 v[224:239], v[48:51], v[44:47], v[224:239]
    ds_read_b128 v[8:11], v86 offset:8192
    v_accvgpr_read_b32 v122, a188
    v_accvgpr_read_b32 v123, a189
    v_accvgpr_read_b32 v124, a190
    v_accvgpr_read_b32 v125, a191
    v_mfma_f32_32x32x16_bf16 v[240:255], v[52:55], v[44:47], v[240:255]
    ds_read_b128 v[12:15], v86 offset:12288
    v_cvt_pk_bf16_f32 v126, v122, v123
    v_cvt_pk_bf16_f32 v127, v124, v125
    v_xor_b32 v122, 112, v88
    ds_write_b64 v122, v[126:127]
    s_waitcnt lgkmcnt(0)
    v_mfma_f32_32x32x16_bf16 v[128:143], v[16:19], v[0:3], v[128:143]
    ds_read_b128 v[32:35], v87 offset:0
    ds_read_b128 v[106:109], v89 offset:0
    v_mfma_f32_32x32x16_bf16 v[144:159], v[20:23], v[0:3], v[144:159]
    ds_read_b64_tr_b16 v[48:49], v104 offset:12288
    v_mfma_f32_32x32x16_bf16 v[160:175], v[16:19], v[4:7], v[160:175]
    ds_read_b64_tr_b16 v[50:51], v104 offset:13312
    ds_read_b128 v[110:113], v89 offset:1024
    v_mfma_f32_32x32x16_bf16 v[176:191], v[20:23], v[4:7], v[176:191]
    ds_read_b64_tr_b16 v[52:53], v105 offset:12288
    v_mfma_f32_32x32x16_bf16 v[192:207], v[16:19], v[8:11], v[192:207]
    ds_read_b64_tr_b16 v[54:55], v105 offset:13312
    ds_read_b128 v[114:117], v89 offset:2048
    v_mfma_f32_32x32x16_bf16 v[208:223], v[20:23], v[8:11], v[208:223]
    ds_read_b128 v[36:39], v87 offset:4096
    v_mfma_f32_32x32x16_bf16 v[224:239], v[16:19], v[12:15], v[224:239]
    ds_read_b128 v[40:43], v87 offset:8192
    ds_read_b128 v[118:121], v89 offset:3072
    v_mfma_f32_32x32x16_bf16 v[240:255], v[20:23], v[12:15], v[240:255]
    ds_read_b128 v[44:47], v87 offset:12288
    s_waitcnt lgkmcnt(0)
    s_waitcnt vmcnt(20)
    s_barrier
    v_mfma_f32_32x32x16_bf16 v[128:143], v[48:51], v[32:35], v[128:143]
    v_add_u32 v84, 0xc000, v84
    v_add_u32 v85, 0xc000, v85
    s_mov_b32 s20, 524416
    buffer_store_dwordx4 v[106:109], v90, s[12:15], s20 offen sc1
    s_mov_b32 s20, 589952
    buffer_store_dwordx4 v[110:113], v90, s[12:15], s20 offen sc1
    s_mov_b32 s20, 655488
    v_mfma_f32_32x32x16_bf16 v[144:159], v[52:55], v[32:35], v[144:159]
    v_add_u32 v86, 0xc000, v86
    v_add_u32 v87, 0xc000, v87
    buffer_store_dwordx4 v[114:117], v90, s[12:15], s20 offen sc1
    s_mov_b32 s20, 721024
    buffer_store_dwordx4 v[118:121], v90, s[12:15], s20 offen sc1
    v_accvgpr_read_b32 v68, a192
    v_accvgpr_read_b32 v69, a193
    v_mfma_f32_32x32x16_bf16 v[160:175], v[48:51], v[36:39], v[160:175]
    v_add_u32 v104, 0xc000, v104
    v_add_u32 v105, 0xc000, v105
    v_accvgpr_read_b32 v70, a194
    v_accvgpr_read_b32 v71, a195
    v_cvt_pk_bf16_f32 v72, v68, v69
    v_cvt_pk_bf16_f32 v73, v70, v71
    v_xor_b32 v68, 0, v88
    v_mfma_f32_32x32x16_bf16 v[176:191], v[52:55], v[36:39], v[176:191]
    ds_read_b128 v[0:3], v84 offset:0
    ds_write_b64 v68, v[72:73]
    v_accvgpr_read_b32 v74, a196
    v_accvgpr_read_b32 v75, a197
    v_accvgpr_read_b32 v76, a198
    v_accvgpr_read_b32 v77, a199
    v_mfma_f32_32x32x16_bf16 v[192:207], v[48:51], v[40:43], v[192:207]
    ds_read_b64_tr_b16 v[16:17], v104 offset:0
    ds_read_b64_tr_b16 v[18:19], v104 offset:1024
    v_cvt_pk_bf16_f32 v78, v74, v75
    v_cvt_pk_bf16_f32 v79, v76, v77
    v_xor_b32 v74, 16, v88
    ds_write_b64 v74, v[78:79]
    v_accvgpr_read_b32 v122, a200
    v_mfma_f32_32x32x16_bf16 v[208:223], v[52:55], v[40:43], v[208:223]
    ds_read_b64_tr_b16 v[20:21], v105 offset:0
    ds_read_b64_tr_b16 v[22:23], v105 offset:1024
    v_accvgpr_read_b32 v123, a201
    v_accvgpr_read_b32 v124, a202
    v_accvgpr_read_b32 v125, a203
    v_cvt_pk_bf16_f32 v126, v122, v123
    v_cvt_pk_bf16_f32 v127, v124, v125
    v_mfma_f32_32x32x16_bf16 v[224:239], v[48:51], v[44:47], v[224:239]
    ds_read_b128 v[4:7], v84 offset:4096
    ds_read_b128 v[8:11], v84 offset:8192
    v_xor_b32 v122, 32, v88
    ds_write_b64 v122, v[126:127]
    v_accvgpr_read_b32 v68, a204
    v_accvgpr_read_b32 v69, a205
    v_accvgpr_read_b32 v70, a206
    v_mfma_f32_32x32x16_bf16 v[240:255], v[52:55], v[44:47], v[240:255]
    ds_read_b128 v[12:15], v84 offset:12288
    v_accvgpr_read_b32 v71, a207
    v_cvt_pk_bf16_f32 v72, v68, v69
    v_cvt_pk_bf16_f32 v73, v70, v71
    v_xor_b32 v68, 48, v88
    ds_write_b64 v68, v[72:73]
    s_waitcnt lgkmcnt(0)
    v_mfma_f32_32x32x16_bf16 v[128:143], v[16:19], v[0:3], v[128:143]
    ds_read_b128 v[32:35], v85 offset:0
    v_accvgpr_read_b32 v74, a208
    v_accvgpr_read_b32 v75, a209
    v_accvgpr_read_b32 v76, a210
    v_accvgpr_read_b32 v77, a211
    v_mfma_f32_32x32x16_bf16 v[144:159], v[20:23], v[0:3], v[144:159]
    ds_read_b64_tr_b16 v[48:49], v104 offset:4096
    v_cvt_pk_bf16_f32 v78, v74, v75
    v_cvt_pk_bf16_f32 v79, v76, v77
    v_xor_b32 v74, 64, v88
    ds_write_b64 v74, v[78:79]
    v_mfma_f32_32x32x16_bf16 v[160:175], v[16:19], v[4:7], v[160:175]
    ds_read_b64_tr_b16 v[50:51], v104 offset:5120
    v_accvgpr_read_b32 v122, a212
    v_accvgpr_read_b32 v123, a213
    v_accvgpr_read_b32 v124, a214
    v_accvgpr_read_b32 v125, a215
    v_mfma_f32_32x32x16_bf16 v[176:191], v[20:23], v[4:7], v[176:191]
    ds_read_b64_tr_b16 v[52:53], v105 offset:4096
    v_cvt_pk_bf16_f32 v126, v122, v123
    v_cvt_pk_bf16_f32 v127, v124, v125
    v_xor_b32 v122, 80, v88
    ds_write_b64 v122, v[126:127]
    v_mfma_f32_32x32x16_bf16 v[192:207], v[16:19], v[8:11], v[192:207]
    ds_read_b64_tr_b16 v[54:55], v105 offset:5120
    v_accvgpr_read_b32 v68, a216
    v_accvgpr_read_b32 v69, a217
    v_accvgpr_read_b32 v70, a218
    v_accvgpr_read_b32 v71, a219
    v_mfma_f32_32x32x16_bf16 v[208:223], v[20:23], v[8:11], v[208:223]
    ds_read_b128 v[36:39], v85 offset:4096
    v_cvt_pk_bf16_f32 v72, v68, v69
    v_cvt_pk_bf16_f32 v73, v70, v71
    v_xor_b32 v68, 96, v88
    ds_write_b64 v68, v[72:73]
    v_mfma_f32_32x32x16_bf16 v[224:239], v[16:19], v[12:15], v[224:239]
    ds_read_b128 v[40:43], v85 offset:8192
    v_accvgpr_read_b32 v74, a220
    v_accvgpr_read_b32 v75, a221
    v_accvgpr_read_b32 v76, a222
    v_accvgpr_read_b32 v77, a223
    v_mfma_f32_32x32x16_bf16 v[240:255], v[20:23], v[12:15], v[240:255]
    ds_read_b128 v[44:47], v85 offset:12288
    v_cvt_pk_bf16_f32 v78, v74, v75
    v_cvt_pk_bf16_f32 v79, v76, v77
    v_xor_b32 v74, 112, v88
    ds_write_b64 v74, v[78:79]
    s_waitcnt lgkmcnt(0)
    v_mfma_f32_32x32x16_bf16 v[128:143], v[48:51], v[32:35], v[128:143]
    ds_read_b128 v[0:3], v86 offset:0
    ds_read_b128 v[106:109], v89 offset:0
    v_mfma_f32_32x32x16_bf16 v[144:159], v[52:55], v[32:35], v[144:159]
    ds_read_b64_tr_b16 v[16:17], v104 offset:8192
    v_mfma_f32_32x32x16_bf16 v[160:175], v[48:51], v[36:39], v[160:175]
    ds_read_b64_tr_b16 v[18:19], v104 offset:9216
    ds_read_b128 v[110:113], v89 offset:1024
    v_mfma_f32_32x32x16_bf16 v[176:191], v[52:55], v[36:39], v[176:191]
    ds_read_b64_tr_b16 v[20:21], v105 offset:8192
    v_mfma_f32_32x32x16_bf16 v[192:207], v[48:51], v[40:43], v[192:207]
    ds_read_b64_tr_b16 v[22:23], v105 offset:9216
    ds_read_b128 v[114:117], v89 offset:2048
    v_mfma_f32_32x32x16_bf16 v[208:223], v[52:55], v[40:43], v[208:223]
    ds_read_b128 v[4:7], v86 offset:4096
    v_mfma_f32_32x32x16_bf16 v[224:239], v[48:51], v[44:47], v[224:239]
    ds_read_b128 v[8:11], v86 offset:8192
    ds_read_b128 v[118:121], v89 offset:3072
    v_mfma_f32_32x32x16_bf16 v[240:255], v[52:55], v[44:47], v[240:255]
    ds_read_b128 v[12:15], v86 offset:12288
    s_waitcnt lgkmcnt(0)
    v_mfma_f32_32x32x16_bf16 v[128:143], v[16:19], v[0:3], v[128:143]
    ds_read_b128 v[32:35], v87 offset:0
    s_mov_b32 s20, 786432
    buffer_store_dwordx4 v[106:109], v90, s[12:15], s20 offen sc1
    s_mov_b32 s20, 851968
    buffer_store_dwordx4 v[110:113], v90, s[12:15], s20 offen sc1
    s_mov_b32 s20, 917504
    v_mfma_f32_32x32x16_bf16 v[144:159], v[20:23], v[0:3], v[144:159]
    ds_read_b64_tr_b16 v[48:49], v104 offset:12288
    buffer_store_dwordx4 v[114:117], v90, s[12:15], s20 offen sc1
    s_mov_b32 s20, 983040
    buffer_store_dwordx4 v[118:121], v90, s[12:15], s20 offen sc1
    v_accvgpr_read_b32 v122, a224
    v_accvgpr_read_b32 v123, a225
    v_mfma_f32_32x32x16_bf16 v[160:175], v[16:19], v[4:7], v[160:175]
    ds_read_b64_tr_b16 v[50:51], v104 offset:13312
    v_accvgpr_read_b32 v124, a226
    v_accvgpr_read_b32 v125, a227
    v_cvt_pk_bf16_f32 v126, v122, v123
    v_cvt_pk_bf16_f32 v127, v124, v125
    v_xor_b32 v122, 0, v88
    v_mfma_f32_32x32x16_bf16 v[176:191], v[20:23], v[4:7], v[176:191]
    ds_read_b64_tr_b16 v[52:53], v105 offset:12288
    ds_write_b64 v122, v[126:127]
    v_accvgpr_read_b32 v68, a228
    v_accvgpr_read_b32 v69, a229
    v_accvgpr_read_b32 v70, a230
    v_accvgpr_read_b32 v71, a231
    v_mfma_f32_32x32x16_bf16 v[192:207], v[16:19], v[8:11], v[192:207]
    ds_read_b64_tr_b16 v[54:55], v105 offset:13312
    v_cvt_pk_bf16_f32 v72, v68, v69
    v_cvt_pk_bf16_f32 v73, v70, v71
    v_xor_b32 v68, 16, v88
    ds_write_b64 v68, v[72:73]
    v_accvgpr_read_b32 v74, a232
    v_mfma_f32_32x32x16_bf16 v[208:223], v[20:23], v[8:11], v[208:223]
    ds_read_b128 v[36:39], v87 offset:4096
    v_accvgpr_read_b32 v75, a233
    v_accvgpr_read_b32 v76, a234
    v_accvgpr_read_b32 v77, a235
    v_cvt_pk_bf16_f32 v78, v74, v75
    v_cvt_pk_bf16_f32 v79, v76, v77
    v_mfma_f32_32x32x16_bf16 v[224:239], v[16:19], v[12:15], v[224:239]
    ds_read_b128 v[40:43], v87 offset:8192
    v_xor_b32 v74, 32, v88
    ds_write_b64 v74, v[78:79]
    v_accvgpr_read_b32 v122, a236
    v_accvgpr_read_b32 v123, a237
    v_accvgpr_read_b32 v124, a238
    v_mfma_f32_32x32x16_bf16 v[240:255], v[20:23], v[12:15], v[240:255]
    ds_read_b128 v[44:47], v87 offset:12288
    v_accvgpr_read_b32 v125, a239
    v_cvt_pk_bf16_f32 v126, v122, v123
    v_cvt_pk_bf16_f32 v127, v124, v125
    v_xor_b32 v122, 48, v88
    ds_write_b64 v122, v[126:127]
    s_waitcnt lgkmcnt(0)
    s_waitcnt vmcnt(8)
    s_barrier
    v_mfma_f32_32x32x16_bf16 v[128:143], v[48:51], v[32:35], v[128:143]
    v_add_u32 v84, 0xfffe8000, v84
    v_add_u32 v85, 0xfffe8000, v85
    v_accvgpr_read_b32 v68, a240
    v_accvgpr_read_b32 v69, a241
    v_accvgpr_read_b32 v70, a242
    v_accvgpr_read_b32 v71, a243
    v_mfma_f32_32x32x16_bf16 v[144:159], v[52:55], v[32:35], v[144:159]
    v_add_u32 v86, 0xfffe8000, v86
    v_add_u32 v87, 0xfffe8000, v87
    v_cvt_pk_bf16_f32 v72, v68, v69
    v_cvt_pk_bf16_f32 v73, v70, v71
    v_xor_b32 v68, 64, v88
    ds_write_b64 v68, v[72:73]
    v_mfma_f32_32x32x16_bf16 v[160:175], v[48:51], v[36:39], v[160:175]
    v_add_u32 v104, 0xfffe8000, v104
    v_add_u32 v105, 0xfffe8000, v105
    v_accvgpr_read_b32 v74, a244
    v_accvgpr_read_b32 v75, a245
    v_accvgpr_read_b32 v76, a246
    v_accvgpr_read_b32 v77, a247
    v_mfma_f32_32x32x16_bf16 v[176:191], v[52:55], v[36:39], v[176:191]
    ds_read_b128 v[0:3], v84 offset:0
    v_cvt_pk_bf16_f32 v78, v74, v75
    v_cvt_pk_bf16_f32 v79, v76, v77
    v_xor_b32 v74, 80, v88
    ds_write_b64 v74, v[78:79]
    v_mfma_f32_32x32x16_bf16 v[192:207], v[48:51], v[40:43], v[192:207]
    ds_read_b64_tr_b16 v[16:17], v104 offset:0
    ds_read_b64_tr_b16 v[18:19], v104 offset:1024
    v_accvgpr_read_b32 v122, a248
    v_accvgpr_read_b32 v123, a249
    v_accvgpr_read_b32 v124, a250
    v_accvgpr_read_b32 v125, a251
    v_mfma_f32_32x32x16_bf16 v[208:223], v[52:55], v[40:43], v[208:223]
    ds_read_b64_tr_b16 v[20:21], v105 offset:0
    ds_read_b64_tr_b16 v[22:23], v105 offset:1024
    v_cvt_pk_bf16_f32 v126, v122, v123
    v_cvt_pk_bf16_f32 v127, v124, v125
    v_xor_b32 v122, 96, v88
    ds_write_b64 v122, v[126:127]
    v_mfma_f32_32x32x16_bf16 v[224:239], v[48:51], v[44:47], v[224:239]
    ds_read_b128 v[4:7], v84 offset:4096
    ds_read_b128 v[8:11], v84 offset:8192
    v_accvgpr_read_b32 v68, a252
    v_accvgpr_read_b32 v69, a253
    v_accvgpr_read_b32 v70, a254
    v_accvgpr_read_b32 v71, a255
    v_mfma_f32_32x32x16_bf16 v[240:255], v[52:55], v[44:47], v[240:255]
    ds_read_b128 v[12:15], v84 offset:12288
    v_cvt_pk_bf16_f32 v72, v68, v69
    v_cvt_pk_bf16_f32 v73, v70, v71
    v_xor_b32 v68, 112, v88
    ds_write_b64 v68, v[72:73]
    s_waitcnt lgkmcnt(0)
    v_mfma_f32_32x32x16_bf16 v[128:143], v[16:19], v[0:3], v[128:143]
    ds_read_b128 v[32:35], v85 offset:0
    ds_read_b128 v[106:109], v89 offset:0
    v_mfma_f32_32x32x16_bf16 v[144:159], v[20:23], v[0:3], v[144:159]
    ds_read_b64_tr_b16 v[48:49], v104 offset:4096
    v_mfma_f32_32x32x16_bf16 v[160:175], v[16:19], v[4:7], v[160:175]
    ds_read_b64_tr_b16 v[50:51], v104 offset:5120
    ds_read_b128 v[110:113], v89 offset:1024
    v_mfma_f32_32x32x16_bf16 v[176:191], v[20:23], v[4:7], v[176:191]
    ds_read_b64_tr_b16 v[52:53], v105 offset:4096
    v_mfma_f32_32x32x16_bf16 v[192:207], v[16:19], v[8:11], v[192:207]
    ds_read_b64_tr_b16 v[54:55], v105 offset:5120
    ds_read_b128 v[114:117], v89 offset:2048
    v_mfma_f32_32x32x16_bf16 v[208:223], v[20:23], v[8:11], v[208:223]
    ds_read_b128 v[36:39], v85 offset:4096
    v_mfma_f32_32x32x16_bf16 v[224:239], v[16:19], v[12:15], v[224:239]
    ds_read_b128 v[40:43], v85 offset:8192
    ds_read_b128 v[118:121], v89 offset:3072
    v_mfma_f32_32x32x16_bf16 v[240:255], v[20:23], v[12:15], v[240:255]
    ds_read_b128 v[44:47], v85 offset:12288
    s_waitcnt lgkmcnt(0)
    v_mfma_f32_32x32x16_bf16 v[128:143], v[48:51], v[32:35], v[128:143]
    ds_read_b128 v[0:3], v86 offset:0
    s_mov_b32 s20, 786560
    v_mfma_f32_32x32x16_bf16 v[144:159], v[52:55], v[32:35], v[144:159]
    ds_read_b64_tr_b16 v[16:17], v104 offset:8192
    buffer_store_dwordx4 v[106:109], v90, s[12:15], s20 offen sc1
    v_mfma_f32_32x32x16_bf16 v[160:175], v[48:51], v[36:39], v[160:175]
    ds_read_b64_tr_b16 v[18:19], v104 offset:9216
    s_mov_b32 s20, 852096
    v_mfma_f32_32x32x16_bf16 v[176:191], v[52:55], v[36:39], v[176:191]
    ds_read_b64_tr_b16 v[20:21], v105 offset:8192
    buffer_store_dwordx4 v[110:113], v90, s[12:15], s20 offen sc1
    v_mfma_f32_32x32x16_bf16 v[192:207], v[48:51], v[40:43], v[192:207]
    ds_read_b64_tr_b16 v[22:23], v105 offset:9216
    s_mov_b32 s20, 917632
    v_mfma_f32_32x32x16_bf16 v[208:223], v[52:55], v[40:43], v[208:223]
    ds_read_b128 v[4:7], v86 offset:4096
    buffer_store_dwordx4 v[114:117], v90, s[12:15], s20 offen sc1
    v_mfma_f32_32x32x16_bf16 v[224:239], v[48:51], v[44:47], v[224:239]
    ds_read_b128 v[8:11], v86 offset:8192
    s_mov_b32 s20, 983168
    v_mfma_f32_32x32x16_bf16 v[240:255], v[52:55], v[44:47], v[240:255]
    ds_read_b128 v[12:15], v86 offset:12288
    buffer_store_dwordx4 v[118:121], v90, s[12:15], s20 offen sc1
    s_waitcnt lgkmcnt(0)
    v_mfma_f32_32x32x16_bf16 v[128:143], v[16:19], v[0:3], v[128:143]
    ds_read_b128 v[32:35], v87 offset:0
    v_mfma_f32_32x32x16_bf16 v[144:159], v[20:23], v[0:3], v[144:159]
    ds_read_b64_tr_b16 v[48:49], v104 offset:12288
    v_mfma_f32_32x32x16_bf16 v[160:175], v[16:19], v[4:7], v[160:175]
    ds_read_b64_tr_b16 v[50:51], v104 offset:13312
    v_mfma_f32_32x32x16_bf16 v[176:191], v[20:23], v[4:7], v[176:191]
    ds_read_b64_tr_b16 v[52:53], v105 offset:12288
    v_mfma_f32_32x32x16_bf16 v[192:207], v[16:19], v[8:11], v[192:207]
    ds_read_b64_tr_b16 v[54:55], v105 offset:13312
    v_mfma_f32_32x32x16_bf16 v[208:223], v[20:23], v[8:11], v[208:223]
    ds_read_b128 v[36:39], v87 offset:4096
    v_mfma_f32_32x32x16_bf16 v[224:239], v[16:19], v[12:15], v[224:239]
    ds_read_b128 v[40:43], v87 offset:8192
    v_mfma_f32_32x32x16_bf16 v[240:255], v[20:23], v[12:15], v[240:255]
    ds_read_b128 v[44:47], v87 offset:12288
    s_waitcnt lgkmcnt(0)
    v_mfma_f32_32x32x16_bf16 v[128:143], v[48:51], v[32:35], v[128:143]
    v_mfma_f32_32x32x16_bf16 v[144:159], v[52:55], v[32:35], v[144:159]
    v_mfma_f32_32x32x16_bf16 v[160:175], v[48:51], v[36:39], v[160:175]
    v_mfma_f32_32x32x16_bf16 v[176:191], v[52:55], v[36:39], v[176:191]
    v_mfma_f32_32x32x16_bf16 v[192:207], v[48:51], v[40:43], v[192:207]
    v_mfma_f32_32x32x16_bf16 v[208:223], v[52:55], v[40:43], v[208:223]
    v_mfma_f32_32x32x16_bf16 v[224:239], v[48:51], v[44:47], v[224:239]
    v_mfma_f32_32x32x16_bf16 v[240:255], v[52:55], v[44:47], v[240:255]
    s_barrier
    s_nop 7
    s_and_b32 s25, s16, 1
    s_lshr_b32 s26, s16, 1
    s_lshl_b32 s25, s25, 7
    s_lshl_b32 s26, s26, 6
    s_add_u32 s25, s25, s22
    s_add_u32 s26, s26, s24
    s_mul_i32 s31, s16, 18432
    v_mul_u32_u24 v88, 144, v66
    v_lshl_add_u32 v88, v65, 3, v88
    v_add_u32 v88, s31, v88
    v_lshrrev_b32 v89, 3, v64
    v_mul_u32_u24 v89, 144, v89
    v_and_b32 v90, 7, v64
    v_lshl_add_u32 v89, v90, 4, v89
    v_add_u32 v89, s31, v89
    v_lshrrev_b32 v91, 3, v64
    v_add_u32 v91, s25, v91
    v_lshlrev_b32 v91, 13, v91
    v_lshl_add_u32 v90, v90, 4, v91
    s_lshl_b32 s26, s26, 1
    v_add_u32 v90, s26, v90
    v_cvt_pk_bf16_f32 v0, v128, v129
    v_cvt_pk_bf16_f32 v1, v130, v131
    ds_write_b64 v88, v[0:1] offset:0
    v_cvt_pk_bf16_f32 v2, v132, v133
    v_cvt_pk_bf16_f32 v3, v134, v135
    ds_write_b64 v88, v[2:3] offset:16
    v_cvt_pk_bf16_f32 v4, v136, v137
    v_cvt_pk_bf16_f32 v5, v138, v139
    ds_write_b64 v88, v[4:5] offset:32
    v_cvt_pk_bf16_f32 v6, v140, v141
    v_cvt_pk_bf16_f32 v7, v142, v143
    ds_write_b64 v88, v[6:7] offset:48
    v_cvt_pk_bf16_f32 v8, v144, v145
    v_cvt_pk_bf16_f32 v9, v146, v147
    ds_write_b64 v88, v[8:9] offset:64
    v_cvt_pk_bf16_f32 v10, v148, v149
    v_cvt_pk_bf16_f32 v11, v150, v151
    ds_write_b64 v88, v[10:11] offset:80
    v_cvt_pk_bf16_f32 v12, v152, v153
    v_cvt_pk_bf16_f32 v13, v154, v155
    ds_write_b64 v88, v[12:13] offset:96
    v_cvt_pk_bf16_f32 v14, v156, v157
    v_cvt_pk_bf16_f32 v15, v158, v159
    ds_write_b64 v88, v[14:15] offset:112
    v_cvt_pk_bf16_f32 v16, v160, v161
    v_cvt_pk_bf16_f32 v17, v162, v163
    ds_write_b64 v88, v[16:17] offset:4608
    v_cvt_pk_bf16_f32 v18, v164, v165
    v_cvt_pk_bf16_f32 v19, v166, v167
    ds_write_b64 v88, v[18:19] offset:4624
    v_cvt_pk_bf16_f32 v20, v168, v169
    v_cvt_pk_bf16_f32 v21, v170, v171
    ds_write_b64 v88, v[20:21] offset:4640
    v_cvt_pk_bf16_f32 v22, v172, v173
    v_cvt_pk_bf16_f32 v23, v174, v175
    ds_write_b64 v88, v[22:23] offset:4656
    v_cvt_pk_bf16_f32 v24, v176, v177
    v_cvt_pk_bf16_f32 v25, v178, v179
    ds_write_b64 v88, v[24:25] offset:4672
    v_cvt_pk_bf16_f32 v26, v180, v181
    v_cvt_pk_bf16_f32 v27, v182, v183
    ds_write_b64 v88, v[26:27] offset:4688
    v_cvt_pk_bf16_f32 v28, v184, v185
    v_cvt_pk_bf16_f32 v29, v186, v187
    ds_write_b64 v88, v[28:29] offset:4704
    v_cvt_pk_bf16_f32 v30, v188, v189
    v_cvt_pk_bf16_f32 v31, v190, v191
    ds_write_b64 v88, v[30:31] offset:4720
    v_cvt_pk_bf16_f32 v0, v192, v193
    v_cvt_pk_bf16_f32 v1, v194, v195
    ds_write_b64 v88, v[0:1] offset:9216
    v_cvt_pk_bf16_f32 v2, v196, v197
    v_cvt_pk_bf16_f32 v3, v198, v199
    ds_write_b64 v88, v[2:3] offset:9232
    v_cvt_pk_bf16_f32 v4, v200, v201
    v_cvt_pk_bf16_f32 v5, v202, v203
    ds_write_b64 v88, v[4:5] offset:9248
    v_cvt_pk_bf16_f32 v6, v204, v205
    v_cvt_pk_bf16_f32 v7, v206, v207
    ds_write_b64 v88, v[6:7] offset:9264
    v_cvt_pk_bf16_f32 v8, v208, v209
    v_cvt_pk_bf16_f32 v9, v210, v211
    ds_write_b64 v88, v[8:9] offset:9280
    v_cvt_pk_bf16_f32 v10, v212, v213
    v_cvt_pk_bf16_f32 v11, v214, v215
    ds_write_b64 v88, v[10:11] offset:9296
    v_cvt_pk_bf16_f32 v12, v216, v217
    v_cvt_pk_bf16_f32 v13, v218, v219
    ds_write_b64 v88, v[12:13] offset:9312
    v_cvt_pk_bf16_f32 v14, v220, v221
    v_cvt_pk_bf16_f32 v15, v222, v223
    ds_write_b64 v88, v[14:15] offset:9328
    v_cvt_pk_bf16_f32 v16, v224, v225
    v_cvt_pk_bf16_f32 v17, v226, v227
    ds_write_b64 v88, v[16:17] offset:13824
    v_cvt_pk_bf16_f32 v18, v228, v229
    v_cvt_pk_bf16_f32 v19, v230, v231
    ds_write_b64 v88, v[18:19] offset:13840
    v_cvt_pk_bf16_f32 v20, v232, v233
    v_cvt_pk_bf16_f32 v21, v234, v235
    ds_write_b64 v88, v[20:21] offset:13856
    v_cvt_pk_bf16_f32 v22, v236, v237
    v_cvt_pk_bf16_f32 v23, v238, v239
    ds_write_b64 v88, v[22:23] offset:13872
    v_cvt_pk_bf16_f32 v24, v240, v241
    v_cvt_pk_bf16_f32 v25, v242, v243
    ds_write_b64 v88, v[24:25] offset:13888
    v_cvt_pk_bf16_f32 v26, v244, v245
    v_cvt_pk_bf16_f32 v27, v246, v247
    ds_write_b64 v88, v[26:27] offset:13904
    v_cvt_pk_bf16_f32 v28, v248, v249
    v_cvt_pk_bf16_f32 v29, v250, v251
    ds_write_b64 v88, v[28:29] offset:13920
    v_cvt_pk_bf16_f32 v30, v252, v253
    v_cvt_pk_bf16_f32 v31, v254, v255
    ds_write_b64 v88, v[30:31] offset:13936
    s_waitcnt lgkmcnt(0)
    ds_read_b128 v[128:131], v89 offset:0
    ds_read_b128 v[132:135], v89 offset:1152
    ds_read_b128 v[136:139], v89 offset:2304
    ds_read_b128 v[140:143], v89 offset:3456
    ds_read_b128 v[144:147], v89 offset:4608
    ds_read_b128 v[148:151], v89 offset:5760
    ds_read_b128 v[152:155], v89 offset:6912
    ds_read_b128 v[156:159], v89 offset:8064
    ds_read_b128 v[160:163], v89 offset:9216
    ds_read_b128 v[164:167], v89 offset:10368
    ds_read_b128 v[168:171], v89 offset:11520
    ds_read_b128 v[172:175], v89 offset:12672
    ds_read_b128 v[176:179], v89 offset:13824
    ds_read_b128 v[180:183], v89 offset:14976
    ds_read_b128 v[184:187], v89 offset:16128
    ds_read_b128 v[188:191], v89 offset:17280
    s_waitcnt lgkmcnt(15)
    s_mov_b32 s25, 0
    buffer_store_dwordx4 v[128:131], v90, s[56:59], s25 offen sc1
    s_waitcnt lgkmcnt(14)
    s_mov_b32 s25, 65536
    buffer_store_dwordx4 v[132:135], v90, s[56:59], s25 offen sc1
    s_waitcnt lgkmcnt(13)
    s_mov_b32 s25, 131072
    buffer_store_dwordx4 v[136:139], v90, s[56:59], s25 offen sc1
    s_waitcnt lgkmcnt(12)
    s_mov_b32 s25, 196608
    buffer_store_dwordx4 v[140:143], v90, s[56:59], s25 offen sc1
    s_waitcnt lgkmcnt(11)
    s_mov_b32 s25, 262144
    buffer_store_dwordx4 v[144:147], v90, s[56:59], s25 offen sc1
    s_waitcnt lgkmcnt(10)
    s_mov_b32 s25, 327680
    buffer_store_dwordx4 v[148:151], v90, s[56:59], s25 offen sc1
    s_waitcnt lgkmcnt(9)
    s_mov_b32 s25, 393216
    buffer_store_dwordx4 v[152:155], v90, s[56:59], s25 offen sc1
    s_waitcnt lgkmcnt(8)
    s_mov_b32 s25, 458752
    buffer_store_dwordx4 v[156:159], v90, s[56:59], s25 offen sc1
    s_waitcnt lgkmcnt(7)
    s_mov_b32 s25, 524288
    buffer_store_dwordx4 v[160:163], v90, s[56:59], s25 offen sc1
    s_waitcnt lgkmcnt(6)
    s_mov_b32 s25, 589824
    buffer_store_dwordx4 v[164:167], v90, s[56:59], s25 offen sc1
    s_waitcnt lgkmcnt(5)
    s_mov_b32 s25, 655360
    buffer_store_dwordx4 v[168:171], v90, s[56:59], s25 offen sc1
    s_waitcnt lgkmcnt(4)
    s_mov_b32 s25, 720896
    buffer_store_dwordx4 v[172:175], v90, s[56:59], s25 offen sc1
    s_waitcnt lgkmcnt(3)
    s_mov_b32 s25, 786432
    buffer_store_dwordx4 v[176:179], v90, s[56:59], s25 offen sc1
    s_waitcnt lgkmcnt(2)
    s_mov_b32 s25, 851968
    buffer_store_dwordx4 v[180:183], v90, s[56:59], s25 offen sc1
    s_waitcnt lgkmcnt(1)
    s_mov_b32 s25, 917504
    buffer_store_dwordx4 v[184:187], v90, s[56:59], s25 offen sc1
    s_waitcnt lgkmcnt(0)
    s_mov_b32 s25, 983040
    buffer_store_dwordx4 v[188:191], v90, s[56:59], s25 offen sc1
    s_endpgm
L_proj_m1:
    s_waitcnt lgkmcnt(0)
    v_mfma_f32_32x32x16_bf16 a[0:15], v[0:3], v[16:19], 0
    s_add_u32 m0, s17, 32768
    ds_read_b128 v[32:35], v85 offset:0
    buffer_load_dwordx4 v76, s[8:11], s19 offen lds
    v_mfma_f32_32x32x16_bf16 a[16:31], v[0:3], v[20:23], 0
    s_add_u32 m0, s17, 33792
    ds_read_b64_tr_b16 v[48:49], v88 offset:8192
    buffer_load_dwordx4 v77, s[8:11], s19 offen lds
    v_mfma_f32_32x32x16_bf16 a[32:47], v[0:3], v[24:27], 0
    ds_read_b64_tr_b16 v[50:51], v88 offset:10240
    v_mfma_f32_32x32x16_bf16 a[48:63], v[0:3], v[28:31], 0
    s_add_u32 m0, s17, 34816
    ds_read_b64_tr_b16 v[52:53], v89 offset:8192
    buffer_load_dwordx4 v78, s[8:11], s19 offen lds
    v_mfma_f32_32x32x16_bf16 a[64:79], v[4:7], v[16:19], 0
    ds_read_b64_tr_b16 v[54:55], v89 offset:10240
    v_mfma_f32_32x32x16_bf16 a[80:95], v[4:7], v[20:23], 0
    s_add_u32 m0, s17, 35840
    ds_read_b128 v[36:39], v85 offset:4096
    buffer_load_dwordx4 v79, s[8:11], s19 offen lds
    v_mfma_f32_32x32x16_bf16 a[96:111], v[4:7], v[24:27], 0
    ds_read_b64_tr_b16 v[56:57], v90 offset:8192
    v_mfma_f32_32x32x16_bf16 a[112:127], v[4:7], v[28:31], 0
    s_add_u32 m0, s17, 36864
    ds_read_b64_tr_b16 v[58:59], v90 offset:10240
    buffer_load_dwordx4 v80, s[8:11], s19 offen lds
    v_mfma_f32_32x32x16_bf16 a[128:143], v[8:11], v[16:19], 0
    s_add_u32 m0, s17, 37888
    ds_read_b64_tr_b16 v[60:61], v91 offset:8192
    buffer_load_dwordx4 v81, s[8:11], s19 offen lds
    v_mfma_f32_32x32x16_bf16 a[144:159], v[8:11], v[20:23], 0
    ds_read_b64_tr_b16 v[62:63], v91 offset:10240
    v_mfma_f32_32x32x16_bf16 a[160:175], v[8:11], v[24:27], 0
    s_add_u32 m0, s17, 38912
    ds_read_b128 v[40:43], v85 offset:8192
    buffer_load_dwordx4 v82, s[8:11], s19 offen lds
    v_mfma_f32_32x32x16_bf16 a[176:191], v[8:11], v[28:31], 0
    ds_read_b128 v[44:47], v85 offset:12288
    s_add_u32 m0, s17, 39936
    v_mfma_f32_32x32x16_bf16 a[192:207], v[12:15], v[16:19], 0
    buffer_load_dwordx4 v83, s[8:11], s19 offen lds
    v_mfma_f32_32x32x16_bf16 a[208:223], v[12:15], v[20:23], 0
    v_mfma_f32_32x32x16_bf16 a[224:239], v[12:15], v[24:27], 0
    s_add_u32 s19, s19, 0x80000
    s_xor_b32 s17, s17, 0x10000
    v_mfma_f32_32x32x16_bf16 a[240:255], v[12:15], v[28:31], 0
    s_waitcnt lgkmcnt(0)
    v_mfma_f32_32x32x16_bf16 a[0:15], v[32:35], v[48:51], a[0:15]
    ds_read_b128 v[0:3], v86 offset:0
    v_mfma_f32_32x32x16_bf16 a[16:31], v[32:35], v[52:55], a[16:31]
    ds_read_b64_tr_b16 v[16:17], v88 offset:16384
    v_mfma_f32_32x32x16_bf16 a[32:47], v[32:35], v[56:59], a[32:47]
    ds_read_b64_tr_b16 v[18:19], v88 offset:18432
    v_mfma_f32_32x32x16_bf16 a[48:63], v[32:35], v[60:63], a[48:63]
    ds_read_b64_tr_b16 v[20:21], v89 offset:16384
    v_mfma_f32_32x32x16_bf16 a[64:79], v[36:39], v[48:51], a[64:79]
    ds_read_b64_tr_b16 v[22:23], v89 offset:18432
    v_mfma_f32_32x32x16_bf16 a[80:95], v[36:39], v[52:55], a[80:95]
    ds_read_b128 v[4:7], v86 offset:4096
    v_mfma_f32_32x32x16_bf16 a[96:111], v[36:39], v[56:59], a[96:111]
    ds_read_b64_tr_b16 v[24:25], v90 offset:16384
    v_mfma_f32_32x32x16_bf16 a[112:127], v[36:39], v[60:63], a[112:127]
    ds_read_b64_tr_b16 v[26:27], v90 offset:18432
    v_mfma_f32_32x32x16_bf16 a[128:143], v[40:43], v[48:51], a[128:143]
    ds_read_b64_tr_b16 v[28:29], v91 offset:16384
    v_mfma_f32_32x32x16_bf16 a[144:159], v[40:43], v[52:55], a[144:159]
    ds_read_b64_tr_b16 v[30:31], v91 offset:18432
    v_mfma_f32_32x32x16_bf16 a[160:175], v[40:43], v[56:59], a[160:175]
    ds_read_b128 v[8:11], v86 offset:8192
    v_mfma_f32_32x32x16_bf16 a[176:191], v[40:43], v[60:63], a[176:191]
    ds_read_b128 v[12:15], v86 offset:12288
    v_mfma_f32_32x32x16_bf16 a[192:207], v[44:47], v[48:51], a[192:207]
    v_mfma_f32_32x32x16_bf16 a[208:223], v[44:47], v[52:55], a[208:223]
    v_mfma_f32_32x32x16_bf16 a[224:239], v[44:47], v[56:59], a[224:239]
    v_mfma_f32_32x32x16_bf16 a[240:255], v[44:47], v[60:63], a[240:255]
    s_waitcnt lgkmcnt(0)
    v_mfma_f32_32x32x16_bf16 a[0:15], v[0:3], v[16:19], a[0:15]
    ds_read_b128 v[32:35], v87 offset:0
    v_mfma_f32_32x32x16_bf16 a[16:31], v[0:3], v[20:23], a[16:31]
    ds_read_b64_tr_b16 v[48:49], v88 offset:24576
    v_mfma_f32_32x32x16_bf16 a[32:47], v[0:3], v[24:27], a[32:47]
    ds_read_b64_tr_b16 v[50:51], v88 offset:26624
    v_mfma_f32_32x32x16_bf16 a[48:63], v[0:3], v[28:31], a[48:63]
    ds_read_b64_tr_b16 v[52:53], v89 offset:24576
    v_mfma_f32_32x32x16_bf16 a[64:79], v[4:7], v[16:19], a[64:79]
    ds_read_b64_tr_b16 v[54:55], v89 offset:26624
    v_mfma_f32_32x32x16_bf16 a[80:95], v[4:7], v[20:23], a[80:95]
    ds_read_b128 v[36:39], v87 offset:4096
    v_mfma_f32_32x32x16_bf16 a[96:111], v[4:7], v[24:27], a[96:111]
    ds_read_b64_tr_b16 v[56:57], v90 offset:24576
    v_mfma_f32_32x32x16_bf16 a[112:127], v[4:7], v[28:31], a[112:127]
    ds_read_b64_tr_b16 v[58:59], v90 offset:26624
    v_mfma_f32_32x32x16_bf16 a[128:143], v[8:11], v[16:19], a[128:143]
    ds_read_b64_tr_b16 v[60:61], v91 offset:24576
    v_mfma_f32_32x32x16_bf16 a[144:159], v[8:11], v[20:23], a[144:159]
    ds_read_b64_tr_b16 v[62:63], v91 offset:26624
    v_mfma_f32_32x32x16_bf16 a[160:175], v[8:11], v[24:27], a[160:175]
    ds_read_b128 v[40:43], v87 offset:8192
    v_mfma_f32_32x32x16_bf16 a[176:191], v[8:11], v[28:31], a[176:191]
    ds_read_b128 v[44:47], v87 offset:12288
    v_mfma_f32_32x32x16_bf16 a[192:207], v[12:15], v[16:19], a[192:207]
    v_mfma_f32_32x32x16_bf16 a[208:223], v[12:15], v[20:23], a[208:223]
    v_mfma_f32_32x32x16_bf16 a[224:239], v[12:15], v[24:27], a[224:239]
    v_mfma_f32_32x32x16_bf16 a[240:255], v[12:15], v[28:31], a[240:255]
    s_waitcnt lgkmcnt(0)
    s_waitcnt vmcnt(0)
    s_barrier
    v_mfma_f32_32x32x16_bf16 a[0:15], v[32:35], v[48:51], a[0:15]
    v_xor_b32 v84, 0x10000, v84
    s_add_u32 m0, s17, 0
    v_xor_b32 v85, 0x10000, v85
    buffer_load_dwordx4 v68, s[4:7], s18 offen lds
    v_mfma_f32_32x32x16_bf16 a[16:31], v[32:35], v[52:55], a[16:31]
    s_add_u32 m0, s17, 1024
    v_xor_b32 v86, 0x10000, v86
    buffer_load_dwordx4 v69, s[4:7], s18 offen lds
    v_mfma_f32_32x32x16_bf16 a[32:47], v[32:35], v[56:59], a[32:47]
    v_xor_b32 v87, 0x10000, v87
    v_mfma_f32_32x32x16_bf16 a[48:63], v[32:35], v[60:63], a[48:63]
    s_add_u32 m0, s17, 2048
    v_xor_b32 v88, 0x10000, v88
    buffer_load_dwordx4 v70, s[4:7], s18 offen lds
    v_mfma_f32_32x32x16_bf16 a[64:79], v[36:39], v[48:51], a[64:79]
    v_xor_b32 v89, 0x10000, v89
    v_xor_b32 v90, 0x10000, v90
    v_mfma_f32_32x32x16_bf16 a[80:95], v[36:39], v[52:55], a[80:95]
    s_add_u32 m0, s17, 3072
    v_xor_b32 v91, 0x10000, v91
    buffer_load_dwordx4 v71, s[4:7], s18 offen lds
    v_mfma_f32_32x32x16_bf16 a[96:111], v[36:39], v[56:59], a[96:111]
    ds_read_b128 v[0:3], v84 offset:0
    v_mfma_f32_32x32x16_bf16 a[112:127], v[36:39], v[60:63], a[112:127]
    s_add_u32 m0, s17, 4096
    ds_read_b64_tr_b16 v[16:17], v88 offset:0
    buffer_load_dwordx4 v72, s[4:7], s18 offen lds
    v_mfma_f32_32x32x16_bf16 a[128:143], v[40:43], v[48:51], a[128:143]
    ds_read_b64_tr_b16 v[18:19], v88 offset:2048
    s_add_u32 m0, s17, 5120
    ds_read_b64_tr_b16 v[20:21], v89 offset:0
    buffer_load_dwordx4 v73, s[4:7], s18 offen lds
    v_mfma_f32_32x32x16_bf16 a[144:159], v[40:43], v[52:55], a[144:159]
    ds_read_b64_tr_b16 v[22:23], v89 offset:2048
    v_mfma_f32_32x32x16_bf16 a[160:175], v[40:43], v[56:59], a[160:175]
    s_add_u32 m0, s17, 6144
    ds_read_b128 v[4:7], v84 offset:4096
    buffer_load_dwordx4 v74, s[4:7], s18 offen lds
    v_mfma_f32_32x32x16_bf16 a[176:191], v[40:43], v[60:63], a[176:191]
    ds_read_b64_tr_b16 v[24:25], v90 offset:0
    v_mfma_f32_32x32x16_bf16 a[192:207], v[44:47], v[48:51], a[192:207]
    ds_read_b64_tr_b16 v[26:27], v90 offset:2048
    s_add_u32 m0, s17, 7168
    ds_read_b64_tr_b16 v[28:29], v91 offset:0
    buffer_load_dwordx4 v75, s[4:7], s18 offen lds
    v_mfma_f32_32x32x16_bf16 a[208:223], v[44:47], v[52:55], a[208:223]
    ds_read_b64_tr_b16 v[30:31], v91 offset:2048
    v_mfma_f32_32x32x16_bf16 a[224:239], v[44:47], v[56:59], a[224:239]
    ds_read_b128 v[8:11], v84 offset:8192
    s_add_u32 s18, s18, 128
    v_mfma_f32_32x32x16_bf16 a[240:255], v[44:47], v[60:63], a[240:255]
    ds_read_b128 v[12:15], v84 offset:12288
    s_mov_b32 s20, 13
L_proj_loop1:
    s_waitcnt lgkmcnt(0)
    v_mfma_f32_32x32x16_bf16 a[0:15], v[0:3], v[16:19], a[0:15]
    s_add_u32 m0, s17, 32768
    ds_read_b128 v[32:35], v85 offset:0
    buffer_load_dwordx4 v76, s[8:11], s19 offen lds
    v_mfma_f32_32x32x16_bf16 a[16:31], v[0:3], v[20:23], a[16:31]
    s_add_u32 m0, s17, 33792
    ds_read_b64_tr_b16 v[48:49], v88 offset:8192
    buffer_load_dwordx4 v77, s[8:11], s19 offen lds
    v_mfma_f32_32x32x16_bf16 a[32:47], v[0:3], v[24:27], a[32:47]
    ds_read_b64_tr_b16 v[50:51], v88 offset:10240
    v_mfma_f32_32x32x16_bf16 a[48:63], v[0:3], v[28:31], a[48:63]
    s_add_u32 m0, s17, 34816
    ds_read_b64_tr_b16 v[52:53], v89 offset:8192
    buffer_load_dwordx4 v78, s[8:11], s19 offen lds
    v_mfma_f32_32x32x16_bf16 a[64:79], v[4:7], v[16:19], a[64:79]
    ds_read_b64_tr_b16 v[54:55], v89 offset:10240
    v_mfma_f32_32x32x16_bf16 a[80:95], v[4:7], v[20:23], a[80:95]
    s_add_u32 m0, s17, 35840
    ds_read_b128 v[36:39], v85 offset:4096
    buffer_load_dwordx4 v79, s[8:11], s19 offen lds
    v_mfma_f32_32x32x16_bf16 a[96:111], v[4:7], v[24:27], a[96:111]
    ds_read_b64_tr_b16 v[56:57], v90 offset:8192
    v_mfma_f32_32x32x16_bf16 a[112:127], v[4:7], v[28:31], a[112:127]
    s_add_u32 m0, s17, 36864
    ds_read_b64_tr_b16 v[58:59], v90 offset:10240
    buffer_load_dwordx4 v80, s[8:11], s19 offen lds
    v_mfma_f32_32x32x16_bf16 a[128:143], v[8:11], v[16:19], a[128:143]
    s_add_u32 m0, s17, 37888
    ds_read_b64_tr_b16 v[60:61], v91 offset:8192
    buffer_load_dwordx4 v81, s[8:11], s19 offen lds
    v_mfma_f32_32x32x16_bf16 a[144:159], v[8:11], v[20:23], a[144:159]
    ds_read_b64_tr_b16 v[62:63], v91 offset:10240
    v_mfma_f32_32x32x16_bf16 a[160:175], v[8:11], v[24:27], a[160:175]
    s_add_u32 m0, s17, 38912
    ds_read_b128 v[40:43], v85 offset:8192
    buffer_load_dwordx4 v82, s[8:11], s19 offen lds
    v_mfma_f32_32x32x16_bf16 a[176:191], v[8:11], v[28:31], a[176:191]
    ds_read_b128 v[44:47], v85 offset:12288
    s_add_u32 m0, s17, 39936
    v_mfma_f32_32x32x16_bf16 a[192:207], v[12:15], v[16:19], a[192:207]
    buffer_load_dwordx4 v83, s[8:11], s19 offen lds
    v_mfma_f32_32x32x16_bf16 a[208:223], v[12:15], v[20:23], a[208:223]
    v_mfma_f32_32x32x16_bf16 a[224:239], v[12:15], v[24:27], a[224:239]
    s_add_u32 s19, s19, 0x80000
    s_xor_b32 s17, s17, 0x10000
    v_mfma_f32_32x32x16_bf16 a[240:255], v[12:15], v[28:31], a[240:255]
    s_waitcnt lgkmcnt(0)
    v_mfma_f32_32x32x16_bf16 a[0:15], v[32:35], v[48:51], a[0:15]
    ds_read_b128 v[0:3], v86 offset:0
    v_mfma_f32_32x32x16_bf16 a[16:31], v[32:35], v[52:55], a[16:31]
    ds_read_b64_tr_b16 v[16:17], v88 offset:16384
    v_mfma_f32_32x32x16_bf16 a[32:47], v[32:35], v[56:59], a[32:47]
    ds_read_b64_tr_b16 v[18:19], v88 offset:18432
    v_mfma_f32_32x32x16_bf16 a[48:63], v[32:35], v[60:63], a[48:63]
    ds_read_b64_tr_b16 v[20:21], v89 offset:16384
    v_mfma_f32_32x32x16_bf16 a[64:79], v[36:39], v[48:51], a[64:79]
    ds_read_b64_tr_b16 v[22:23], v89 offset:18432
    v_mfma_f32_32x32x16_bf16 a[80:95], v[36:39], v[52:55], a[80:95]
    ds_read_b128 v[4:7], v86 offset:4096
    v_mfma_f32_32x32x16_bf16 a[96:111], v[36:39], v[56:59], a[96:111]
    ds_read_b64_tr_b16 v[24:25], v90 offset:16384
    v_mfma_f32_32x32x16_bf16 a[112:127], v[36:39], v[60:63], a[112:127]
    ds_read_b64_tr_b16 v[26:27], v90 offset:18432
    v_mfma_f32_32x32x16_bf16 a[128:143], v[40:43], v[48:51], a[128:143]
    ds_read_b64_tr_b16 v[28:29], v91 offset:16384
    v_mfma_f32_32x32x16_bf16 a[144:159], v[40:43], v[52:55], a[144:159]
    ds_read_b64_tr_b16 v[30:31], v91 offset:18432
    v_mfma_f32_32x32x16_bf16 a[160:175], v[40:43], v[56:59], a[160:175]
    ds_read_b128 v[8:11], v86 offset:8192
    v_mfma_f32_32x32x16_bf16 a[176:191], v[40:43], v[60:63], a[176:191]
    ds_read_b128 v[12:15], v86 offset:12288
    v_mfma_f32_32x32x16_bf16 a[192:207], v[44:47], v[48:51], a[192:207]
    v_mfma_f32_32x32x16_bf16 a[208:223], v[44:47], v[52:55], a[208:223]
    v_mfma_f32_32x32x16_bf16 a[224:239], v[44:47], v[56:59], a[224:239]
    v_mfma_f32_32x32x16_bf16 a[240:255], v[44:47], v[60:63], a[240:255]
    s_waitcnt lgkmcnt(0)
    v_mfma_f32_32x32x16_bf16 a[0:15], v[0:3], v[16:19], a[0:15]
    ds_read_b128 v[32:35], v87 offset:0
    v_mfma_f32_32x32x16_bf16 a[16:31], v[0:3], v[20:23], a[16:31]
    ds_read_b64_tr_b16 v[48:49], v88 offset:24576
    v_mfma_f32_32x32x16_bf16 a[32:47], v[0:3], v[24:27], a[32:47]
    ds_read_b64_tr_b16 v[50:51], v88 offset:26624
    v_mfma_f32_32x32x16_bf16 a[48:63], v[0:3], v[28:31], a[48:63]
    ds_read_b64_tr_b16 v[52:53], v89 offset:24576
    v_mfma_f32_32x32x16_bf16 a[64:79], v[4:7], v[16:19], a[64:79]
    ds_read_b64_tr_b16 v[54:55], v89 offset:26624
    v_mfma_f32_32x32x16_bf16 a[80:95], v[4:7], v[20:23], a[80:95]
    ds_read_b128 v[36:39], v87 offset:4096
    v_mfma_f32_32x32x16_bf16 a[96:111], v[4:7], v[24:27], a[96:111]
    ds_read_b64_tr_b16 v[56:57], v90 offset:24576
    v_mfma_f32_32x32x16_bf16 a[112:127], v[4:7], v[28:31], a[112:127]
    ds_read_b64_tr_b16 v[58:59], v90 offset:26624
    v_mfma_f32_32x32x16_bf16 a[128:143], v[8:11], v[16:19], a[128:143]
    ds_read_b64_tr_b16 v[60:61], v91 offset:24576
    v_mfma_f32_32x32x16_bf16 a[144:159], v[8:11], v[20:23], a[144:159]
    ds_read_b64_tr_b16 v[62:63], v91 offset:26624
    v_mfma_f32_32x32x16_bf16 a[160:175], v[8:11], v[24:27], a[160:175]
    ds_read_b128 v[40:43], v87 offset:8192
    v_mfma_f32_32x32x16_bf16 a[176:191], v[8:11], v[28:31], a[176:191]
    ds_read_b128 v[44:47], v87 offset:12288
    v_mfma_f32_32x32x16_bf16 a[192:207], v[12:15], v[16:19], a[192:207]
    v_mfma_f32_32x32x16_bf16 a[208:223], v[12:15], v[20:23], a[208:223]
    v_mfma_f32_32x32x16_bf16 a[224:239], v[12:15], v[24:27], a[224:239]
    v_mfma_f32_32x32x16_bf16 a[240:255], v[12:15], v[28:31], a[240:255]
    s_waitcnt lgkmcnt(0)
    s_waitcnt vmcnt(0)
    s_barrier
    v_mfma_f32_32x32x16_bf16 a[0:15], v[32:35], v[48:51], a[0:15]
    v_xor_b32 v84, 0x10000, v84
    s_add_u32 m0, s17, 0
    v_xor_b32 v85, 0x10000, v85
    buffer_load_dwordx4 v68, s[4:7], s18 offen lds
    v_mfma_f32_32x32x16_bf16 a[16:31], v[32:35], v[52:55], a[16:31]
    s_add_u32 m0, s17, 1024
    v_xor_b32 v86, 0x10000, v86
    buffer_load_dwordx4 v69, s[4:7], s18 offen lds
    v_mfma_f32_32x32x16_bf16 a[32:47], v[32:35], v[56:59], a[32:47]
    v_xor_b32 v87, 0x10000, v87
    v_mfma_f32_32x32x16_bf16 a[48:63], v[32:35], v[60:63], a[48:63]
    s_add_u32 m0, s17, 2048
    v_xor_b32 v88, 0x10000, v88
    buffer_load_dwordx4 v70, s[4:7], s18 offen lds
    v_mfma_f32_32x32x16_bf16 a[64:79], v[36:39], v[48:51], a[64:79]
    v_xor_b32 v89, 0x10000, v89
    v_xor_b32 v90, 0x10000, v90
    v_mfma_f32_32x32x16_bf16 a[80:95], v[36:39], v[52:55], a[80:95]
    s_add_u32 m0, s17, 3072
    v_xor_b32 v91, 0x10000, v91
    buffer_load_dwordx4 v71, s[4:7], s18 offen lds
    v_mfma_f32_32x32x16_bf16 a[96:111], v[36:39], v[56:59], a[96:111]
    ds_read_b128 v[0:3], v84 offset:0
    v_mfma_f32_32x32x16_bf16 a[112:127], v[36:39], v[60:63], a[112:127]
    s_add_u32 m0, s17, 4096
    ds_read_b64_tr_b16 v[16:17], v88 offset:0
    buffer_load_dwordx4 v72, s[4:7], s18 offen lds
    v_mfma_f32_32x32x16_bf16 a[128:143], v[40:43], v[48:51], a[128:143]
    ds_read_b64_tr_b16 v[18:19], v88 offset:2048
    s_add_u32 m0, s17, 5120
    ds_read_b64_tr_b16 v[20:21], v89 offset:0
    buffer_load_dwordx4 v73, s[4:7], s18 offen lds
    v_mfma_f32_32x32x16_bf16 a[144:159], v[40:43], v[52:55], a[144:159]
    ds_read_b64_tr_b16 v[22:23], v89 offset:2048
    v_mfma_f32_32x32x16_bf16 a[160:175], v[40:43], v[56:59], a[160:175]
    s_add_u32 m0, s17, 6144
    ds_read_b128 v[4:7], v84 offset:4096
    buffer_load_dwordx4 v74, s[4:7], s18 offen lds
    v_mfma_f32_32x32x16_bf16 a[176:191], v[40:43], v[60:63], a[176:191]
    ds_read_b64_tr_b16 v[24:25], v90 offset:0
    v_mfma_f32_32x32x16_bf16 a[192:207], v[44:47], v[48:51], a[192:207]
    ds_read_b64_tr_b16 v[26:27], v90 offset:2048
    s_add_u32 m0, s17, 7168
    ds_read_b64_tr_b16 v[28:29], v91 offset:0
    buffer_load_dwordx4 v75, s[4:7], s18 offen lds
    v_mfma_f32_32x32x16_bf16 a[208:223], v[44:47], v[52:55], a[208:223]
    ds_read_b64_tr_b16 v[30:31], v91 offset:2048
    v_mfma_f32_32x32x16_bf16 a[224:239], v[44:47], v[56:59], a[224:239]
    ds_read_b128 v[8:11], v84 offset:8192
    s_add_u32 s18, s18, 128
    v_mfma_f32_32x32x16_bf16 a[240:255], v[44:47], v[60:63], a[240:255]
    ds_read_b128 v[12:15], v84 offset:12288
    s_sub_u32 s20, s20, 1
    s_cmp_lg_u32 s20, 0
    s_cbranch_scc1 L_proj_loop1
    s_waitcnt lgkmcnt(0)
    v_mfma_f32_32x32x16_bf16 a[0:15], v[0:3], v[16:19], a[0:15]
    s_add_u32 m0, s17, 32768
    ds_read_b128 v[32:35], v85 offset:0
    buffer_load_dwordx4 v76, s[8:11], s19 offen lds
    v_mfma_f32_32x32x16_bf16 a[16:31], v[0:3], v[20:23], a[16:31]
    s_add_u32 m0, s17, 33792
    ds_read_b64_tr_b16 v[48:49], v88 offset:8192
    buffer_load_dwordx4 v77, s[8:11], s19 offen lds
    v_mfma_f32_32x32x16_bf16 a[32:47], v[0:3], v[24:27], a[32:47]
    ds_read_b64_tr_b16 v[50:51], v88 offset:10240
    v_mfma_f32_32x32x16_bf16 a[48:63], v[0:3], v[28:31], a[48:63]
    s_add_u32 m0, s17, 34816
    ds_read_b64_tr_b16 v[52:53], v89 offset:8192
    buffer_load_dwordx4 v78, s[8:11], s19 offen lds
    v_mfma_f32_32x32x16_bf16 a[64:79], v[4:7], v[16:19], a[64:79]
    ds_read_b64_tr_b16 v[54:55], v89 offset:10240
    v_mfma_f32_32x32x16_bf16 a[80:95], v[4:7], v[20:23], a[80:95]
    s_add_u32 m0, s17, 35840
    ds_read_b128 v[36:39], v85 offset:4096
    buffer_load_dwordx4 v79, s[8:11], s19 offen lds
    v_mfma_f32_32x32x16_bf16 a[96:111], v[4:7], v[24:27], a[96:111]
    ds_read_b64_tr_b16 v[56:57], v90 offset:8192
    v_mfma_f32_32x32x16_bf16 a[112:127], v[4:7], v[28:31], a[112:127]
    s_add_u32 m0, s17, 36864
    ds_read_b64_tr_b16 v[58:59], v90 offset:10240
    buffer_load_dwordx4 v80, s[8:11], s19 offen lds
    v_mfma_f32_32x32x16_bf16 a[128:143], v[8:11], v[16:19], a[128:143]
    s_add_u32 m0, s17, 37888
    ds_read_b64_tr_b16 v[60:61], v91 offset:8192
    buffer_load_dwordx4 v81, s[8:11], s19 offen lds
    v_mfma_f32_32x32x16_bf16 a[144:159], v[8:11], v[20:23], a[144:159]
    ds_read_b64_tr_b16 v[62:63], v91 offset:10240
    v_mfma_f32_32x32x16_bf16 a[160:175], v[8:11], v[24:27], a[160:175]
    s_add_u32 m0, s17, 38912
    ds_read_b128 v[40:43], v85 offset:8192
    buffer_load_dwordx4 v82, s[8:11], s19 offen lds
    v_mfma_f32_32x32x16_bf16 a[176:191], v[8:11], v[28:31], a[176:191]
    ds_read_b128 v[44:47], v85 offset:12288
    s_add_u32 m0, s17, 39936
    v_mfma_f32_32x32x16_bf16 a[192:207], v[12:15], v[16:19], a[192:207]
    buffer_load_dwordx4 v83, s[8:11], s19 offen lds
    v_mfma_f32_32x32x16_bf16 a[208:223], v[12:15], v[20:23], a[208:223]
    v_mfma_f32_32x32x16_bf16 a[224:239], v[12:15], v[24:27], a[224:239]
    s_add_u32 s19, s19, 0x80000
    s_xor_b32 s17, s17, 0x10000
    v_mfma_f32_32x32x16_bf16 a[240:255], v[12:15], v[28:31], a[240:255]
    s_waitcnt lgkmcnt(0)
    v_mfma_f32_32x32x16_bf16 a[0:15], v[32:35], v[48:51], a[0:15]
    ds_read_b128 v[0:3], v86 offset:0
    v_mfma_f32_32x32x16_bf16 a[16:31], v[32:35], v[52:55], a[16:31]
    ds_read_b64_tr_b16 v[16:17], v88 offset:16384
    v_mfma_f32_32x32x16_bf16 a[32:47], v[32:35], v[56:59], a[32:47]
    ds_read_b64_tr_b16 v[18:19], v88 offset:18432
    v_mfma_f32_32x32x16_bf16 a[48:63], v[32:35], v[60:63], a[48:63]
    ds_read_b64_tr_b16 v[20:21], v89 offset:16384
    v_mfma_f32_32x32x16_bf16 a[64:79], v[36:39], v[48:51], a[64:79]
    ds_read_b64_tr_b16 v[22:23], v89 offset:18432
    v_mfma_f32_32x32x16_bf16 a[80:95], v[36:39], v[52:55], a[80:95]
    ds_read_b128 v[4:7], v86 offset:4096
    v_mfma_f32_32x32x16_bf16 a[96:111], v[36:39], v[56:59], a[96:111]
    ds_read_b64_tr_b16 v[24:25], v90 offset:16384
    v_mfma_f32_32x32x16_bf16 a[112:127], v[36:39], v[60:63], a[112:127]
    ds_read_b64_tr_b16 v[26:27], v90 offset:18432
    v_mfma_f32_32x32x16_bf16 a[128:143], v[40:43], v[48:51], a[128:143]
    ds_read_b64_tr_b16 v[28:29], v91 offset:16384
    v_mfma_f32_32x32x16_bf16 a[144:159], v[40:43], v[52:55], a[144:159]
    ds_read_b64_tr_b16 v[30:31], v91 offset:18432
    v_mfma_f32_32x32x16_bf16 a[160:175], v[40:43], v[56:59], a[160:175]
    ds_read_b128 v[8:11], v86 offset:8192
    v_mfma_f32_32x32x16_bf16 a[176:191], v[40:43], v[60:63], a[176:191]
    ds_read_b128 v[12:15], v86 offset:12288
    v_mfma_f32_32x32x16_bf16 a[192:207], v[44:47], v[48:51], a[192:207]
    v_mfma_f32_32x32x16_bf16 a[208:223], v[44:47], v[52:55], a[208:223]
    v_mfma_f32_32x32x16_bf16 a[224:239], v[44:47], v[56:59], a[224:239]
    v_mfma_f32_32x32x16_bf16 a[240:255], v[44:47], v[60:63], a[240:255]
    s_waitcnt lgkmcnt(0)
    v_mfma_f32_32x32x16_bf16 a[0:15], v[0:3], v[16:19], a[0:15]
    ds_read_b128 v[32:35], v87 offset:0
    v_mfma_f32_32x32x16_bf16 a[16:31], v[0:3], v[20:23], a[16:31]
    ds_read_b64_tr_b16 v[48:49], v88 offset:24576
    v_mfma_f32_32x32x16_bf16 a[32:47], v[0:3], v[24:27], a[32:47]
    ds_read_b64_tr_b16 v[50:51], v88 offset:26624
    v_mfma_f32_32x32x16_bf16 a[48:63], v[0:3], v[28:31], a[48:63]
    ds_read_b64_tr_b16 v[52:53], v89 offset:24576
    v_mfma_f32_32x32x16_bf16 a[64:79], v[4:7], v[16:19], a[64:79]
    ds_read_b64_tr_b16 v[54:55], v89 offset:26624
    v_mfma_f32_32x32x16_bf16 a[80:95], v[4:7], v[20:23], a[80:95]
    ds_read_b128 v[36:39], v87 offset:4096
    v_mfma_f32_32x32x16_bf16 a[96:111], v[4:7], v[24:27], a[96:111]
    ds_read_b64_tr_b16 v[56:57], v90 offset:24576
    v_mfma_f32_32x32x16_bf16 a[112:127], v[4:7], v[28:31], a[112:127]
    ds_read_b64_tr_b16 v[58:59], v90 offset:26624
    v_mfma_f32_32x32x16_bf16 a[128:143], v[8:11], v[16:19], a[128:143]
    ds_read_b64_tr_b16 v[60:61], v91 offset:24576
    v_mfma_f32_32x32x16_bf16 a[144:159], v[8:11], v[20:23], a[144:159]
    ds_read_b64_tr_b16 v[62:63], v91 offset:26624
    v_mfma_f32_32x32x16_bf16 a[160:175], v[8:11], v[24:27], a[160:175]
    ds_read_b128 v[40:43], v87 offset:8192
    v_mfma_f32_32x32x16_bf16 a[176:191], v[8:11], v[28:31], a[176:191]
    ds_read_b128 v[44:47], v87 offset:12288
    v_mfma_f32_32x32x16_bf16 a[192:207], v[12:15], v[16:19], a[192:207]
    v_mfma_f32_32x32x16_bf16 a[208:223], v[12:15], v[20:23], a[208:223]
    v_mfma_f32_32x32x16_bf16 a[224:239], v[12:15], v[24:27], a[224:239]
    v_mfma_f32_32x32x16_bf16 a[240:255], v[12:15], v[28:31], a[240:255]
    s_waitcnt lgkmcnt(0)
    s_waitcnt vmcnt(0)
    s_barrier
    v_mfma_f32_32x32x16_bf16 a[0:15], v[32:35], v[48:51], a[0:15]
    v_xor_b32 v84, 0x10000, v84
    s_add_u32 m0, s45, 0
    v_xor_b32 v85, 0x10000, v85
    buffer_load_dwordx4 v92, s[48:51], s29 offen lds
    v_mfma_f32_32x32x16_bf16 a[16:31], v[32:35], v[52:55], a[16:31]
    s_add_u32 m0, s45, 1024
    v_xor_b32 v86, 0x10000, v86
    buffer_load_dwordx4 v93, s[48:51], s29 offen lds
    v_mfma_f32_32x32x16_bf16 a[32:47], v[32:35], v[56:59], a[32:47]
    v_xor_b32 v87, 0x10000, v87
    v_mfma_f32_32x32x16_bf16 a[48:63], v[32:35], v[60:63], a[48:63]
    s_add_u32 m0, s45, 2048
    v_xor_b32 v88, 0x10000, v88
    buffer_load_dwordx4 v94, s[48:51], s29 offen lds
    v_mfma_f32_32x32x16_bf16 a[64:79], v[36:39], v[48:51], a[64:79]
    v_xor_b32 v89, 0x10000, v89
    v_xor_b32 v90, 0x10000, v90
    v_mfma_f32_32x32x16_bf16 a[80:95], v[36:39], v[52:55], a[80:95]
    s_add_u32 m0, s45, 3072
    v_xor_b32 v91, 0x10000, v91
    buffer_load_dwordx4 v95, s[48:51], s29 offen lds
    v_mfma_f32_32x32x16_bf16 a[96:111], v[36:39], v[56:59], a[96:111]
    ds_read_b128 v[0:3], v84 offset:0
    v_mfma_f32_32x32x16_bf16 a[112:127], v[36:39], v[60:63], a[112:127]
    s_add_u32 m0, s45, 4096
    ds_read_b64_tr_b16 v[16:17], v88 offset:0
    buffer_load_dwordx4 v96, s[48:51], s29 offen lds
    v_mfma_f32_32x32x16_bf16 a[128:143], v[40:43], v[48:51], a[128:143]
    ds_read_b64_tr_b16 v[18:19], v88 offset:2048
    s_add_u32 m0, s45, 5120
    ds_read_b64_tr_b16 v[20:21], v89 offset:0
    buffer_load_dwordx4 v97, s[48:51], s29 offen lds
    v_mfma_f32_32x32x16_bf16 a[144:159], v[40:43], v[52:55], a[144:159]
    ds_read_b64_tr_b16 v[22:23], v89 offset:2048
    v_mfma_f32_32x32x16_bf16 a[160:175], v[40:43], v[56:59], a[160:175]
    s_add_u32 m0, s45, 6144
    ds_read_b128 v[4:7], v84 offset:4096
    buffer_load_dwordx4 v98, s[48:51], s29 offen lds
    v_mfma_f32_32x32x16_bf16 a[176:191], v[40:43], v[60:63], a[176:191]
    ds_read_b64_tr_b16 v[24:25], v90 offset:0
    v_mfma_f32_32x32x16_bf16 a[192:207], v[44:47], v[48:51], a[192:207]
    ds_read_b64_tr_b16 v[26:27], v90 offset:2048
    s_add_u32 m0, s45, 7168
    ds_read_b64_tr_b16 v[28:29], v91 offset:0
    buffer_load_dwordx4 v99, s[48:51], s29 offen lds
    v_mfma_f32_32x32x16_bf16 a[208:223], v[44:47], v[52:55], a[208:223]
    ds_read_b64_tr_b16 v[30:31], v91 offset:2048
    v_mfma_f32_32x32x16_bf16 a[224:239], v[44:47], v[56:59], a[224:239]
    ds_read_b128 v[8:11], v84 offset:8192
    s_add_u32 s29, s29, 128
    v_mfma_f32_32x32x16_bf16 a[240:255], v[44:47], v[60:63], a[240:255]
    ds_read_b128 v[12:15], v84 offset:12288
    s_waitcnt lgkmcnt(0)
    v_mfma_f32_32x32x16_bf16 a[0:15], v[0:3], v[16:19], a[0:15]
    s_add_u32 m0, s28, 32768
    ds_read_b128 v[32:35], v85 offset:0
    buffer_load_dwordx4 v100, s[52:55], s30 offen lds
    v_mfma_f32_32x32x16_bf16 a[16:31], v[0:3], v[20:23], a[16:31]
    ds_read_b64_tr_b16 v[48:49], v88 offset:8192
    v_mfma_f32_32x32x16_bf16 a[32:47], v[0:3], v[24:27], a[32:47]
    ds_read_b64_tr_b16 v[50:51], v88 offset:10240
    v_mfma_f32_32x32x16_bf16 a[48:63], v[0:3], v[28:31], a[48:63]
    s_add_u32 m0, s28, 33792
    ds_read_b64_tr_b16 v[52:53], v89 offset:8192
    buffer_load_dwordx4 v101, s[52:55], s30 offen lds
    v_mfma_f32_32x32x16_bf16 a[64:79], v[4:7], v[16:19], a[64:79]
    ds_read_b64_tr_b16 v[54:55], v89 offset:10240
    v_mfma_f32_32x32x16_bf16 a[80:95], v[4:7], v[20:23], a[80:95]
    ds_read_b128 v[36:39], v85 offset:4096
    v_mfma_f32_32x32x16_bf16 a[96:111], v[4:7], v[24:27], a[96:111]
    s_add_u32 m0, s28, 34816
    ds_read_b64_tr_b16 v[56:57], v90 offset:8192
    buffer_load_dwordx4 v102, s[52:55], s30 offen lds
    v_mfma_f32_32x32x16_bf16 a[112:127], v[4:7], v[28:31], a[112:127]
    ds_read_b64_tr_b16 v[58:59], v90 offset:10240
    v_mfma_f32_32x32x16_bf16 a[128:143], v[8:11], v[16:19], a[128:143]
    ds_read_b64_tr_b16 v[60:61], v91 offset:8192
    v_mfma_f32_32x32x16_bf16 a[144:159], v[8:11], v[20:23], a[144:159]
    s_add_u32 m0, s28, 35840
    ds_read_b64_tr_b16 v[62:63], v91 offset:10240
    buffer_load_dwordx4 v103, s[52:55], s30 offen lds
    v_mfma_f32_32x32x16_bf16 a[160:175], v[8:11], v[24:27], a[160:175]
    ds_read_b128 v[40:43], v85 offset:8192
    v_mfma_f32_32x32x16_bf16 a[176:191], v[8:11], v[28:31], a[176:191]
    ds_read_b128 v[44:47], v85 offset:12288
    v_mfma_f32_32x32x16_bf16 a[192:207], v[12:15], v[16:19], a[192:207]
    s_add_u32 s30, s30, 0x80000
    v_mfma_f32_32x32x16_bf16 a[208:223], v[12:15], v[20:23], a[208:223]
    v_mfma_f32_32x32x16_bf16 a[224:239], v[12:15], v[24:27], a[224:239]
    v_mfma_f32_32x32x16_bf16 a[240:255], v[12:15], v[28:31], a[240:255]
    s_waitcnt lgkmcnt(0)
    v_mfma_f32_32x32x16_bf16 a[0:15], v[32:35], v[48:51], a[0:15]
    ds_read_b128 v[0:3], v86 offset:0
    v_mfma_f32_32x32x16_bf16 a[16:31], v[32:35], v[52:55], a[16:31]
    ds_read_b64_tr_b16 v[16:17], v88 offset:16384
    v_mfma_f32_32x32x16_bf16 a[32:47], v[32:35], v[56:59], a[32:47]
    ds_read_b64_tr_b16 v[18:19], v88 offset:18432
    v_mfma_f32_32x32x16_bf16 a[48:63], v[32:35], v[60:63], a[48:63]
    ds_read_b64_tr_b16 v[20:21], v89 offset:16384
    v_mfma_f32_32x32x16_bf16 a[64:79], v[36:39], v[48:51], a[64:79]
    ds_read_b64_tr_b16 v[22:23], v89 offset:18432
    v_mfma_f32_32x32x16_bf16 a[80:95], v[36:39], v[52:55], a[80:95]
    ds_read_b128 v[4:7], v86 offset:4096
    v_mfma_f32_32x32x16_bf16 a[96:111], v[36:39], v[56:59], a[96:111]
    ds_read_b64_tr_b16 v[24:25], v90 offset:16384
    v_mfma_f32_32x32x16_bf16 a[112:127], v[36:39], v[60:63], a[112:127]
    ds_read_b64_tr_b16 v[26:27], v90 offset:18432
    v_mfma_f32_32x32x16_bf16 a[128:143], v[40:43], v[48:51], a[128:143]
    ds_read_b64_tr_b16 v[28:29], v91 offset:16384
    v_mfma_f32_32x32x16_bf16 a[144:159], v[40:43], v[52:55], a[144:159]
    ds_read_b64_tr_b16 v[30:31], v91 offset:18432
    v_mfma_f32_32x32x16_bf16 a[160:175], v[40:43], v[56:59], a[160:175]
    ds_read_b128 v[8:11], v86 offset:8192
    v_mfma_f32_32x32x16_bf16 a[176:191], v[40:43], v[60:63], a[176:191]
    ds_read_b128 v[12:15], v86 offset:12288
    v_mfma_f32_32x32x16_bf16 a[192:207], v[44:47], v[48:51], a[192:207]
    v_mfma_f32_32x32x16_bf16 a[208:223], v[44:47], v[52:55], a[208:223]
    v_mfma_f32_32x32x16_bf16 a[224:239], v[44:47], v[56:59], a[224:239]
    v_mfma_f32_32x32x16_bf16 a[240:255], v[44:47], v[60:63], a[240:255]
    s_waitcnt lgkmcnt(0)
    v_mfma_f32_32x32x16_bf16 a[0:15], v[0:3], v[16:19], a[0:15]
    ds_read_b128 v[32:35], v87 offset:0
    v_mfma_f32_32x32x16_bf16 a[16:31], v[0:3], v[20:23], a[16:31]
    ds_read_b64_tr_b16 v[48:49], v88 offset:24576
    v_mfma_f32_32x32x16_bf16 a[32:47], v[0:3], v[24:27], a[32:47]
    ds_read_b64_tr_b16 v[50:51], v88 offset:26624
    v_mfma_f32_32x32x16_bf16 a[48:63], v[0:3], v[28:31], a[48:63]
    ds_read_b64_tr_b16 v[52:53], v89 offset:24576
    v_mfma_f32_32x32x16_bf16 a[64:79], v[4:7], v[16:19], a[64:79]
    ds_read_b64_tr_b16 v[54:55], v89 offset:26624
    v_mfma_f32_32x32x16_bf16 a[80:95], v[4:7], v[20:23], a[80:95]
    ds_read_b128 v[36:39], v87 offset:4096
    v_mfma_f32_32x32x16_bf16 a[96:111], v[4:7], v[24:27], a[96:111]
    ds_read_b64_tr_b16 v[56:57], v90 offset:24576
    v_mfma_f32_32x32x16_bf16 a[112:127], v[4:7], v[28:31], a[112:127]
    ds_read_b64_tr_b16 v[58:59], v90 offset:26624
    v_mfma_f32_32x32x16_bf16 a[128:143], v[8:11], v[16:19], a[128:143]
    ds_read_b64_tr_b16 v[60:61], v91 offset:24576
    v_mfma_f32_32x32x16_bf16 a[144:159], v[8:11], v[20:23], a[144:159]
    ds_read_b64_tr_b16 v[62:63], v91 offset:26624
    v_mfma_f32_32x32x16_bf16 a[160:175], v[8:11], v[24:27], a[160:175]
    ds_read_b128 v[40:43], v87 offset:8192
    v_mfma_f32_32x32x16_bf16 a[176:191], v[8:11], v[28:31], a[176:191]
    ds_read_b128 v[44:47], v87 offset:12288
    v_mfma_f32_32x32x16_bf16 a[192:207], v[12:15], v[16:19], a[192:207]
    v_mfma_f32_32x32x16_bf16 a[208:223], v[12:15], v[20:23], a[208:223]
    v_mfma_f32_32x32x16_bf16 a[224:239], v[12:15], v[24:27], a[224:239]
    v_mfma_f32_32x32x16_bf16 a[240:255], v[12:15], v[28:31], a[240:255]
    s_waitcnt lgkmcnt(0)
    s_waitcnt vmcnt(0)
    s_barrier
    v_mfma_f32_32x32x16_bf16 a[0:15], v[32:35], v[48:51], a[0:15]
    s_add_u32 m0, s45, 49152
    v_xor_b32 v84, 0x10000, v84
    buffer_load_dwordx4 v92, s[48:51], s29 offen lds
    v_mfma_f32_32x32x16_bf16 a[16:31], v[32:35], v[52:55], a[16:31]
    s_add_u32 m0, s45, 50176
    v_xor_b32 v85, 0x10000, v85
    buffer_load_dwordx4 v93, s[48:51], s29 offen lds
    v_mfma_f32_32x32x16_bf16 a[32:47], v[32:35], v[56:59], a[32:47]
    s_add_u32 m0, s45, 51200
    v_xor_b32 v86, 0x10000, v86
    buffer_load_dwordx4 v94, s[48:51], s29 offen lds
    v_mfma_f32_32x32x16_bf16 a[48:63], v[32:35], v[60:63], a[48:63]
    s_add_u32 m0, s45, 52224
    v_xor_b32 v87, 0x10000, v87
    buffer_load_dwordx4 v95, s[48:51], s29 offen lds
    v_mfma_f32_32x32x16_bf16 a[64:79], v[36:39], v[48:51], a[64:79]
    s_add_u32 m0, s45, 53248
    ds_read_b128 v[0:3], v84 offset:0
    buffer_load_dwordx4 v96, s[48:51], s29 offen lds
    v_mfma_f32_32x32x16_bf16 a[80:95], v[36:39], v[52:55], a[80:95]
    s_add_u32 m0, s45, 54272
    ds_read_b64_tr_b16 v[16:17], v104 offset:0
    buffer_load_dwordx4 v97, s[48:51], s29 offen lds
    v_mfma_f32_32x32x16_bf16 a[96:111], v[36:39], v[56:59], a[96:111]
    s_add_u32 m0, s45, 55296
    ds_read_b64_tr_b16 v[18:19], v104 offset:1024
    buffer_load_dwordx4 v98, s[48:51], s29 offen lds
    v_mfma_f32_32x32x16_bf16 a[112:127], v[36:39], v[60:63], a[112:127]
    ds_read_b64_tr_b16 v[20:21], v105 offset:0
    v_mfma_f32_32x32x16_bf16 a[128:143], v[40:43], v[48:51], a[128:143]
    s_add_u32 m0, s45, 56320
    ds_read_b64_tr_b16 v[22:23], v105 offset:1024
    buffer_load_dwordx4 v99, s[48:51], s29 offen lds
    v_mfma_f32_32x32x16_bf16 a[144:159], v[40:43], v[52:55], a[144:159]
    ds_read_b128 v[4:7], v84 offset:4096
    s_add_u32 s29, s29, 128
    v_mfma_f32_32x32x16_bf16 a[160:175], v[40:43], v[56:59], a[160:175]
    s_add_u32 m0, s28, 81920
    ds_read_b128 v[8:11], v84 offset:8192
    buffer_load_dwordx4 v100, s[52:55], s30 offen lds
    v_mfma_f32_32x32x16_bf16 a[176:191], v[40:43], v[60:63], a[176:191]
    s_add_u32 m0, s28, 82944
    ds_read_b128 v[12:15], v84 offset:12288
    buffer_load_dwordx4 v101, s[52:55], s30 offen lds
    s_add_u32 m0, s28, 83968
    v_mfma_f32_32x32x16_bf16 a[192:207], v[44:47], v[48:51], a[192:207]
    buffer_load_dwordx4 v102, s[52:55], s30 offen lds
    s_add_u32 m0, s28, 84992
    v_mfma_f32_32x32x16_bf16 a[208:223], v[44:47], v[52:55], a[208:223]
    buffer_load_dwordx4 v103, s[52:55], s30 offen lds
    v_mfma_f32_32x32x16_bf16 a[224:239], v[44:47], v[56:59], a[224:239]
    s_add_u32 s30, s30, 0x80000
    v_mfma_f32_32x32x16_bf16 a[240:255], v[44:47], v[60:63], a[240:255]
    s_waitcnt lgkmcnt(0)
    v_mfma_f32_32x32x16_bf16 v[128:143], v[16:19], v[0:3], 0
    s_add_u32 m0, s45, 98304
    ds_read_b128 v[32:35], v85 offset:0
    buffer_load_dwordx4 v92, s[48:51], s29 offen lds
    s_add_u32 m0, s45, 99328
    s_nop 0
    buffer_load_dwordx4 v93, s[48:51], s29 offen lds
    s_and_b32 s25, s16, 1
    s_lshr_b32 s26, s16, 1
    s_lshl_b32 s25, s25, 7
    v_mfma_f32_32x32x16_bf16 v[144:159], v[20:23], v[0:3], 0
    s_add_u32 m0, s45, 100352
    ds_read_b64_tr_b16 v[48:49], v104 offset:4096
    buffer_load_dwordx4 v94, s[48:51], s29 offen lds
    s_lshl_b32 s26, s26, 7
    s_add_u32 s25, s25, s22
    s_add_u32 s26, s26, s23
    v_mfma_f32_32x32x16_bf16 v[160:175], v[16:19], v[4:7], 0
    s_add_u32 m0, s45, 101376
    ds_read_b64_tr_b16 v[50:51], v104 offset:5120
    buffer_load_dwordx4 v95, s[48:51], s29 offen lds
    s_add_u32 s31, s28, 147456
    v_and_b32 v88, 7, v66
    v_xor_b32 v88, v88, v65
    v_mfma_f32_32x32x16_bf16 v[176:191], v[20:23], v[4:7], 0
    s_add_u32 m0, s45, 102400
    ds_read_b64_tr_b16 v[52:53], v105 offset:4096
    buffer_load_dwordx4 v96, s[48:51], s29 offen lds
    v_lshlrev_b32 v88, 4, v88
    v_lshl_add_u32 v88, v66, 7, v88
    v_add_u32 v88, s31, v88
    v_mfma_f32_32x32x16_bf16 v[192:207], v[16:19], v[8:11], 0
    s_add_u32 m0, s45, 103424
    ds_read_b64_tr_b16 v[54:55], v105 offset:5120
    buffer_load_dwordx4 v97, s[48:51], s29 offen lds
    v_lshrrev_b32 v89, 3, v64
    v_and_b32 v90, 7, v64
    v_xor_b32 v91, v89, v90
    v_mfma_f32_32x32x16_bf16 v[208:223], v[20:23], v[8:11], 0
    s_add_u32 m0, s45, 104448
    ds_read_b128 v[36:39], v85 offset:4096
    buffer_load_dwordx4 v98, s[48:51], s29 offen lds
    v_lshlrev_b32 v91, 4, v91
    v_lshl_add_u32 v91, v89, 7, v91
    v_add_u32 v89, s26, v89
    v_mfma_f32_32x32x16_bf16 v[224:239], v[16:19], v[12:15], 0
    s_add_u32 m0, s45, 105472
    ds_read_b128 v[40:43], v85 offset:8192
    buffer_load_dwordx4 v99, s[48:51], s29 offen lds
    v_lshlrev_b32 v89, 12, v89
    v_lshl_add_u32 v90, v90, 4, v89
    s_lshl_b32 s25, s25, 1
    v_mfma_f32_32x32x16_bf16 v[240:255], v[20:23], v[12:15], 0
    ds_read_b128 v[44:47], v85 offset:12288
    s_add_u32 s29, s29, 128
    v_add_u32 v90, s25, v90
    v_add_u32 v89, s31, v91
    s_waitcnt lgkmcnt(0)
    v_mfma_f32_32x32x16_bf16 v[128:143], v[48:51], v[32:35], v[128:143]
    s_add_u32 m0, s28, 131072
    ds_read_b128 v[0:3], v86 offset:0
    buffer_load_dwordx4 v100, s[52:55], s30 offen lds
    v_accvgpr_read_b32 v68, a0
    v_accvgpr_read_b32 v69, a1
    v_accvgpr_read_b32 v70, a2
    v_accvgpr_read_b32 v71, a3
    v_mfma_f32_32x32x16_bf16 v[144:159], v[52:55], v[32:35], v[144:159]
    s_add_u32 m0, s28, 132096
    ds_read_b64_tr_b16 v[16:17], v104 offset:8192
    buffer_load_dwordx4 v101, s[52:55], s30 offen lds
    v_cvt_pk_bf16_f32 v72, v68, v69
    v_cvt_pk_bf16_f32 v73, v70, v71
    v_xor_b32 v68, 0, v88
    ds_write_b64 v68, v[72:73] offset:0
    v_mfma_f32_32x32x16_bf16 v[160:175], v[48:51], v[36:39], v[160:175]
    ds_read_b64_tr_b16 v[18:19], v104 offset:9216
    v_accvgpr_read_b32 v74, a4
    v_accvgpr_read_b32 v75, a5
    v_accvgpr_read_b32 v76, a6
    v_accvgpr_read_b32 v77, a7
    v_mfma_f32_32x32x16_bf16 v[176:191], v[52:55], v[36:39], v[176:191]
    s_add_u32 m0, s28, 133120
    ds_read_b64_tr_b16 v[20:21], v105 offset:8192
    buffer_load_dwordx4 v102, s[52:55], s30 offen lds
    v_cvt_pk_bf16_f32 v78, v74, v75
    v_cvt_pk_bf16_f32 v79, v76, v77
    v_xor_b32 v74, 0, v88
    ds_write_b64 v74, v[78:79] offset:8
    v_mfma_f32_32x32x16_bf16 v[192:207], v[48:51], v[40:43], v[192:207]
    s_add_u32 m0, s28, 134144
    ds_read_b64_tr_b16 v[22:23], v105 offset:9216
    buffer_load_dwordx4 v103, s[52:55], s30 offen lds
    v_accvgpr_read_b32 v122, a8
    v_accvgpr_read_b32 v123, a9
    v_accvgpr_read_b32 v124, a10
    v_accvgpr_read_b32 v125, a11
    v_mfma_f32_32x32x16_bf16 v[208:223], v[52:55], v[40:43], v[208:223]
    ds_read_b128 v[4:7], v86 offset:4096
    v_cvt_pk_bf16_f32 v126, v122, v123
    v_cvt_pk_bf16_f32 v127, v124, v125
    v_xor_b32 v122, 32, v88
    ds_write_b64 v122, v[126:127] offset:0
    v_mfma_f32_32x32x16_bf16 v[224:239], v[48:51], v[44:47], v[224:239]
    ds_read_b128 v[8:11], v86 offset:8192
    s_add_u32 s30, s30, 0x80000
    v_accvgpr_read_b32 v68, a12
    v_accvgpr_read_b32 v69, a13
    v_accvgpr_read_b32 v70, a14
    v_accvgpr_read_b32 v71, a15
    v_mfma_f32_32x32x16_bf16 v[240:255], v[52:55], v[44:47], v[240:255]
    ds_read_b128 v[12:15], v86 offset:12288
    v_cvt_pk_bf16_f32 v72, v68, v69
    v_cvt_pk_bf16_f32 v73, v70, v71
    v_xor_b32 v68, 32, v88
    ds_write_b64 v68, v[72:73] offset:8
    s_waitcnt lgkmcnt(0)
    v_mfma_f32_32x32x16_bf16 v[128:143], v[16:19], v[0:3], v[128:143]
    ds_read_b128 v[32:35], v87 offset:0
    v_accvgpr_read_b32 v74, a64
    v_accvgpr_read_b32 v75, a65
    v_accvgpr_read_b32 v76, a66
    v_accvgpr_read_b32 v77, a67
    v_mfma_f32_32x32x16_bf16 v[144:159], v[20:23], v[0:3], v[144:159]
    ds_read_b64_tr_b16 v[48:49], v104 offset:12288
    v_cvt_pk_bf16_f32 v78, v74, v75
    v_cvt_pk_bf16_f32 v79, v76, v77
    v_xor_b32 v74, 64, v88
    ds_write_b64 v74, v[78:79] offset:0
    v_mfma_f32_32x32x16_bf16 v[160:175], v[16:19], v[4:7], v[160:175]
    ds_read_b64_tr_b16 v[50:51], v104 offset:13312
    v_accvgpr_read_b32 v122, a68
    v_accvgpr_read_b32 v123, a69
    v_accvgpr_read_b32 v124, a70
    v_accvgpr_read_b32 v125, a71
    v_mfma_f32_32x32x16_bf16 v[176:191], v[20:23], v[4:7], v[176:191]
    ds_read_b64_tr_b16 v[52:53], v105 offset:12288
    v_cvt_pk_bf16_f32 v126, v122, v123
    v_cvt_pk_bf16_f32 v127, v124, v125
    v_xor_b32 v122, 64, v88
    ds_write_b64 v122, v[126:127] offset:8
    v_mfma_f32_32x32x16_bf16 v[192:207], v[16:19], v[8:11], v[192:207]
    ds_read_b64_tr_b16 v[54:55], v105 offset:13312
    v_accvgpr_read_b32 v68, a72
    v_accvgpr_read_b32 v69, a73
    v_accvgpr_read_b32 v70, a74
    v_accvgpr_read_b32 v71, a75
    v_mfma_f32_32x32x16_bf16 v[208:223], v[20:23], v[8:11], v[208:223]
    ds_read_b128 v[36:39], v87 offset:4096
    v_cvt_pk_bf16_f32 v72, v68, v69
    v_cvt_pk_bf16_f32 v73, v70, v71
    v_xor_b32 v68, 96, v88
    ds_write_b64 v68, v[72:73] offset:0
    v_mfma_f32_32x32x16_bf16 v[224:239], v[16:19], v[12:15], v[224:239]
    ds_read_b128 v[40:43], v87 offset:8192
    v_accvgpr_read_b32 v74, a76
    v_accvgpr_read_b32 v75, a77
    v_accvgpr_read_b32 v76, a78
    v_accvgpr_read_b32 v77, a79
    v_mfma_f32_32x32x16_bf16 v[240:255], v[20:23], v[12:15], v[240:255]
    ds_read_b128 v[44:47], v87 offset:12288
    v_cvt_pk_bf16_f32 v78, v74, v75
    v_cvt_pk_bf16_f32 v79, v76, v77
    v_xor_b32 v74, 96, v88
    ds_write_b64 v74, v[78:79] offset:8
    s_waitcnt lgkmcnt(0)
    s_waitcnt vmcnt(12)
    s_barrier
    v_mfma_f32_32x32x16_bf16 v[128:143], v[48:51], v[32:35], v[128:143]
    v_add_u32 v84, 0xc000, v84
    s_add_u32 m0, s45, 0
    v_add_u32 v85, 0xc000, v85
    buffer_load_dwordx4 v92, s[48:51], s29 offen lds
    s_add_u32 m0, s45, 1024
    s_nop 0
    buffer_load_dwordx4 v93, s[48:51], s29 offen lds
    ds_read_b128 v[106:109], v89 offset:0
    v_mfma_f32_32x32x16_bf16 v[144:159], v[52:55], v[32:35], v[144:159]
    v_add_u32 v86, 0xc000, v86
    s_add_u32 m0, s45, 2048
    v_add_u32 v87, 0xc000, v87
    buffer_load_dwordx4 v94, s[48:51], s29 offen lds
    v_mfma_f32_32x32x16_bf16 v[160:175], v[48:51], v[36:39], v[160:175]
    v_add_u32 v104, 0xc000, v104
    s_add_u32 m0, s45, 3072
    v_add_u32 v105, 0xc000, v105
    buffer_load_dwordx4 v95, s[48:51], s29 offen lds
    ds_read_b128 v[110:113], v89 offset:1024
    v_mfma_f32_32x32x16_bf16 v[176:191], v[52:55], v[36:39], v[176:191]
    s_add_u32 m0, s45, 4096
    ds_read_b128 v[0:3], v84 offset:0
    buffer_load_dwordx4 v96, s[48:51], s29 offen lds
    v_mfma_f32_32x32x16_bf16 v[192:207], v[48:51], v[40:43], v[192:207]
    ds_read_b64_tr_b16 v[16:17], v104 offset:0
    s_add_u32 m0, s45, 5120
    ds_read_b64_tr_b16 v[18:19], v104 offset:1024
    buffer_load_dwordx4 v97, s[48:51], s29 offen lds
    ds_read_b128 v[114:117], v89 offset:2048
    v_mfma_f32_32x32x16_bf16 v[208:223], v[52:55], v[40:43], v[208:223]
    ds_read_b64_tr_b16 v[20:21], v105 offset:0
    s_add_u32 m0, s45, 6144
    ds_read_b64_tr_b16 v[22:23], v105 offset:1024
    buffer_load_dwordx4 v98, s[48:51], s29 offen lds
    v_mfma_f32_32x32x16_bf16 v[224:239], v[48:51], v[44:47], v[224:239]
    ds_read_b128 v[4:7], v84 offset:4096
    s_add_u32 m0, s45, 7168
    ds_read_b128 v[8:11], v84 offset:8192
    buffer_load_dwordx4 v99, s[48:51], s29 offen lds
    ds_read_b128 v[118:121], v89 offset:3072
    v_mfma_f32_32x32x16_bf16 v[240:255], v[52:55], v[44:47], v[240:255]
    ds_read_b128 v[12:15], v84 offset:12288
    s_add_u32 s29, s29, 128
    s_waitcnt lgkmcnt(0)
    v_mfma_f32_32x32x16_bf16 v[128:143], v[16:19], v[0:3], v[128:143]
    s_add_u32 m0, s28, 32768
    ds_read_b128 v[32:35], v85 offset:0
    buffer_load_dwordx4 v100, s[52:55], s30 offen lds
    s_mov_b32 s20, 0
    buffer_store_dwordx4 v[106:109], v90, s[12:15], s20 offen sc1
    s_mov_b32 s20, 32768
    buffer_store_dwordx4 v[110:113], v90, s[12:15], s20 offen sc1
    s_mov_b32 s20, 65536
    v_mfma_f32_32x32x16_bf16 v[144:159], v[20:23], v[0:3], v[144:159]
    s_add_u32 m0, s28, 33792
    ds_read_b64_tr_b16 v[48:49], v104 offset:4096
    buffer_load_dwordx4 v101, s[52:55], s30 offen lds
    buffer_store_dwordx4 v[114:117], v90, s[12:15], s20 offen sc1
    s_mov_b32 s20, 98304
    buffer_store_dwordx4 v[118:121], v90, s[12:15], s20 offen sc1
    v_accvgpr_read_b32 v122, a128
    v_accvgpr_read_b32 v123, a129
    v_mfma_f32_32x32x16_bf16 v[160:175], v[16:19], v[4:7], v[160:175]
    ds_read_b64_tr_b16 v[50:51], v104 offset:5120
    v_accvgpr_read_b32 v124, a130
    v_accvgpr_read_b32 v125, a131
    v_cvt_pk_bf16_f32 v126, v122, v123
    v_cvt_pk_bf16_f32 v127, v124, v125
    v_xor_b32 v122, 0, v88
    v_mfma_f32_32x32x16_bf16 v[176:191], v[20:23], v[4:7], v[176:191]
    s_add_u32 m0, s28, 34816
    ds_read_b64_tr_b16 v[52:53], v105 offset:4096
    buffer_load_dwordx4 v102, s[52:55], s30 offen lds
    ds_write_b64 v122, v[126:127] offset:0
    v_accvgpr_read_b32 v68, a132
    v_accvgpr_read_b32 v69, a133
    v_accvgpr_read_b32 v70, a134
    v_accvgpr_read_b32 v71, a135
    v_mfma_f32_32x32x16_bf16 v[192:207], v[16:19], v[8:11], v[192:207]
    s_add_u32 m0, s28, 35840
    ds_read_b64_tr_b16 v[54:55], v105 offset:5120
    buffer_load_dwordx4 v103, s[52:55], s30 offen lds
    v_cvt_pk_bf16_f32 v72, v68, v69
    v_cvt_pk_bf16_f32 v73, v70, v71
    v_xor_b32 v68, 0, v88
    ds_write_b64 v68, v[72:73] offset:8
    v_accvgpr_read_b32 v74, a136
    v_mfma_f32_32x32x16_bf16 v[208:223], v[20:23], v[8:11], v[208:223]
    ds_read_b128 v[36:39], v85 offset:4096
    v_accvgpr_read_b32 v75, a137
    v_accvgpr_read_b32 v76, a138
    v_accvgpr_read_b32 v77, a139
    v_cvt_pk_bf16_f32 v78, v74, v75
    v_cvt_pk_bf16_f32 v79, v76, v77
    v_mfma_f32_32x32x16_bf16 v[224:239], v[16:19], v[12:15], v[224:239]
    ds_read_b128 v[40:43], v85 offset:8192
    s_add_u32 s30, s30, 0x80000
    v_xor_b32 v74, 32, v88
    ds_write_b64 v74, v[78:79] offset:0
    v_accvgpr_read_b32 v122, a140
    v_accvgpr_read_b32 v123, a141
    v_accvgpr_read_b32 v124, a142
    v_mfma_f32_32x32x16_bf16 v[240:255], v[20:23], v[12:15], v[240:255]
    ds_read_b128 v[44:47], v85 offset:12288
    v_accvgpr_read_b32 v125, a143
    v_cvt_pk_bf16_f32 v126, v122, v123
    v_cvt_pk_bf16_f32 v127, v124, v125
    v_xor_b32 v122, 32, v88
    ds_write_b64 v122, v[126:127] offset:8
    s_waitcnt lgkmcnt(0)
    v_mfma_f32_32x32x16_bf16 v[128:143], v[48:51], v[32:35], v[128:143]
    ds_read_b128 v[0:3], v86 offset:0
    v_accvgpr_read_b32 v68, a192
    v_accvgpr_read_b32 v69, a193
    v_accvgpr_read_b32 v70, a194
    v_accvgpr_read_b32 v71, a195
    v_mfma_f32_32x32x16_bf16 v[144:159], v[52:55], v[32:35], v[144:159]
    ds_read_b64_tr_b16 v[16:17], v104 offset:8192
    v_cvt_pk_bf16_f32 v72, v68, v69
    v_cvt_pk_bf16_f32 v73, v70, v71
    v_xor_b32 v68, 64, v88
    ds_write_b64 v68, v[72:73] offset:0
    v_mfma_f32_32x32x16_bf16 v[160:175], v[48:51], v[36:39], v[160:175]
    ds_read_b64_tr_b16 v[18:19], v104 offset:9216
    v_accvgpr_read_b32 v74, a196
    v_accvgpr_read_b32 v75, a197
    v_accvgpr_read_b32 v76, a198
    v_accvgpr_read_b32 v77, a199
    v_mfma_f32_32x32x16_bf16 v[176:191], v[52:55], v[36:39], v[176:191]
    ds_read_b64_tr_b16 v[20:21], v105 offset:8192
    v_cvt_pk_bf16_f32 v78, v74, v75
    v_cvt_pk_bf16_f32 v79, v76, v77
    v_xor_b32 v74, 64, v88
    ds_write_b64 v74, v[78:79] offset:8
    v_mfma_f32_32x32x16_bf16 v[192:207], v[48:51], v[40:43], v[192:207]
    ds_read_b64_tr_b16 v[22:23], v105 offset:9216
    v_accvgpr_read_b32 v122, a200
    v_accvgpr_read_b32 v123, a201
    v_accvgpr_read_b32 v124, a202
    v_accvgpr_read_b32 v125, a203
    v_mfma_f32_32x32x16_bf16 v[208:223], v[52:55], v[40:43], v[208:223]
    ds_read_b128 v[4:7], v86 offset:4096
    v_cvt_pk_bf16_f32 v126, v122, v123
    v_cvt_pk_bf16_f32 v127, v124, v125
    v_xor_b32 v122, 96, v88
    ds_write_b64 v122, v[126:127] offset:0
    v_mfma_f32_32x32x16_bf16 v[224:239], v[48:51], v[44:47], v[224:239]
    ds_read_b128 v[8:11], v86 offset:8192
    v_accvgpr_read_b32 v68, a204
    v_accvgpr_read_b32 v69, a205
    v_accvgpr_read_b32 v70, a206
    v_accvgpr_read_b32 v71, a207
    v_mfma_f32_32x32x16_bf16 v[240:255], v[52:55], v[44:47], v[240:255]
    ds_read_b128 v[12:15], v86 offset:12288
    v_cvt_pk_bf16_f32 v72, v68, v69
    v_cvt_pk_bf16_f32 v73, v70, v71
    v_xor_b32 v68, 96, v88
    ds_write_b64 v68, v[72:73] offset:8
    s_waitcnt lgkmcnt(0)
    v_mfma_f32_32x32x16_bf16 v[128:143], v[16:19], v[0:3], v[128:143]
    ds_read_b128 v[32:35], v87 offset:0
    ds_read_b128 v[106:109], v89 offset:0
    v_mfma_f32_32x32x16_bf16 v[144:159], v[20:23], v[0:3], v[144:159]
    ds_read_b64_tr_b16 v[48:49], v104 offset:12288
    v_mfma_f32_32x32x16_bf16 v[160:175], v[16:19], v[4:7], v[160:175]
    ds_read_b64_tr_b16 v[50:51], v104 offset:13312
    ds_read_b128 v[110:113], v89 offset:1024
    v_mfma_f32_32x32x16_bf16 v[176:191], v[20:23], v[4:7], v[176:191]
    ds_read_b64_tr_b16 v[52:53], v105 offset:12288
    v_mfma_f32_32x32x16_bf16 v[192:207], v[16:19], v[8:11], v[192:207]
    ds_read_b64_tr_b16 v[54:55], v105 offset:13312
    ds_read_b128 v[114:117], v89 offset:2048
    v_mfma_f32_32x32x16_bf16 v[208:223], v[20:23], v[8:11], v[208:223]
    ds_read_b128 v[36:39], v87 offset:4096
    v_mfma_f32_32x32x16_bf16 v[224:239], v[16:19], v[12:15], v[224:239]
    ds_read_b128 v[40:43], v87 offset:8192
    ds_read_b128 v[118:121], v89 offset:3072
    v_mfma_f32_32x32x16_bf16 v[240:255], v[20:23], v[12:15], v[240:255]
    ds_read_b128 v[44:47], v87 offset:12288
    s_waitcnt lgkmcnt(0)
    s_waitcnt vmcnt(16)
    s_barrier
    v_mfma_f32_32x32x16_bf16 v[128:143], v[48:51], v[32:35], v[128:143]
    v_add_u32 v84, 0xc000, v84
    s_add_u32 m0, s45, 49152
    v_add_u32 v85, 0xc000, v85
    buffer_load_dwordx4 v92, s[48:51], s29 offen lds
    s_add_u32 m0, s45, 50176
    s_nop 0
    buffer_load_dwordx4 v93, s[48:51], s29 offen lds
    s_mov_b32 s20, 128
    buffer_store_dwordx4 v[106:109], v90, s[12:15], s20 offen sc1
    s_mov_b32 s20, 32896
    buffer_store_dwordx4 v[110:113], v90, s[12:15], s20 offen sc1
    s_mov_b32 s20, 65664
    v_mfma_f32_32x32x16_bf16 v[144:159], v[52:55], v[32:35], v[144:159]
    v_add_u32 v86, 0xc000, v86
    s_add_u32 m0, s45, 51200
    v_add_u32 v87, 0xc000, v87
    buffer_load_dwordx4 v94, s[48:51], s29 offen lds
    buffer_store_dwordx4 v[114:117], v90, s[12:15], s20 offen sc1
    s_mov_b32 s20, 98432
    buffer_store_dwordx4 v[118:121], v90, s[12:15], s20 offen sc1
    v_accvgpr_read_b32 v74, a16
    v_accvgpr_read_b32 v75, a17
    v_mfma_f32_32x32x16_bf16 v[160:175], v[48:51], v[36:39], v[160:175]
    v_add_u32 v104, 0xc000, v104
    s_add_u32 m0, s45, 52224
    v_add_u32 v105, 0xc000, v105
    buffer_load_dwordx4 v95, s[48:51], s29 offen lds
    v_accvgpr_read_b32 v76, a18
    v_accvgpr_read_b32 v77, a19
    v_cvt_pk_bf16_f32 v78, v74, v75
    v_cvt_pk_bf16_f32 v79, v76, v77
    v_xor_b32 v74, 0, v88
    v_mfma_f32_32x32x16_bf16 v[176:191], v[52:55], v[36:39], v[176:191]
    s_add_u32 m0, s45, 53248
    ds_read_b128 v[0:3], v84 offset:0
    buffer_load_dwordx4 v96, s[48:51], s29 offen lds
    ds_write_b64 v74, v[78:79] offset:0
    v_accvgpr_read_b32 v122, a20
    v_accvgpr_read_b32 v123, a21
    v_accvgpr_read_b32 v124, a22
    v_accvgpr_read_b32 v125, a23
    v_mfma_f32_32x32x16_bf16 v[192:207], v[48:51], v[40:43], v[192:207]
    ds_read_b64_tr_b16 v[16:17], v104 offset:0
    s_add_u32 m0, s45, 54272
    ds_read_b64_tr_b16 v[18:19], v104 offset:1024
    buffer_load_dwordx4 v97, s[48:51], s29 offen lds
    v_cvt_pk_bf16_f32 v126, v122, v123
    v_cvt_pk_bf16_f32 v127, v124, v125
    v_xor_b32 v122, 0, v88
    ds_write_b64 v122, v[126:127] offset:8
    v_accvgpr_read_b32 v68, a24
    v_mfma_f32_32x32x16_bf16 v[208:223], v[52:55], v[40:43], v[208:223]
    ds_read_b64_tr_b16 v[20:21], v105 offset:0
    s_add_u32 m0, s45, 55296
    ds_read_b64_tr_b16 v[22:23], v105 offset:1024
    buffer_load_dwordx4 v98, s[48:51], s29 offen lds
    v_accvgpr_read_b32 v69, a25
    v_accvgpr_read_b32 v70, a26
    v_accvgpr_read_b32 v71, a27
    v_cvt_pk_bf16_f32 v72, v68, v69
    v_cvt_pk_bf16_f32 v73, v70, v71
    v_mfma_f32_32x32x16_bf16 v[224:239], v[48:51], v[44:47], v[224:239]
    ds_read_b128 v[4:7], v84 offset:4096
    s_add_u32 m0, s45, 56320
    ds_read_b128 v[8:11], v84 offset:8192
    buffer_load_dwordx4 v99, s[48:51], s29 offen lds
    v_xor_b32 v68, 32, v88
    ds_write_b64 v68, v[72:73] offset:0
    v_accvgpr_read_b32 v74, a28
    v_accvgpr_read_b32 v75, a29
    v_accvgpr_read_b32 v76, a30
    v_mfma_f32_32x32x16_bf16 v[240:255], v[52:55], v[44:47], v[240:255]
    ds_read_b128 v[12:15], v84 offset:12288
    s_add_u32 s29, s29, 128
    v_accvgpr_read_b32 v77, a31
    v_cvt_pk_bf16_f32 v78, v74, v75
    v_cvt_pk_bf16_f32 v79, v76, v77
    v_xor_b32 v74, 32, v88
    ds_write_b64 v74, v[78:79] offset:8
    s_waitcnt lgkmcnt(0)
    v_mfma_f32_32x32x16_bf16 v[128:143], v[16:19], v[0:3], v[128:143]
    s_add_u32 m0, s28, 81920
    ds_read_b128 v[32:35], v85 offset:0
    buffer_load_dwordx4 v100, s[52:55], s30 offen lds
    v_accvgpr_read_b32 v122, a80
    v_accvgpr_read_b32 v123, a81
    v_accvgpr_read_b32 v124, a82
    v_accvgpr_read_b32 v125, a83
    v_mfma_f32_32x32x16_bf16 v[144:159], v[20:23], v[0:3], v[144:159]
    s_add_u32 m0, s28, 82944
    ds_read_b64_tr_b16 v[48:49], v104 offset:4096
    buffer_load_dwordx4 v101, s[52:55], s30 offen lds
    v_cvt_pk_bf16_f32 v126, v122, v123
    v_cvt_pk_bf16_f32 v127, v124, v125
    v_xor_b32 v122, 64, v88
    ds_write_b64 v122, v[126:127] offset:0
    v_mfma_f32_32x32x16_bf16 v[160:175], v[16:19], v[4:7], v[160:175]
    ds_read_b64_tr_b16 v[50:51], v104 offset:5120
    v_accvgpr_read_b32 v68, a84
    v_accvgpr_read_b32 v69, a85
    v_accvgpr_read_b32 v70, a86
    v_accvgpr_read_b32 v71, a87
    v_mfma_f32_32x32x16_bf16 v[176:191], v[20:23], v[4:7], v[176:191]
    s_add_u32 m0, s28, 83968
    ds_read_b64_tr_b16 v[52:53], v105 offset:4096
    buffer_load_dwordx4 v102, s[52:55], s30 offen lds
    v_cvt_pk_bf16_f32 v72, v68, v69
    v_cvt_pk_bf16_f32 v73, v70, v71
    v_xor_b32 v68, 64, v88
    ds_write_b64 v68, v[72:73] offset:8
    v_mfma_f32_32x32x16_bf16 v[192:207], v[16:19], v[8:11], v[192:207]
    s_add_u32 m0, s28, 84992
    ds_read_b64_tr_b16 v[54:55], v105 offset:5120
    buffer_load_dwordx4 v103, s[52:55], s30 offen lds
    v_accvgpr_read_b32 v74, a88
    v_accvgpr_read_b32 v75, a89
    v_accvgpr_read_b32 v76, a90
    v_accvgpr_read_b32 v77, a91
    v_mfma_f32_32x32x16_bf16 v[208:223], v[20:23], v[8:11], v[208:223]
    ds_read_b128 v[36:39], v85 offset:4096
    v_cvt_pk_bf16_f32 v78, v74, v75
    v_cvt_pk_bf16_f32 v79, v76, v77
    v_xor_b32 v74, 96, v88
    ds_write_b64 v74, v[78:79] offset:0
    v_mfma_f32_32x32x16_bf16 v[224:239], v[16:19], v[12:15], v[224:239]
    ds_read_b128 v[40:43], v85 offset:8192
    s_add_u32 s30, s30, 0x80000
    v_accvgpr_read_b32 v122, a92
    v_accvgpr_read_b32 v123, a93
    v_accvgpr_read_b32 v124, a94
    v_accvgpr_read_b32 v125, a95
    v_mfma_f32_32x32x16_bf16 v[240:255], v[20:23], v[12:15], v[240:255]
    ds_read_b128 v[44:47], v85 offset:12288
    v_cvt_pk_bf16_f32 v126, v122, v123
    v_cvt_pk_bf16_f32 v127, v124, v125
    v_xor_b32 v122, 96, v88
    ds_write_b64 v122, v[126:127] offset:8
    s_waitcnt lgkmcnt(0)
    v_mfma_f32_32x32x16_bf16 v[128:143], v[48:51], v[32:35], v[128:143]
    ds_read_b128 v[0:3], v86 offset:0
    ds_read_b128 v[106:109], v89 offset:0
    v_mfma_f32_32x32x16_bf16 v[144:159], v[52:55], v[32:35], v[144:159]
    ds_read_b64_tr_b16 v[16:17], v104 offset:8192
    v_mfma_f32_32x32x16_bf16 v[160:175], v[48:51], v[36:39], v[160:175]
    ds_read_b64_tr_b16 v[18:19], v104 offset:9216
    ds_read_b128 v[110:113], v89 offset:1024
    v_mfma_f32_32x32x16_bf16 v[176:191], v[52:55], v[36:39], v[176:191]
    ds_read_b64_tr_b16 v[20:21], v105 offset:8192
    v_mfma_f32_32x32x16_bf16 v[192:207], v[48:51], v[40:43], v[192:207]
    ds_read_b64_tr_b16 v[22:23], v105 offset:9216
    ds_read_b128 v[114:117], v89 offset:2048
    v_mfma_f32_32x32x16_bf16 v[208:223], v[52:55], v[40:43], v[208:223]
    ds_read_b128 v[4:7], v86 offset:4096
    v_mfma_f32_32x32x16_bf16 v[224:239], v[48:51], v[44:47], v[224:239]
    ds_read_b128 v[8:11], v86 offset:8192
    ds_read_b128 v[118:121], v89 offset:3072
    v_mfma_f32_32x32x16_bf16 v[240:255], v[52:55], v[44:47], v[240:255]
    ds_read_b128 v[12:15], v86 offset:12288
    s_waitcnt lgkmcnt(0)
    v_mfma_f32_32x32x16_bf16 v[128:143], v[16:19], v[0:3], v[128:143]
    ds_read_b128 v[32:35], v87 offset:0
    s_mov_b32 s20, 131072
    buffer_store_dwordx4 v[106:109], v90, s[12:15], s20 offen sc1
    s_mov_b32 s20, 163840
    buffer_store_dwordx4 v[110:113], v90, s[12:15], s20 offen sc1
    s_mov_b32 s20, 196608
    v_mfma_f32_32x32x16_bf16 v[144:159], v[20:23], v[0:3], v[144:159]
    ds_read_b64_tr_b16 v[48:49], v104 offset:12288
    buffer_store_dwordx4 v[114:117], v90, s[12:15], s20 offen sc1
    s_mov_b32 s20, 229376
    buffer_store_dwordx4 v[118:121], v90, s[12:15], s20 offen sc1
    v_accvgpr_read_b32 v68, a144
    v_accvgpr_read_b32 v69, a145
    v_mfma_f32_32x32x16_bf16 v[160:175], v[16:19], v[4:7], v[160:175]
    ds_read_b64_tr_b16 v[50:51], v104 offset:13312
    v_accvgpr_read_b32 v70, a146
    v_accvgpr_read_b32 v71, a147
    v_cvt_pk_bf16_f32 v72, v68, v69
    v_cvt_pk_bf16_f32 v73, v70, v71
    v_xor_b32 v68, 0, v88
    v_mfma_f32_32x32x16_bf16 v[176:191], v[20:23], v[4:7], v[176:191]
    ds_read_b64_tr_b16 v[52:53], v105 offset:12288
    ds_write_b64 v68, v[72:73] offset:0
    v_accvgpr_read_b32 v74, a148
    v_accvgpr_read_b32 v75, a149
    v_accvgpr_read_b32 v76, a150
    v_accvgpr_read_b32 v77, a151
    v_mfma_f32_32x32x16_bf16 v[192:207], v[16:19], v[8:11], v[192:207]
    ds_read_b64_tr_b16 v[54:55], v105 offset:13312
    v_cvt_pk_bf16_f32 v78, v74, v75
    v_cvt_pk_bf16_f32 v79, v76, v77
    v_xor_b32 v74, 0, v88
    ds_write_b64 v74, v[78:79] offset:8
    v_accvgpr_read_b32 v122, a152
    v_mfma_f32_32x32x16_bf16 v[208:223], v[20:23], v[8:11], v[208:223]
    ds_read_b128 v[36:39], v87 offset:4096
    v_accvgpr_read_b32 v123, a153
    v_accvgpr_read_b32 v124, a154
    v_accvgpr_read_b32 v125, a155
    v_cvt_pk_bf16_f32 v126, v122, v123
    v_cvt_pk_bf16_f32 v127, v124, v125
    v_mfma_f32_32x32x16_bf16 v[224:239], v[16:19], v[12:15], v[224:239]
    ds_read_b128 v[40:43], v87 offset:8192
    v_xor_b32 v122, 32, v88
    ds_write_b64 v122, v[126:127] offset:0
    v_accvgpr_read_b32 v68, a156
    v_accvgpr_read_b32 v69, a157
    v_accvgpr_read_b32 v70, a158
    v_mfma_f32_32x32x16_bf16 v[240:255], v[20:23], v[12:15], v[240:255]
    ds_read_b128 v[44:47], v87 offset:12288
    v_accvgpr_read_b32 v71, a159
    v_cvt_pk_bf16_f32 v72, v68, v69
    v_cvt_pk_bf16_f32 v73, v70, v71
    v_xor_b32 v68, 32, v88
    ds_write_b64 v68, v[72:73] offset:8
    s_waitcnt lgkmcnt(0)
    s_waitcnt vmcnt(20)
    s_barrier
    v_mfma_f32_32x32x16_bf16 v[128:143], v[48:51], v[32:35], v[128:143]
    v_add_u32 v84, 0xfffe8000, v84
    s_add_u32 m0, s45, 98304
    v_add_u32 v85, 0xfffe8000, v85
    buffer_load_dwordx4 v92, s[48:51], s29 offen lds
    s_add_u32 m0, s45, 99328
    s_nop 0
    buffer_load_dwordx4 v93, s[48:51], s29 offen lds
    v_accvgpr_read_b32 v74, a208
    v_accvgpr_read_b32 v75, a209
    v_accvgpr_read_b32 v76, a210
    v_accvgpr_read_b32 v77, a211
    v_mfma_f32_32x32x16_bf16 v[144:159], v[52:55], v[32:35], v[144:159]
    v_add_u32 v86, 0xfffe8000, v86
    s_add_u32 m0, s45, 100352
    v_add_u32 v87, 0xfffe8000, v87
    buffer_load_dwordx4 v94, s[48:51], s29 offen lds
    v_cvt_pk_bf16_f32 v78, v74, v75
    v_cvt_pk_bf16_f32 v79, v76, v77
    v_xor_b32 v74, 64, v88
    ds_write_b64 v74, v[78:79] offset:0
    v_mfma_f32_32x32x16_bf16 v[160:175], v[48:51], v[36:39], v[160:175]
    v_add_u32 v104, 0xfffe8000, v104
    s_add_u32 m0, s45, 101376
    v_add_u32 v105, 0xfffe8000, v105
    buffer_load_dwordx4 v95, s[48:51], s29 offen lds
    v_accvgpr_read_b32 v122, a212
    v_accvgpr_read_b32 v123, a213
    v_accvgpr_read_b32 v124, a214
    v_accvgpr_read_b32 v125, a215
    v_mfma_f32_32x32x16_bf16 v[176:191], v[52:55], v[36:39], v[176:191]
    s_add_u32 m0, s45, 102400
    ds_read_b128 v[0:3], v84 offset:0
    buffer_load_dwordx4 v96, s[48:51], s29 offen lds
    v_cvt_pk_bf16_f32 v126, v122, v123
    v_cvt_pk_bf16_f32 v127, v124, v125
    v_xor_b32 v122, 64, v88
    ds_write_b64 v122, v[126:127] offset:8
    v_mfma_f32_32x32x16_bf16 v[192:207], v[48:51], v[40:43], v[192:207]
    ds_read_b64_tr_b16 v[16:17], v104 offset:0
    s_add_u32 m0, s45, 103424
    ds_read_b64_tr_b16 v[18:19], v104 offset:1024
    buffer_load_dwordx4 v97, s[48:51], s29 offen lds
    v_accvgpr_read_b32 v68, a216
    v_accvgpr_read_b32 v69, a217
    v_accvgpr_read_b32 v70, a218
    v_accvgpr_read_b32 v71, a219
    v_mfma_f32_32x32x16_bf16 v[208:223], v[52:55], v[40:43], v[208:223]
    ds_read_b64_tr_b16 v[20:21], v105 offset:0
    s_add_u32 m0, s45, 104448
    ds_read_b64_tr_b16 v[22:23], v105 offset:1024
    buffer_load_dwordx4 v98, s[48:51], s29 offen lds
    v_cvt_pk_bf16_f32 v72, v68, v69
    v_cvt_pk_bf16_f32 v73, v70, v71
    v_xor_b32 v68, 96, v88
    ds_write_b64 v68, v[72:73] offset:0
    v_mfma_f32_32x32x16_bf16 v[224:239], v[48:51], v[44:47], v[224:239]
    ds_read_b128 v[4:7], v84 offset:4096
    s_add_u32 m0, s45, 105472
    ds_read_b128 v[8:11], v84 offset:8192
    buffer_load_dwordx4 v99, s[48:51], s29 offen lds
    v_accvgpr_read_b32 v74, a220
    v_accvgpr_read_b32 v75, a221
    v_accvgpr_read_b32 v76, a222
    v_accvgpr_read_b32 v77, a223
    v_mfma_f32_32x32x16_bf16 v[240:255], v[52:55], v[44:47], v[240:255]
    ds_read_b128 v[12:15], v84 offset:12288
    s_add_u32 s29, s29, 128
    v_cvt_pk_bf16_f32 v78, v74, v75
    v_cvt_pk_bf16_f32 v79, v76, v77
    v_xor_b32 v74, 96, v88
    ds_write_b64 v74, v[78:79] offset:8
    s_waitcnt lgkmcnt(0)
    v_mfma_f32_32x32x16_bf16 v[128:143], v[16:19], v[0:3], v[128:143]
    s_add_u32 m0, s28, 131072
    ds_read_b128 v[32:35], v85 offset:0
    buffer_load_dwordx4 v100, s[52:55], s30 offen lds
    ds_read_b128 v[106:109], v89 offset:0
    v_mfma_f32_32x32x16_bf16 v[144:159], v[20:23], v[0:3], v[144:159]
    s_add_u32 m0, s28, 132096
    ds_read_b64_tr_b16 v[48:49], v104 offset:4096
    buffer_load_dwordx4 v101, s[52:55], s30 offen lds
    v_mfma_f32_32x32x16_bf16 v[160:175], v[16:19], v[4:7], v[160:175]
    ds_read_b64_tr_b16 v[50:51], v104 offset:5120
    ds_read_b128 v[110:113], v89 offset:1024
    v_mfma_f32_32x32x16_bf16 v[176:191], v[20:23], v[4:7], v[176:191]
    s_add_u32 m0, s28, 133120
    ds_read_b64_tr_b16 v[52:53], v105 offset:4096
    buffer_load_dwordx4 v102, s[52:55], s30 offen lds
    v_mfma_f32_32x32x16_bf16 v[192:207], v[16:19], v[8:11], v[192:207]
    s_add_u32 m0, s28, 134144
    ds_read_b64_tr_b16 v[54:55], v105 offset:5120
    buffer_load_dwordx4 v103, s[52:55], s30 offen lds
    ds_read_b128 v[114:117], v89 offset:2048
    v_mfma_f32_32x32x16_bf16 v[208:223], v[20:23], v[8:11], v[208:223]
    ds_read_b128 v[36:39], v85 offset:4096
    v_mfma_f32_32x32x16_bf16 v[224:239], v[16:19], v[12:15], v[224:239]
    ds_read_b128 v[40:43], v85 offset:8192
    s_add_u32 s30, s30, 0x80000
    ds_read_b128 v[118:121], v89 offset:3072
    v_mfma_f32_32x32x16_bf16 v[240:255], v[20:23], v[12:15], v[240:255]
    ds_read_b128 v[44:47], v85 offset:12288
    s_waitcnt lgkmcnt(0)
    v_mfma_f32_32x32x16_bf16 v[128:143], v[48:51], v[32:35], v[128:143]
    ds_read_b128 v[0:3], v86 offset:0
    s_mov_b32 s20, 131200
    buffer_store_dwordx4 v[106:109], v90, s[12:15], s20 offen sc1
    s_mov_b32 s20, 163968
    buffer_store_dwordx4 v[110:113], v90, s[12:15], s20 offen sc1
    s_mov_b32 s20, 196736
    v_mfma_f32_32x32x16_bf16 v[144:159], v[52:55], v[32:35], v[144:159]
    ds_read_b64_tr_b16 v[16:17], v104 offset:8192
    buffer_store_dwordx4 v[114:117], v90, s[12:15], s20 offen sc1
    s_mov_b32 s20, 229504
    buffer_store_dwordx4 v[118:121], v90, s[12:15], s20 offen sc1
    v_accvgpr_read_b32 v122, a32
    v_accvgpr_read_b32 v123, a33
    v_mfma_f32_32x32x16_bf16 v[160:175], v[48:51], v[36:39], v[160:175]
    ds_read_b64_tr_b16 v[18:19], v104 offset:9216
    v_accvgpr_read_b32 v124, a34
    v_accvgpr_read_b32 v125, a35
    v_cvt_pk_bf16_f32 v126, v122, v123
    v_cvt_pk_bf16_f32 v127, v124, v125
    v_xor_b32 v122, 0, v88
    v_mfma_f32_32x32x16_bf16 v[176:191], v[52:55], v[36:39], v[176:191]
    ds_read_b64_tr_b16 v[20:21], v105 offset:8192
    ds_write_b64 v122, v[126:127] offset:0
    v_accvgpr_read_b32 v68, a36
    v_accvgpr_read_b32 v69, a37
    v_accvgpr_read_b32 v70, a38
    v_accvgpr_read_b32 v71, a39
    v_mfma_f32_32x32x16_bf16 v[192:207], v[48:51], v[40:43], v[192:207]
    ds_read_b64_tr_b16 v[22:23], v105 offset:9216
    v_cvt_pk_bf16_f32 v72, v68, v69
    v_cvt_pk_bf16_f32 v73, v70, v71
    v_xor_b32 v68, 0, v88
    ds_write_b64 v68, v[72:73] offset:8
    v_accvgpr_read_b32 v74, a40
    v_mfma_f32_32x32x16_bf16 v[208:223], v[52:55], v[40:43], v[208:223]
    ds_read_b128 v[4:7], v86 offset:4096
    v_accvgpr_read_b32 v75, a41
    v_accvgpr_read_b32 v76, a42
    v_accvgpr_read_b32 v77, a43
    v_cvt_pk_bf16_f32 v78, v74, v75
    v_cvt_pk_bf16_f32 v79, v76, v77
    v_mfma_f32_32x32x16_bf16 v[224:239], v[48:51], v[44:47], v[224:239]
    ds_read_b128 v[8:11], v86 offset:8192
    v_xor_b32 v74, 32, v88
    ds_write_b64 v74, v[78:79] offset:0
    v_accvgpr_read_b32 v122, a44
    v_accvgpr_read_b32 v123, a45
    v_accvgpr_read_b32 v124, a46
    v_mfma_f32_32x32x16_bf16 v[240:255], v[52:55], v[44:47], v[240:255]
    ds_read_b128 v[12:15], v86 offset:12288
    v_accvgpr_read_b32 v125, a47
    v_cvt_pk_bf16_f32 v126, v122, v123
    v_cvt_pk_bf16_f32 v127, v124, v125
    v_xor_b32 v122, 32, v88
    ds_write_b64 v122, v[126:127] offset:8
    s_waitcnt lgkmcnt(0)
    v_mfma_f32_32x32x16_bf16 v[128:143], v[16:19], v[0:3], v[128:143]
    ds_read_b128 v[32:35], v87 offset:0
    v_accvgpr_read_b32 v68, a96
    v_accvgpr_read_b32 v69, a97
    v_accvgpr_read_b32 v70, a98
    v_accvgpr_read_b32 v71, a99
    v_mfma_f32_32x32x16_bf16 v[144:159], v[20:23], v[0:3], v[144:159]
    ds_read_b64_tr_b16 v[48:49], v104 offset:12288
    v_cvt_pk_bf16_f32 v72, v68, v69
    v_cvt_pk_bf16_f32 v73, v70, v71
    v_xor_b32 v68, 64, v88
    ds_write_b64 v68, v[72:73] offset:0
    v_mfma_f32_32x32x16_bf16 v[160:175], v[16:19], v[4:7], v[160:175]
    ds_read_b64_tr_b16 v[50:51], v104 offset:13312
    v_accvgpr_read_b32 v74, a100
    v_accvgpr_read_b32 v75, a101
    v_accvgpr_read_b32 v76, a102
    v_accvgpr_read_b32 v77, a103
    v_mfma_f32_32x32x16_bf16 v[176:191], v[20:23], v[4:7], v[176:191]
    ds_read_b64_tr_b16 v[52:53], v105 offset:12288
    v_cvt_pk_bf16_f32 v78, v74, v75
    v_cvt_pk_bf16_f32 v79, v76, v77
    v_xor_b32 v74, 64, v88
    ds_write_b64 v74, v[78:79] offset:8
    v_mfma_f32_32x32x16_bf16 v[192:207], v[16:19], v[8:11], v[192:207]
    ds_read_b64_tr_b16 v[54:55], v105 offset:13312
    v_accvgpr_read_b32 v122, a104
    v_accvgpr_read_b32 v123, a105
    v_accvgpr_read_b32 v124, a106
    v_accvgpr_read_b32 v125, a107
    v_mfma_f32_32x32x16_bf16 v[208:223], v[20:23], v[8:11], v[208:223]
    ds_read_b128 v[36:39], v87 offset:4096
    v_cvt_pk_bf16_f32 v126, v122, v123
    v_cvt_pk_bf16_f32 v127, v124, v125
    v_xor_b32 v122, 96, v88
    ds_write_b64 v122, v[126:127] offset:0
    v_mfma_f32_32x32x16_bf16 v[224:239], v[16:19], v[12:15], v[224:239]
    ds_read_b128 v[40:43], v87 offset:8192
    v_accvgpr_read_b32 v68, a108
    v_accvgpr_read_b32 v69, a109
    v_accvgpr_read_b32 v70, a110
    v_accvgpr_read_b32 v71, a111
    v_mfma_f32_32x32x16_bf16 v[240:255], v[20:23], v[12:15], v[240:255]
    ds_read_b128 v[44:47], v87 offset:12288
    v_cvt_pk_bf16_f32 v72, v68, v69
    v_cvt_pk_bf16_f32 v73, v70, v71
    v_xor_b32 v68, 96, v88
    ds_write_b64 v68, v[72:73] offset:8
    s_waitcnt lgkmcnt(0)
    s_waitcnt vmcnt(20)
    s_barrier
    v_mfma_f32_32x32x16_bf16 v[128:143], v[48:51], v[32:35], v[128:143]
    v_add_u32 v84, 0xc000, v84
    s_add_u32 m0, s45, 0
    v_add_u32 v85, 0xc000, v85
    buffer_load_dwordx4 v92, s[48:51], s29 offen lds
    s_add_u32 m0, s45, 1024
    s_nop 0
    buffer_load_dwordx4 v93, s[48:51], s29 offen lds
    ds_read_b128 v[106:109], v89 offset:0
    v_mfma_f32_32x32x16_bf16 v[144:159], v[52:55], v[32:35], v[144:159]
    v_add_u32 v86, 0xc000, v86
    s_add_u32 m0, s45, 2048
    v_add_u32 v87, 0xc000, v87
    buffer_load_dwordx4 v94, s[48:51], s29 offen lds
    v_mfma_f32_32x32x16_bf16 v[160:175], v[48:51], v[36:39], v[160:175]
    v_add_u32 v104, 0xc000, v104
    s_add_u32 m0, s45, 3072
    v_add_u32 v105, 0xc000, v105
    buffer_load_dwordx4 v95, s[48:51], s29 offen lds
    ds_read_b128 v[110:113], v89 offset:1024
    v_mfma_f32_32x32x16_bf16 v[176:191], v[52:55], v[36:39], v[176:191]
    s_add_u32 m0, s45, 4096
    ds_read_b128 v[0:3], v84 offset:0
    buffer_load_dwordx4 v96, s[48:51], s29 offen lds
    v_mfma_f32_32x32x16_bf16 v[192:207], v[48:51], v[40:43], v[192:207]
    ds_read_b64_tr_b16 v[16:17], v104 offset:0
    s_add_u32 m0, s45, 5120
    ds_read_b64_tr_b16 v[18:19], v104 offset:1024
    buffer_load_dwordx4 v97, s[48:51], s29 offen lds
    ds_read_b128 v[114:117], v89 offset:2048
    v_mfma_f32_32x32x16_bf16 v[208:223], v[52:55], v[40:43], v[208:223]
    ds_read_b64_tr_b16 v[20:21], v105 offset:0
    s_add_u32 m0, s45, 6144
    ds_read_b64_tr_b16 v[22:23], v105 offset:1024
    buffer_load_dwordx4 v98, s[48:51], s29 offen lds
    v_mfma_f32_32x32x16_bf16 v[224:239], v[48:51], v[44:47], v[224:239]
    ds_read_b128 v[4:7], v84 offset:4096
    s_add_u32 m0, s45, 7168
    ds_read_b128 v[8:11], v84 offset:8192
    buffer_load_dwordx4 v99, s[48:51], s29 offen lds
    ds_read_b128 v[118:121], v89 offset:3072
    v_mfma_f32_32x32x16_bf16 v[240:255], v[52:55], v[44:47], v[240:255]
    ds_read_b128 v[12:15], v84 offset:12288
    s_add_u32 s29, s29, 128
    s_waitcnt lgkmcnt(0)
    v_mfma_f32_32x32x16_bf16 v[128:143], v[16:19], v[0:3], v[128:143]
    s_add_u32 m0, s28, 32768
    ds_read_b128 v[32:35], v85 offset:0
    buffer_load_dwordx4 v100, s[52:55], s30 offen lds
    s_mov_b32 s20, 262144
    buffer_store_dwordx4 v[106:109], v90, s[12:15], s20 offen sc1
    s_mov_b32 s20, 294912
    buffer_store_dwordx4 v[110:113], v90, s[12:15], s20 offen sc1
    s_mov_b32 s20, 327680
    v_mfma_f32_32x32x16_bf16 v[144:159], v[20:23], v[0:3], v[144:159]
    s_add_u32 m0, s28, 33792
    ds_read_b64_tr_b16 v[48:49], v104 offset:4096
    buffer_load_dwordx4 v101, s[52:55], s30 offen lds
    buffer_store_dwordx4 v[114:117], v90, s[12:15], s20 offen sc1
    s_mov_b32 s20, 360448
    buffer_store_dwordx4 v[118:121], v90, s[12:15], s20 offen sc1
    v_accvgpr_read_b32 v74, a160
    v_accvgpr_read_b32 v75, a161
    v_mfma_f32_32x32x16_bf16 v[160:175], v[16:19], v[4:7], v[160:175]
    ds_read_b64_tr_b16 v[50:51], v104 offset:5120
    v_accvgpr_read_b32 v76, a162
    v_accvgpr_read_b32 v77, a163
    v_cvt_pk_bf16_f32 v78, v74, v75
    v_cvt_pk_bf16_f32 v79, v76, v77
    v_xor_b32 v74, 0, v88
    v_mfma_f32_32x32x16_bf16 v[176:191], v[20:23], v[4:7], v[176:191]
    s_add_u32 m0, s28, 34816
    ds_read_b64_tr_b16 v[52:53], v105 offset:4096
    buffer_load_dwordx4 v102, s[52:55], s30 offen lds
    ds_write_b64 v74, v[78:79] offset:0
    v_accvgpr_read_b32 v122, a164
    v_accvgpr_read_b32 v123, a165
    v_accvgpr_read_b32 v124, a166
    v_accvgpr_read_b32 v125, a167
    v_mfma_f32_32x32x16_bf16 v[192:207], v[16:19], v[8:11], v[192:207]
    s_add_u32 m0, s28, 35840
    ds_read_b64_tr_b16 v[54:55], v105 offset:5120
    buffer_load_dwordx4 v103, s[52:55], s30 offen lds
    v_cvt_pk_bf16_f32 v126, v122, v123
    v_cvt_pk_bf16_f32 v127, v124, v125
    v_xor_b32 v122, 0, v88
    ds_write_b64 v122, v[126:127] offset:8
    v_accvgpr_read_b32 v68, a168
    v_mfma_f32_32x32x16_bf16 v[208:223], v[20:23], v[8:11], v[208:223]
    ds_read_b128 v[36:39], v85 offset:4096
    v_accvgpr_read_b32 v69, a169
    v_accvgpr_read_b32 v70, a170
    v_accvgpr_read_b32 v71, a171
    v_cvt_pk_bf16_f32 v72, v68, v69
    v_cvt_pk_bf16_f32 v73, v70, v71
    v_mfma_f32_32x32x16_bf16 v[224:239], v[16:19], v[12:15], v[224:239]
    ds_read_b128 v[40:43], v85 offset:8192
    s_add_u32 s30, s30, 0x80000
    v_xor_b32 v68, 32, v88
    ds_write_b64 v68, v[72:73] offset:0
    v_accvgpr_read_b32 v74, a172
    v_accvgpr_read_b32 v75, a173
    v_accvgpr_read_b32 v76, a174
    v_mfma_f32_32x32x16_bf16 v[240:255], v[20:23], v[12:15], v[240:255]
    ds_read_b128 v[44:47], v85 offset:12288
    v_accvgpr_read_b32 v77, a175
    v_cvt_pk_bf16_f32 v78, v74, v75
    v_cvt_pk_bf16_f32 v79, v76, v77
    v_xor_b32 v74, 32, v88
    ds_write_b64 v74, v[78:79] offset:8
    s_waitcnt lgkmcnt(0)
    v_mfma_f32_32x32x16_bf16 v[128:143], v[48:51], v[32:35], v[128:143]
    ds_read_b128 v[0:3], v86 offset:0
    v_accvgpr_read_b32 v122, a224
    v_accvgpr_read_b32 v123, a225
    v_accvgpr_read_b32 v124, a226
    v_accvgpr_read_b32 v125, a227
    v_mfma_f32_32x32x16_bf16 v[144:159], v[52:55], v[32:35], v[144:159]
    ds_read_b64_tr_b16 v[16:17], v104 offset:8192
    v_cvt_pk_bf16_f32 v126, v122, v123
    v_cvt_pk_bf16_f32 v127, v124, v125
    v_xor_b32 v122, 64, v88
    ds_write_b64 v122, v[126:127] offset:0
    v_mfma_f32_32x32x16_bf16 v[160:175], v[48:51], v[36:39], v[160:175]
    ds_read_b64_tr_b16 v[18:19], v104 offset:9216
    v_accvgpr_read_b32 v68, a228
    v_accvgpr_read_b32 v69, a229
    v_accvgpr_read_b32 v70, a230
    v_accvgpr_read_b32 v71, a231
    v_mfma_f32_32x32x16_bf16 v[176:191], v[52:55], v[36:39], v[176:191]
    ds_read_b64_tr_b16 v[20:21], v105 offset:8192
    v_cvt_pk_bf16_f32 v72, v68, v69
    v_cvt_pk_bf16_f32 v73, v70, v71
    v_xor_b32 v68, 64, v88
    ds_write_b64 v68, v[72:73] offset:8
    v_mfma_f32_32x32x16_bf16 v[192:207], v[48:51], v[40:43], v[192:207]
    ds_read_b64_tr_b16 v[22:23], v105 offset:9216
    v_accvgpr_read_b32 v74, a232
    v_accvgpr_read_b32 v75, a233
    v_accvgpr_read_b32 v76, a234
    v_accvgpr_read_b32 v77, a235
    v_mfma_f32_32x32x16_bf16 v[208:223], v[52:55], v[40:43], v[208:223]
    ds_read_b128 v[4:7], v86 offset:4096
    v_cvt_pk_bf16_f32 v78, v74, v75
    v_cvt_pk_bf16_f32 v79, v76, v77
    v_xor_b32 v74, 96, v88
    ds_write_b64 v74, v[78:79] offset:0
    v_mfma_f32_32x32x16_bf16 v[224:239], v[48:51], v[44:47], v[224:239]
    ds_read_b128 v[8:11], v86 offset:8192
    v_accvgpr_read_b32 v122, a236
    v_accvgpr_read_b32 v123, a237
    v_accvgpr_read_b32 v124, a238
    v_accvgpr_read_b32 v125, a239
    v_mfma_f32_32x32x16_bf16 v[240:255], v[52:55], v[44:47], v[240:255]
    ds_read_b128 v[12:15], v86 offset:12288
    v_cvt_pk_bf16_f32 v126, v122, v123
    v_cvt_pk_bf16_f32 v127, v124, v125
    v_xor_b32 v122, 96, v88
    ds_write_b64 v122, v[126:127] offset:8
    s_waitcnt lgkmcnt(0)
    v_mfma_f32_32x32x16_bf16 v[128:143], v[16:19], v[0:3], v[128:143]
    ds_read_b128 v[32:35], v87 offset:0
    ds_read_b128 v[106:109], v89 offset:0
    v_mfma_f32_32x32x16_bf16 v[144:159], v[20:23], v[0:3], v[144:159]
    ds_read_b64_tr_b16 v[48:49], v104 offset:12288
    v_mfma_f32_32x32x16_bf16 v[160:175], v[16:19], v[4:7], v[160:175]
    ds_read_b64_tr_b16 v[50:51], v104 offset:13312
    ds_read_b128 v[110:113], v89 offset:1024
    v_mfma_f32_32x32x16_bf16 v[176:191], v[20:23], v[4:7], v[176:191]
    ds_read_b64_tr_b16 v[52:53], v105 offset:12288
    v_mfma_f32_32x32x16_bf16 v[192:207], v[16:19], v[8:11], v[192:207]
    ds_read_b64_tr_b16 v[54:55], v105 offset:13312
    ds_read_b128 v[114:117], v89 offset:2048
    v_mfma_f32_32x32x16_bf16 v[208:223], v[20:23], v[8:11], v[208:223]
    ds_read_b128 v[36:39], v87 offset:4096
    v_mfma_f32_32x32x16_bf16 v[224:239], v[16:19], v[12:15], v[224:239]
    ds_read_b128 v[40:43], v87 offset:8192
    ds_read_b128 v[118:121], v89 offset:3072
    v_mfma_f32_32x32x16_bf16 v[240:255], v[20:23], v[12:15], v[240:255]
    ds_read_b128 v[44:47], v87 offset:12288
    s_waitcnt lgkmcnt(0)
    s_waitcnt vmcnt(20)
    s_barrier
    v_mfma_f32_32x32x16_bf16 v[128:143], v[48:51], v[32:35], v[128:143]
    v_add_u32 v84, 0xc000, v84
    v_add_u32 v85, 0xc000, v85
    s_mov_b32 s20, 262272
    buffer_store_dwordx4 v[106:109], v90, s[12:15], s20 offen sc1
    s_mov_b32 s20, 295040
    buffer_store_dwordx4 v[110:113], v90, s[12:15], s20 offen sc1
    s_mov_b32 s20, 327808
    v_mfma_f32_32x32x16_bf16 v[144:159], v[52:55], v[32:35], v[144:159]
    v_add_u32 v86, 0xc000, v86
    v_add_u32 v87, 0xc000, v87
    buffer_store_dwordx4 v[114:117], v90, s[12:15], s20 offen sc1
    s_mov_b32 s20, 360576
    buffer_store_dwordx4 v[118:121], v90, s[12:15], s20 offen sc1
    v_accvgpr_read_b32 v68, a48
    v_accvgpr_read_b32 v69, a49
    v_mfma_f32_32x32x16_bf16 v[160:175], v[48:51], v[36:39], v[160:175]
    v_add_u32 v104, 0xc000, v104
    v_add_u32 v105, 0xc000, v105
    v_accvgpr_read_b32 v70, a50
    v_accvgpr_read_b32 v71, a51
    v_cvt_pk_bf16_f32 v72, v68, v69
    v_cvt_pk_bf16_f32 v73, v70, v71
    v_xor_b32 v68, 0, v88
    v_mfma_f32_32x32x16_bf16 v[176:191], v[52:55], v[36:39], v[176:191]
    ds_read_b128 v[0:3], v84 offset:0
    ds_write_b64 v68, v[72:73] offset:0
    v_accvgpr_read_b32 v74, a52
    v_accvgpr_read_b32 v75, a53
    v_accvgpr_read_b32 v76, a54
    v_accvgpr_read_b32 v77, a55
    v_mfma_f32_32x32x16_bf16 v[192:207], v[48:51], v[40:43], v[192:207]
    ds_read_b64_tr_b16 v[16:17], v104 offset:0
    ds_read_b64_tr_b16 v[18:19], v104 offset:1024
    v_cvt_pk_bf16_f32 v78, v74, v75
    v_cvt_pk_bf16_f32 v79, v76, v77
    v_xor_b32 v74, 0, v88
    ds_write_b64 v74, v[78:79] offset:8
    v_accvgpr_read_b32 v122, a56
    v_mfma_f32_32x32x16_bf16 v[208:223], v[52:55], v[40:43], v[208:223]
    ds_read_b64_tr_b16 v[20:21], v105 offset:0
    ds_read_b64_tr_b16 v[22:23], v105 offset:1024
    v_accvgpr_read_b32 v123, a57
    v_accvgpr_read_b32 v124, a58
    v_accvgpr_read_b32 v125, a59
    v_cvt_pk_bf16_f32 v126, v122, v123
    v_cvt_pk_bf16_f32 v127, v124, v125
    v_mfma_f32_32x32x16_bf16 v[224:239], v[48:51], v[44:47], v[224:239]
    ds_read_b128 v[4:7], v84 offset:4096
    ds_read_b128 v[8:11], v84 offset:8192
    v_xor_b32 v122, 32, v88
    ds_write_b64 v122, v[126:127] offset:0
    v_accvgpr_read_b32 v68, a60
    v_accvgpr_read_b32 v69, a61
    v_accvgpr_read_b32 v70, a62
    v_mfma_f32_32x32x16_bf16 v[240:255], v[52:55], v[44:47], v[240:255]
    ds_read_b128 v[12:15], v84 offset:12288
    v_accvgpr_read_b32 v71, a63
    v_cvt_pk_bf16_f32 v72, v68, v69
    v_cvt_pk_bf16_f32 v73, v70, v71
    v_xor_b32 v68, 32, v88
    ds_write_b64 v68, v[72:73] offset:8
    s_waitcnt lgkmcnt(0)
    v_mfma_f32_32x32x16_bf16 v[128:143], v[16:19], v[0:3], v[128:143]
    ds_read_b128 v[32:35], v85 offset:0
    v_accvgpr_read_b32 v74, a112
    v_accvgpr_read_b32 v75, a113
    v_accvgpr_read_b32 v76, a114
    v_accvgpr_read_b32 v77, a115
    v_mfma_f32_32x32x16_bf16 v[144:159], v[20:23], v[0:3], v[144:159]
    ds_read_b64_tr_b16 v[48:49], v104 offset:4096
    v_cvt_pk_bf16_f32 v78, v74, v75
    v_cvt_pk_bf16_f32 v79, v76, v77
    v_xor_b32 v74, 64, v88
    ds_write_b64 v74, v[78:79] offset:0
    v_mfma_f32_32x32x16_bf16 v[160:175], v[16:19], v[4:7], v[160:175]
    ds_read_b64_tr_b16 v[50:51], v104 offset:5120
    v_accvgpr_read_b32 v122, a116
    v_accvgpr_read_b32 v123, a117
    v_accvgpr_read_b32 v124, a118
    v_accvgpr_read_b32 v125, a119
    v_mfma_f32_32x32x16_bf16 v[176:191], v[20:23], v[4:7], v[176:191]
    ds_read_b64_tr_b16 v[52:53], v105 offset:4096
    v_cvt_pk_bf16_f32 v126, v122, v123
    v_cvt_pk_bf16_f32 v127, v124, v125
    v_xor_b32 v122, 64, v88
    ds_write_b64 v122, v[126:127] offset:8
    v_mfma_f32_32x32x16_bf16 v[192:207], v[16:19], v[8:11], v[192:207]
    ds_read_b64_tr_b16 v[54:55], v105 offset:5120
    v_accvgpr_read_b32 v68, a120
    v_accvgpr_read_b32 v69, a121
    v_accvgpr_read_b32 v70, a122
    v_accvgpr_read_b32 v71, a123
    v_mfma_f32_32x32x16_bf16 v[208:223], v[20:23], v[8:11], v[208:223]
    ds_read_b128 v[36:39], v85 offset:4096
    v_cvt_pk_bf16_f32 v72, v68, v69
    v_cvt_pk_bf16_f32 v73, v70, v71
    v_xor_b32 v68, 96, v88
    ds_write_b64 v68, v[72:73] offset:0
    v_mfma_f32_32x32x16_bf16 v[224:239], v[16:19], v[12:15], v[224:239]
    ds_read_b128 v[40:43], v85 offset:8192
    v_accvgpr_read_b32 v74, a124
    v_accvgpr_read_b32 v75, a125
    v_accvgpr_read_b32 v76, a126
    v_accvgpr_read_b32 v77, a127
    v_mfma_f32_32x32x16_bf16 v[240:255], v[20:23], v[12:15], v[240:255]
    ds_read_b128 v[44:47], v85 offset:12288
    v_cvt_pk_bf16_f32 v78, v74, v75
    v_cvt_pk_bf16_f32 v79, v76, v77
    v_xor_b32 v74, 96, v88
    ds_write_b64 v74, v[78:79] offset:8
    s_waitcnt lgkmcnt(0)
    v_mfma_f32_32x32x16_bf16 v[128:143], v[48:51], v[32:35], v[128:143]
    ds_read_b128 v[0:3], v86 offset:0
    ds_read_b128 v[106:109], v89 offset:0
    v_mfma_f32_32x32x16_bf16 v[144:159], v[52:55], v[32:35], v[144:159]
    ds_read_b64_tr_b16 v[16:17], v104 offset:8192
    v_mfma_f32_32x32x16_bf16 v[160:175], v[48:51], v[36:39], v[160:175]
    ds_read_b64_tr_b16 v[18:19], v104 offset:9216
    ds_read_b128 v[110:113], v89 offset:1024
    v_mfma_f32_32x32x16_bf16 v[176:191], v[52:55], v[36:39], v[176:191]
    ds_read_b64_tr_b16 v[20:21], v105 offset:8192
    v_mfma_f32_32x32x16_bf16 v[192:207], v[48:51], v[40:43], v[192:207]
    ds_read_b64_tr_b16 v[22:23], v105 offset:9216
    ds_read_b128 v[114:117], v89 offset:2048
    v_mfma_f32_32x32x16_bf16 v[208:223], v[52:55], v[40:43], v[208:223]
    ds_read_b128 v[4:7], v86 offset:4096
    v_mfma_f32_32x32x16_bf16 v[224:239], v[48:51], v[44:47], v[224:239]
    ds_read_b128 v[8:11], v86 offset:8192
    ds_read_b128 v[118:121], v89 offset:3072
    v_mfma_f32_32x32x16_bf16 v[240:255], v[52:55], v[44:47], v[240:255]
    ds_read_b128 v[12:15], v86 offset:12288
    s_waitcnt lgkmcnt(0)
    v_mfma_f32_32x32x16_bf16 v[128:143], v[16:19], v[0:3], v[128:143]
    ds_read_b128 v[32:35], v87 offset:0
    s_mov_b32 s20, 393216
    buffer_store_dwordx4 v[106:109], v90, s[12:15], s20 offen sc1
    s_mov_b32 s20, 425984
    buffer_store_dwordx4 v[110:113], v90, s[12:15], s20 offen sc1
    s_mov_b32 s20, 458752
    v_mfma_f32_32x32x16_bf16 v[144:159], v[20:23], v[0:3], v[144:159]
    ds_read_b64_tr_b16 v[48:49], v104 offset:12288
    buffer_store_dwordx4 v[114:117], v90, s[12:15], s20 offen sc1
    s_mov_b32 s20, 491520
    buffer_store_dwordx4 v[118:121], v90, s[12:15], s20 offen sc1
    v_accvgpr_read_b32 v122, a176
    v_accvgpr_read_b32 v123, a177
    v_mfma_f32_32x32x16_bf16 v[160:175], v[16:19], v[4:7], v[160:175]
    ds_read_b64_tr_b16 v[50:51], v104 offset:13312
    v_accvgpr_read_b32 v124, a178
    v_accvgpr_read_b32 v125, a179
    v_cvt_pk_bf16_f32 v126, v122, v123
    v_cvt_pk_bf16_f32 v127, v124, v125
    v_xor_b32 v122, 0, v88
    v_mfma_f32_32x32x16_bf16 v[176:191], v[20:23], v[4:7], v[176:191]
    ds_read_b64_tr_b16 v[52:53], v105 offset:12288
    ds_write_b64 v122, v[126:127] offset:0
    v_accvgpr_read_b32 v68, a180
    v_accvgpr_read_b32 v69, a181
    v_accvgpr_read_b32 v70, a182
    v_accvgpr_read_b32 v71, a183
    v_mfma_f32_32x32x16_bf16 v[192:207], v[16:19], v[8:11], v[192:207]
    ds_read_b64_tr_b16 v[54:55], v105 offset:13312
    v_cvt_pk_bf16_f32 v72, v68, v69
    v_cvt_pk_bf16_f32 v73, v70, v71
    v_xor_b32 v68, 0, v88
    ds_write_b64 v68, v[72:73] offset:8
    v_accvgpr_read_b32 v74, a184
    v_mfma_f32_32x32x16_bf16 v[208:223], v[20:23], v[8:11], v[208:223]
    ds_read_b128 v[36:39], v87 offset:4096
    v_accvgpr_read_b32 v75, a185
    v_accvgpr_read_b32 v76, a186
    v_accvgpr_read_b32 v77, a187
    v_cvt_pk_bf16_f32 v78, v74, v75
    v_cvt_pk_bf16_f32 v79, v76, v77
    v_mfma_f32_32x32x16_bf16 v[224:239], v[16:19], v[12:15], v[224:239]
    ds_read_b128 v[40:43], v87 offset:8192
    v_xor_b32 v74, 32, v88
    ds_write_b64 v74, v[78:79] offset:0
    v_accvgpr_read_b32 v122, a188
    v_accvgpr_read_b32 v123, a189
    v_accvgpr_read_b32 v124, a190
    v_mfma_f32_32x32x16_bf16 v[240:255], v[20:23], v[12:15], v[240:255]
    ds_read_b128 v[44:47], v87 offset:12288
    v_accvgpr_read_b32 v125, a191
    v_cvt_pk_bf16_f32 v126, v122, v123
    v_cvt_pk_bf16_f32 v127, v124, v125
    v_xor_b32 v122, 32, v88
    ds_write_b64 v122, v[126:127] offset:8
    s_waitcnt lgkmcnt(0)
    s_waitcnt vmcnt(8)
    s_barrier
    v_mfma_f32_32x32x16_bf16 v[128:143], v[48:51], v[32:35], v[128:143]
    v_add_u32 v84, 0xfffe8000, v84
    v_add_u32 v85, 0xfffe8000, v85
    v_accvgpr_read_b32 v68, a240
    v_accvgpr_read_b32 v69, a241
    v_accvgpr_read_b32 v70, a242
    v_accvgpr_read_b32 v71, a243
    v_mfma_f32_32x32x16_bf16 v[144:159], v[52:55], v[32:35], v[144:159]
    v_add_u32 v86, 0xfffe8000, v86
    v_add_u32 v87, 0xfffe8000, v87
    v_cvt_pk_bf16_f32 v72, v68, v69
    v_cvt_pk_bf16_f32 v73, v70, v71
    v_xor_b32 v68, 64, v88
    ds_write_b64 v68, v[72:73] offset:0
    v_mfma_f32_32x32x16_bf16 v[160:175], v[48:51], v[36:39], v[160:175]
    v_add_u32 v104, 0xfffe8000, v104
    v_add_u32 v105, 0xfffe8000, v105
    v_accvgpr_read_b32 v74, a244
    v_accvgpr_read_b32 v75, a245
    v_accvgpr_read_b32 v76, a246
    v_accvgpr_read_b32 v77, a247
    v_mfma_f32_32x32x16_bf16 v[176:191], v[52:55], v[36:39], v[176:191]
    ds_read_b128 v[0:3], v84 offset:0
    v_cvt_pk_bf16_f32 v78, v74, v75
    v_cvt_pk_bf16_f32 v79, v76, v77
    v_xor_b32 v74, 64, v88
    ds_write_b64 v74, v[78:79] offset:8
    v_mfma_f32_32x32x16_bf16 v[192:207], v[48:51], v[40:43], v[192:207]
    ds_read_b64_tr_b16 v[16:17], v104 offset:0
    ds_read_b64_tr_b16 v[18:19], v104 offset:1024
    v_accvgpr_read_b32 v122, a248
    v_accvgpr_read_b32 v123, a249
    v_accvgpr_read_b32 v124, a250
    v_accvgpr_read_b32 v125, a251
    v_mfma_f32_32x32x16_bf16 v[208:223], v[52:55], v[40:43], v[208:223]
    ds_read_b64_tr_b16 v[20:21], v105 offset:0
    ds_read_b64_tr_b16 v[22:23], v105 offset:1024
    v_cvt_pk_bf16_f32 v126, v122, v123
    v_cvt_pk_bf16_f32 v127, v124, v125
    v_xor_b32 v122, 96, v88
    ds_write_b64 v122, v[126:127] offset:0
    v_mfma_f32_32x32x16_bf16 v[224:239], v[48:51], v[44:47], v[224:239]
    ds_read_b128 v[4:7], v84 offset:4096
    ds_read_b128 v[8:11], v84 offset:8192
    v_accvgpr_read_b32 v68, a252
    v_accvgpr_read_b32 v69, a253
    v_accvgpr_read_b32 v70, a254
    v_accvgpr_read_b32 v71, a255
    v_mfma_f32_32x32x16_bf16 v[240:255], v[52:55], v[44:47], v[240:255]
    ds_read_b128 v[12:15], v84 offset:12288
    v_cvt_pk_bf16_f32 v72, v68, v69
    v_cvt_pk_bf16_f32 v73, v70, v71
    v_xor_b32 v68, 96, v88
    ds_write_b64 v68, v[72:73] offset:8
    s_waitcnt lgkmcnt(0)
    v_mfma_f32_32x32x16_bf16 v[128:143], v[16:19], v[0:3], v[128:143]
    ds_read_b128 v[32:35], v85 offset:0
    ds_read_b128 v[106:109], v89 offset:0
    v_mfma_f32_32x32x16_bf16 v[144:159], v[20:23], v[0:3], v[144:159]
    ds_read_b64_tr_b16 v[48:49], v104 offset:4096
    v_mfma_f32_32x32x16_bf16 v[160:175], v[16:19], v[4:7], v[160:175]
    ds_read_b64_tr_b16 v[50:51], v104 offset:5120
    ds_read_b128 v[110:113], v89 offset:1024
    v_mfma_f32_32x32x16_bf16 v[176:191], v[20:23], v[4:7], v[176:191]
    ds_read_b64_tr_b16 v[52:53], v105 offset:4096
    v_mfma_f32_32x32x16_bf16 v[192:207], v[16:19], v[8:11], v[192:207]
    ds_read_b64_tr_b16 v[54:55], v105 offset:5120
    ds_read_b128 v[114:117], v89 offset:2048
    v_mfma_f32_32x32x16_bf16 v[208:223], v[20:23], v[8:11], v[208:223]
    ds_read_b128 v[36:39], v85 offset:4096
    v_mfma_f32_32x32x16_bf16 v[224:239], v[16:19], v[12:15], v[224:239]
    ds_read_b128 v[40:43], v85 offset:8192
    ds_read_b128 v[118:121], v89 offset:3072
    v_mfma_f32_32x32x16_bf16 v[240:255], v[20:23], v[12:15], v[240:255]
    ds_read_b128 v[44:47], v85 offset:12288
    s_waitcnt lgkmcnt(0)
    v_mfma_f32_32x32x16_bf16 v[128:143], v[48:51], v[32:35], v[128:143]
    ds_read_b128 v[0:3], v86 offset:0
    s_mov_b32 s20, 393344
    v_mfma_f32_32x32x16_bf16 v[144:159], v[52:55], v[32:35], v[144:159]
    ds_read_b64_tr_b16 v[16:17], v104 offset:8192
    buffer_store_dwordx4 v[106:109], v90, s[12:15], s20 offen sc1
    v_mfma_f32_32x32x16_bf16 v[160:175], v[48:51], v[36:39], v[160:175]
    ds_read_b64_tr_b16 v[18:19], v104 offset:9216
    s_mov_b32 s20, 426112
    v_mfma_f32_32x32x16_bf16 v[176:191], v[52:55], v[36:39], v[176:191]
    ds_read_b64_tr_b16 v[20:21], v105 offset:8192
    buffer_store_dwordx4 v[110:113], v90, s[12:15], s20 offen sc1
    v_mfma_f32_32x32x16_bf16 v[192:207], v[48:51], v[40:43], v[192:207]
    ds_read_b64_tr_b16 v[22:23], v105 offset:9216
    s_mov_b32 s20, 458880
    v_mfma_f32_32x32x16_bf16 v[208:223], v[52:55], v[40:43], v[208:223]
    ds_read_b128 v[4:7], v86 offset:4096
    buffer_store_dwordx4 v[114:117], v90, s[12:15], s20 offen sc1
    v_mfma_f32_32x32x16_bf16 v[224:239], v[48:51], v[44:47], v[224:239]
    ds_read_b128 v[8:11], v86 offset:8192
    s_mov_b32 s20, 491648
    v_mfma_f32_32x32x16_bf16 v[240:255], v[52:55], v[44:47], v[240:255]
    ds_read_b128 v[12:15], v86 offset:12288
    buffer_store_dwordx4 v[118:121], v90, s[12:15], s20 offen sc1
    s_waitcnt lgkmcnt(0)
    v_mfma_f32_32x32x16_bf16 v[128:143], v[16:19], v[0:3], v[128:143]
    ds_read_b128 v[32:35], v87 offset:0
    v_mfma_f32_32x32x16_bf16 v[144:159], v[20:23], v[0:3], v[144:159]
    ds_read_b64_tr_b16 v[48:49], v104 offset:12288
    v_mfma_f32_32x32x16_bf16 v[160:175], v[16:19], v[4:7], v[160:175]
    ds_read_b64_tr_b16 v[50:51], v104 offset:13312
    v_mfma_f32_32x32x16_bf16 v[176:191], v[20:23], v[4:7], v[176:191]
    ds_read_b64_tr_b16 v[52:53], v105 offset:12288
    v_mfma_f32_32x32x16_bf16 v[192:207], v[16:19], v[8:11], v[192:207]
    ds_read_b64_tr_b16 v[54:55], v105 offset:13312
    v_mfma_f32_32x32x16_bf16 v[208:223], v[20:23], v[8:11], v[208:223]
    ds_read_b128 v[36:39], v87 offset:4096
    v_mfma_f32_32x32x16_bf16 v[224:239], v[16:19], v[12:15], v[224:239]
    ds_read_b128 v[40:43], v87 offset:8192
    v_mfma_f32_32x32x16_bf16 v[240:255], v[20:23], v[12:15], v[240:255]
    ds_read_b128 v[44:47], v87 offset:12288
    s_waitcnt lgkmcnt(0)
    v_mfma_f32_32x32x16_bf16 v[128:143], v[48:51], v[32:35], v[128:143]
    v_mfma_f32_32x32x16_bf16 v[144:159], v[52:55], v[32:35], v[144:159]
    v_mfma_f32_32x32x16_bf16 v[160:175], v[48:51], v[36:39], v[160:175]
    v_mfma_f32_32x32x16_bf16 v[176:191], v[52:55], v[36:39], v[176:191]
    v_mfma_f32_32x32x16_bf16 v[192:207], v[48:51], v[40:43], v[192:207]
    v_mfma_f32_32x32x16_bf16 v[208:223], v[52:55], v[40:43], v[208:223]
    v_mfma_f32_32x32x16_bf16 v[224:239], v[48:51], v[44:47], v[224:239]
    v_mfma_f32_32x32x16_bf16 v[240:255], v[52:55], v[44:47], v[240:255]
    s_barrier
    s_nop 7
    s_and_b32 s25, s16, 1
    s_lshr_b32 s26, s16, 1
    s_lshl_b32 s25, s25, 7
    s_lshl_b32 s26, s26, 6
    s_add_u32 s25, s25, s22
    s_add_u32 s26, s26, s24
    s_mul_i32 s31, s16, 18432
    v_mul_u32_u24 v88, 144, v66
    v_lshl_add_u32 v88, v65, 3, v88
    v_add_u32 v88, s31, v88
    v_lshrrev_b32 v89, 3, v64
    v_mul_u32_u24 v89, 144, v89
    v_and_b32 v90, 7, v64
    v_lshl_add_u32 v89, v90, 4, v89
    v_add_u32 v89, s31, v89
    v_lshrrev_b32 v91, 3, v64
    v_add_u32 v91, s25, v91
    v_lshlrev_b32 v91, 13, v91
    v_lshl_add_u32 v90, v90, 4, v91
    s_lshl_b32 s26, s26, 1
    v_add_u32 v90, s26, v90
    v_cvt_pk_bf16_f32 v0, v128, v129
    v_cvt_pk_bf16_f32 v1, v130, v131
    ds_write_b64 v88, v[0:1] offset:0
    v_cvt_pk_bf16_f32 v2, v132, v133
    v_cvt_pk_bf16_f32 v3, v134, v135
    ds_write_b64 v88, v[2:3] offset:16
    v_cvt_pk_bf16_f32 v4, v136, v137
    v_cvt_pk_bf16_f32 v5, v138, v139
    ds_write_b64 v88, v[4:5] offset:32
    v_cvt_pk_bf16_f32 v6, v140, v141
    v_cvt_pk_bf16_f32 v7, v142, v143
    ds_write_b64 v88, v[6:7] offset:48
    v_cvt_pk_bf16_f32 v8, v144, v145
    v_cvt_pk_bf16_f32 v9, v146, v147
    ds_write_b64 v88, v[8:9] offset:64
    v_cvt_pk_bf16_f32 v10, v148, v149
    v_cvt_pk_bf16_f32 v11, v150, v151
    ds_write_b64 v88, v[10:11] offset:80
    v_cvt_pk_bf16_f32 v12, v152, v153
    v_cvt_pk_bf16_f32 v13, v154, v155
    ds_write_b64 v88, v[12:13] offset:96
    v_cvt_pk_bf16_f32 v14, v156, v157
    v_cvt_pk_bf16_f32 v15, v158, v159
    ds_write_b64 v88, v[14:15] offset:112
    v_cvt_pk_bf16_f32 v16, v160, v161
    v_cvt_pk_bf16_f32 v17, v162, v163
    ds_write_b64 v88, v[16:17] offset:4608
    v_cvt_pk_bf16_f32 v18, v164, v165
    v_cvt_pk_bf16_f32 v19, v166, v167
    ds_write_b64 v88, v[18:19] offset:4624
    v_cvt_pk_bf16_f32 v20, v168, v169
    v_cvt_pk_bf16_f32 v21, v170, v171
    ds_write_b64 v88, v[20:21] offset:4640
    v_cvt_pk_bf16_f32 v22, v172, v173
    v_cvt_pk_bf16_f32 v23, v174, v175
    ds_write_b64 v88, v[22:23] offset:4656
    v_cvt_pk_bf16_f32 v24, v176, v177
    v_cvt_pk_bf16_f32 v25, v178, v179
    ds_write_b64 v88, v[24:25] offset:4672
    v_cvt_pk_bf16_f32 v26, v180, v181
    v_cvt_pk_bf16_f32 v27, v182, v183
    ds_write_b64 v88, v[26:27] offset:4688
    v_cvt_pk_bf16_f32 v28, v184, v185
    v_cvt_pk_bf16_f32 v29, v186, v187
    ds_write_b64 v88, v[28:29] offset:4704
    v_cvt_pk_bf16_f32 v30, v188, v189
    v_cvt_pk_bf16_f32 v31, v190, v191
    ds_write_b64 v88, v[30:31] offset:4720
    v_cvt_pk_bf16_f32 v0, v192, v193
    v_cvt_pk_bf16_f32 v1, v194, v195
    ds_write_b64 v88, v[0:1] offset:9216
    v_cvt_pk_bf16_f32 v2, v196, v197
    v_cvt_pk_bf16_f32 v3, v198, v199
    ds_write_b64 v88, v[2:3] offset:9232
    v_cvt_pk_bf16_f32 v4, v200, v201
    v_cvt_pk_bf16_f32 v5, v202, v203
    ds_write_b64 v88, v[4:5] offset:9248
    v_cvt_pk_bf16_f32 v6, v204, v205
    v_cvt_pk_bf16_f32 v7, v206, v207
    ds_write_b64 v88, v[6:7] offset:9264
    v_cvt_pk_bf16_f32 v8, v208, v209
    v_cvt_pk_bf16_f32 v9, v210, v211
    ds_write_b64 v88, v[8:9] offset:9280
    v_cvt_pk_bf16_f32 v10, v212, v213
    v_cvt_pk_bf16_f32 v11, v214, v215
    ds_write_b64 v88, v[10:11] offset:9296
    v_cvt_pk_bf16_f32 v12, v216, v217
    v_cvt_pk_bf16_f32 v13, v218, v219
    ds_write_b64 v88, v[12:13] offset:9312
    v_cvt_pk_bf16_f32 v14, v220, v221
    v_cvt_pk_bf16_f32 v15, v222, v223
    ds_write_b64 v88, v[14:15] offset:9328
    v_cvt_pk_bf16_f32 v16, v224, v225
    v_cvt_pk_bf16_f32 v17, v226, v227
    ds_write_b64 v88, v[16:17] offset:13824
    v_cvt_pk_bf16_f32 v18, v228, v229
    v_cvt_pk_bf16_f32 v19, v230, v231
    ds_write_b64 v88, v[18:19] offset:13840
    v_cvt_pk_bf16_f32 v20, v232, v233
    v_cvt_pk_bf16_f32 v21, v234, v235
    ds_write_b64 v88, v[20:21] offset:13856
    v_cvt_pk_bf16_f32 v22, v236, v237
    v_cvt_pk_bf16_f32 v23, v238, v239
    ds_write_b64 v88, v[22:23] offset:13872
    v_cvt_pk_bf16_f32 v24, v240, v241
    v_cvt_pk_bf16_f32 v25, v242, v243
    ds_write_b64 v88, v[24:25] offset:13888
    v_cvt_pk_bf16_f32 v26, v244, v245
    v_cvt_pk_bf16_f32 v27, v246, v247
    ds_write_b64 v88, v[26:27] offset:13904
    v_cvt_pk_bf16_f32 v28, v248, v249
    v_cvt_pk_bf16_f32 v29, v250, v251
    ds_write_b64 v88, v[28:29] offset:13920
    v_cvt_pk_bf16_f32 v30, v252, v253
    v_cvt_pk_bf16_f32 v31, v254, v255
    ds_write_b64 v88, v[30:31] offset:13936
    s_waitcnt lgkmcnt(0)
    ds_read_b128 v[128:131], v89 offset:0
    ds_read_b128 v[132:135], v89 offset:1152
    ds_read_b128 v[136:139], v89 offset:2304
    ds_read_b128 v[140:143], v89 offset:3456
    ds_read_b128 v[144:147], v89 offset:4608
    ds_read_b128 v[148:151], v89 offset:5760
    ds_read_b128 v[152:155], v89 offset:6912
    ds_read_b128 v[156:159], v89 offset:8064
    ds_read_b128 v[160:163], v89 offset:9216
    ds_read_b128 v[164:167], v89 offset:10368
    ds_read_b128 v[168:171], v89 offset:11520
    ds_read_b128 v[172:175], v89 offset:12672
    ds_read_b128 v[176:179], v89 offset:13824
    ds_read_b128 v[180:183], v89 offset:14976
    ds_read_b128 v[184:187], v89 offset:16128
    ds_read_b128 v[188:191], v89 offset:17280
    s_waitcnt lgkmcnt(15)
    s_mov_b32 s25, 0
    buffer_store_dwordx4 v[128:131], v90, s[56:59], s25 offen sc1
    s_waitcnt lgkmcnt(14)
    s_mov_b32 s25, 65536
    buffer_store_dwordx4 v[132:135], v90, s[56:59], s25 offen sc1
    s_waitcnt lgkmcnt(13)
    s_mov_b32 s25, 131072
    buffer_store_dwordx4 v[136:139], v90, s[56:59], s25 offen sc1
    s_waitcnt lgkmcnt(12)
    s_mov_b32 s25, 196608
    buffer_store_dwordx4 v[140:143], v90, s[56:59], s25 offen sc1
    s_waitcnt lgkmcnt(11)
    s_mov_b32 s25, 262144
    buffer_store_dwordx4 v[144:147], v90, s[56:59], s25 offen sc1
    s_waitcnt lgkmcnt(10)
    s_mov_b32 s25, 327680
    buffer_store_dwordx4 v[148:151], v90, s[56:59], s25 offen sc1
    s_waitcnt lgkmcnt(9)
    s_mov_b32 s25, 393216
    buffer_store_dwordx4 v[152:155], v90, s[56:59], s25 offen sc1
    s_waitcnt lgkmcnt(8)
    s_mov_b32 s25, 458752
    buffer_store_dwordx4 v[156:159], v90, s[56:59], s25 offen sc1
    s_waitcnt lgkmcnt(7)
    s_mov_b32 s25, 524288
    buffer_store_dwordx4 v[160:163], v90, s[56:59], s25 offen sc1
    s_waitcnt lgkmcnt(6)
    s_mov_b32 s25, 589824
    buffer_store_dwordx4 v[164:167], v90, s[56:59], s25 offen sc1
    s_waitcnt lgkmcnt(5)
    s_mov_b32 s25, 655360
    buffer_store_dwordx4 v[168:171], v90, s[56:59], s25 offen sc1
    s_waitcnt lgkmcnt(4)
    s_mov_b32 s25, 720896
    buffer_store_dwordx4 v[172:175], v90, s[56:59], s25 offen sc1
    s_waitcnt lgkmcnt(3)
    s_mov_b32 s25, 786432
    buffer_store_dwordx4 v[176:179], v90, s[56:59], s25 offen sc1
    s_waitcnt lgkmcnt(2)
    s_mov_b32 s25, 851968
    buffer_store_dwordx4 v[180:183], v90, s[56:59], s25 offen sc1
    s_waitcnt lgkmcnt(1)
    s_mov_b32 s25, 917504
    buffer_store_dwordx4 v[184:187], v90, s[56:59], s25 offen sc1
    s_waitcnt lgkmcnt(0)
    s_mov_b32 s25, 983040
    buffer_store_dwordx4 v[188:191], v90, s[56:59], s25 offen sc1
    s_endpgm
L_proj_end:
    s_endpgm
L_end_proj:
.text
.globl attn_kernel
.p2align 8
.type attn_kernel,@function
attn_kernel:
    s_cmp_ge_u32 s2, 256
    s_cbranch_scc1 L_attn_conv
    s_load_dwordx2 s[50:51], s[0:1], 120
    s_load_dwordx2 s[52:53], s[0:1], 112
    s_getpc_b64 s[60:61]
L_cpf_attn:
    s_bfe_u32 s62, s2, 0x50003
    s_lshl_b32 s62, s62, 12
    v_lshlrev_b32 v2, 4, v0
    v_add_u32 v2, s62, v2
    v_min_u32 v2, L_end_attn-L_cpf_attn-16, v2
    global_load_dwordx4 v[128:131], v2, s[60:61]
    v_lshrrev_b32 v1, 6, v0
    v_and_b32 v0, 63, v0
    s_nop 0
    v_readfirstlane_b32 s24, v1
    s_and_b32 s30, s2, 7
    s_lshl_b32 s30, s30, 1
    s_bfe_u32 s31, s2, 0x10003
    s_add_u32 s25, s30, s31
    s_lshr_b32 s30, s2, 4
    s_waitcnt lgkmcnt(0)
    s_mov_b32 s4, s50
    s_and_b32 s5, s51, 0xffff
    s_mov_b32 s6, 0x1000000
    s_mov_b32 s7, 0x00020000
    s_add_u32 s54, s50, 0x1000000
    s_addc_u32 s55, s51, 0
    s_mov_b32 s8, s54
    s_and_b32 s9, s55, 0xffff
    s_mov_b32 s10, 0x1000000
    s_mov_b32 s11, 0x00020000
    s_add_u32 s54, s50, 0x2000000
    s_addc_u32 s55, s51, 0
    s_mov_b32 s12, s54
    s_and_b32 s13, s55, 0xffff
    s_mov_b32 s14, 0x1000000
    s_mov_b32 s15, 0x00020000
    s_mov_b32 s16, s52
    s_and_b32 s17, s53, 0xffff
    s_mov_b32 s18, 0x100
    s_mov_b32 s19, 0x00020000
    s_add_u32 s54, s50, 0x3000000
    s_addc_u32 s55, s51, 0
    s_mov_b32 s20, s54
    s_and_b32 s21, s55, 0xffff
    s_mov_b32 s22, 0x2000000
    s_mov_b32 s23, 0x00020000
    s_add_u32 s54, s50, 0xaa00000
    s_addc_u32 s55, s51, 0
    s_mov_b32 s56, s54
    s_and_b32 s57, s55, 0xffff
    s_mov_b32 s58, 0x80000
    s_mov_b32 s59, 0x00020000
    s_mov_b32 s34, 0x3db8aa3b
    s_mov_b32 s49, 0x42b17218
    s_mov_b32 s38, -1
    s_mov_b32 s35, 0
    s_mov_b32 s37, 0
    s_cmp_ge_u32 s30, 7
    s_cbranch_scc1 L_attn_r6
    s_mov_b32 s38, s30
    s_sub_u32 s26, 15, s38
    s_mov_b32 s35, 18
    s_sub_u32 s36, 6, s38
    s_mov_b32 s37, 1
    s_branch L_attn_item
L_attn_r6:
    s_cmp_ge_u32 s30, 14
    s_cbranch_scc1 L_attn_r12
    s_sub_u32 s26, 22, s30
    s_mov_b32 s36, 8
    s_branch L_attn_item
L_attn_r12:
    s_sub_u32 s26, 22, s30
    s_mov_b32 s36, s26
L_attn_item:
    v_mbcnt_lo_u32_b32 v252, -1, 0
    v_mbcnt_hi_u32_b32 v252, -1, v252
    v_lshrrev_b32 v253, 5, v252
    v_and_b32 v254, 31, v252
    s_lshl_b32 s30, s26, 7
    s_lshl_b32 s31, s24, 5
    s_add_u32 s30, s30, s31
    v_add_u32 v208, s30, v254
    v_lshlrev_b32 v208, 13, v208
    v_lshl_add_u32 v208, v253, 4, v208
    s_lshl_b32 s31, s25, 9
    buffer_load_dwordx4 a[0:3], v208, s[4:7], s31 offen offset:0
    buffer_load_dwordx4 a[4:7], v208, s[4:7], s31 offen offset:32
    buffer_load_dwordx4 a[8:11], v208, s[4:7], s31 offen offset:64
    buffer_load_dwordx4 a[12:15], v208, s[4:7], s31 offen offset:96
    buffer_load_dwordx4 a[16:19], v208, s[4:7], s31 offen offset:128
    buffer_load_dwordx4 a[20:23], v208, s[4:7], s31 offen offset:160
    buffer_load_dwordx4 a[24:27], v208, s[4:7], s31 offen offset:192
    buffer_load_dwordx4 a[28:31], v208, s[4:7], s31 offen offset:224
    buffer_load_dwordx4 a[32:35], v208, s[4:7], s31 offen offset:256
    buffer_load_dwordx4 a[36:39], v208, s[4:7], s31 offen offset:288
    buffer_load_dwordx4 a[40:43], v208, s[4:7], s31 offen offset:320
    buffer_load_dwordx4 a[44:47], v208, s[4:7], s31 offen offset:352
    buffer_load_dwordx4 a[48:51], v208, s[4:7], s31 offen offset:384
    buffer_load_dwordx4 a[52:55], v208, s[4:7], s31 offen offset:416
    buffer_load_dwordx4 a[56:59], v208, s[4:7], s31 offen offset:448
    buffer_load_dwordx4 a[60:63], v208, s[4:7], s31 offen offset:480
    s_lshl_b32 s30, s36, 1
    s_add_u32 s30, s30, s35
    s_lshl_b32 s31, s26, 1
    s_sub_u32 s30, s31, s30
    s_lshl_b32 s30, s30, 6
    s_lshl_b32 s31, s24, 5
    s_add_u32 s30, s30, s31
    v_add_u32 v222, s30, v254
    v_lshlrev_b32 v209, 2, v253
    v_sub_u32 v222, v222, v209
    v_mov_b32 v223, 0xd06e6b28
    v_mov_b32 v220, 0xf149f2ca
    v_mov_b32 v221, 0
    v_mov_b32 v255, 0
    s_lshl_b32 s30, s24, 4
    s_lshl_b32 s31, s25, 9
    v_add_u32 v208, 0, v253
    v_xor_b32 v209, v208, v254
    v_add_u32 v208, s30, v208
    v_lshlrev_b32 v208, 13, v208
    v_lshl_add_u32 v208, v209, 4, v208
    v_add_u32 v236, s31, v208
    v_add_u32 v208, 2, v253
    v_xor_b32 v209, v208, v254
    v_add_u32 v208, s30, v208
    v_lshlrev_b32 v208, 13, v208
    v_lshl_add_u32 v208, v209, 4, v208
    v_add_u32 v237, s31, v208
    v_add_u32 v208, 4, v253
    v_xor_b32 v209, v208, v254
    v_add_u32 v208, s30, v208
    v_lshlrev_b32 v208, 13, v208
    v_lshl_add_u32 v208, v209, 4, v208
    v_add_u32 v238, s31, v208
    v_add_u32 v208, 6, v253
    v_xor_b32 v209, v208, v254
    v_add_u32 v208, s30, v208
    v_lshlrev_b32 v208, 13, v208
    v_lshl_add_u32 v208, v209, 4, v208
    v_add_u32 v239, s31, v208
    v_add_u32 v208, 8, v253
    v_xor_b32 v209, v208, v254
    v_add_u32 v208, s30, v208
    v_lshlrev_b32 v208, 13, v208
    v_lshl_add_u32 v208, v209, 4, v208
    v_add_u32 v240, s31, v208
    v_add_u32 v208, 10, v253
    v_xor_b32 v209, v208, v254
    v_add_u32 v208, s30, v208
    v_lshlrev_b32 v208, 13, v208
    v_lshl_add_u32 v208, v209, 4, v208
    v_add_u32 v241, s31, v208
    v_add_u32 v208, 12, v253
    v_xor_b32 v209, v208, v254
    v_add_u32 v208, s30, v208
    v_lshlrev_b32 v208, 13, v208
    v_lshl_add_u32 v208, v209, 4, v208
    v_add_u32 v242, s31, v208
    v_add_u32 v208, 14, v253
    v_xor_b32 v209, v208, v254
    v_add_u32 v208, s30, v208
    v_lshlrev_b32 v208, 13, v208
    v_lshl_add_u32 v208, v209, 4, v208
    v_add_u32 v243, s31, v208
    s_lshl_b32 s30, s25, 8
    s_lshl_b32 s31, s24, 6
    s_add_u32 s30, s30, s31
    v_lshrrev_b32 v208, 3, v252
    v_add_u32 v208, s30, v208
    v_lshlrev_b32 v208, 12, v208
    v_and_b32 v209, 7, v252
    v_lshrrev_b32 v210, 4, v252
    v_xor_b32 v209, v209, v210
    v_xor_b32 v210, 4, v209
    v_lshlrev_b32 v209, 4, v209
    v_lshlrev_b32 v210, 4, v210
    v_add_u32 v244, v208, v209
    v_add_u32 v208, 0x8000, v208
    v_add_u32 v245, v208, v210
    v_add_u32 v208, 0x8000, v208
    v_add_u32 v246, v208, v209
    v_add_u32 v208, 0x8000, v208
    v_add_u32 v247, v208, v210
    v_add_u32 v208, 0x8000, v208
    v_add_u32 v248, v208, v209
    v_add_u32 v208, 0x8000, v208
    v_add_u32 v249, v208, v210
    v_add_u32 v208, 0x8000, v208
    v_add_u32 v250, v208, v209
    v_add_u32 v208, 0x8000, v208
    v_add_u32 v251, v208, v210
    v_and_b32 v208, 15, v252
    v_xor_b32 v208, v208, v253
    v_lshlrev_b32 v209, 9, v254
    v_xor_b32 v210, 0, v208
    v_lshl_add_u32 v224, v210, 4, v209
    v_xor_b32 v210, 2, v208
    v_lshl_add_u32 v225, v210, 4, v209
    v_xor_b32 v210, 4, v208
    v_lshl_add_u32 v226, v210, 4, v209
    v_xor_b32 v210, 6, v208
    v_lshl_add_u32 v227, v210, 4, v209
    v_xor_b32 v210, 8, v208
    v_lshl_add_u32 v228, v210, 4, v209
    v_xor_b32 v210, 10, v208
    v_lshl_add_u32 v229, v210, 4, v209
    v_xor_b32 v210, 12, v208
    v_lshl_add_u32 v230, v210, 4, v209
    v_xor_b32 v210, 14, v208
    v_lshl_add_u32 v231, v210, 4, v209
    v_bfe_u32 v208, v252, 1, 3
    v_xor_b32 v208, v208, v253
    v_lshlrev_b32 v209, 7, v254
    v_add_u32 v209, 0x10000, v209
    v_xor_b32 v210, 0, v208
    v_lshl_add_u32 v232, v210, 4, v209
    v_xor_b32 v210, 2, v208
    v_lshl_add_u32 v233, v210, 4, v209
    v_xor_b32 v210, 4, v208
    v_lshl_add_u32 v234, v210, 4, v209
    v_xor_b32 v210, 6, v208
    v_lshl_add_u32 v235, v210, 4, v209
    s_lshl_b32 s32, s24, 13
    s_lshl_b32 s28, s35, 19
    s_lshl_b32 s29, s35, 7
    s_add_u32 m0, s32, 0
    s_nop 0
    buffer_load_dwordx4 v236, s[8:11], s28 offen lds
    s_add_u32 m0, s32, 1024
    s_nop 0
    buffer_load_dwordx4 v237, s[8:11], s28 offen lds
    s_add_u32 m0, s32, 2048
    s_nop 0
    buffer_load_dwordx4 v238, s[8:11], s28 offen lds
    s_add_u32 m0, s32, 3072
    s_nop 0
    buffer_load_dwordx4 v239, s[8:11], s28 offen lds
    s_add_u32 m0, s32, 4096
    s_nop 0
    buffer_load_dwordx4 v240, s[8:11], s28 offen lds
    s_add_u32 m0, s32, 5120
    s_nop 0
    buffer_load_dwordx4 v241, s[8:11], s28 offen lds
    s_add_u32 m0, s32, 6144
    s_nop 0
    buffer_load_dwordx4 v242, s[8:11], s28 offen lds
    s_add_u32 m0, s32, 7168
    s_nop 0
    buffer_load_dwordx4 v243, s[8:11], s28 offen lds
    s_add_u32 s28, s28, 0x80000
    s_add_u32 m0, s32, 65536
    s_nop 0
    buffer_load_dwordx4 v244, s[12:15], s29 offen lds
    s_add_u32 m0, s32, 66560
    s_nop 0
    buffer_load_dwordx4 v245, s[12:15], s29 offen lds
    s_add_u32 m0, s32, 67584
    s_nop 0
    buffer_load_dwordx4 v246, s[12:15], s29 offen lds
    s_add_u32 m0, s32, 68608
    s_nop 0
    buffer_load_dwordx4 v247, s[12:15], s29 offen lds
    s_add_u32 m0, s32, 69632
    s_nop 0
    buffer_load_dwordx4 v248, s[12:15], s29 offen lds
    s_add_u32 m0, s32, 70656
    s_nop 0
    buffer_load_dwordx4 v249, s[12:15], s29 offen lds
    s_add_u32 m0, s32, 71680
    s_nop 0
    buffer_load_dwordx4 v250, s[12:15], s29 offen lds
    s_add_u32 m0, s32, 72704
    s_nop 0
    buffer_load_dwordx4 v251, s[12:15], s29 offen lds
    s_add_u32 s29, s29, 128
    s_add_u32 m0, s32, 32768
    s_nop 0
    buffer_load_dwordx4 v236, s[8:11], s28 offen lds
    s_add_u32 m0, s32, 33792
    s_nop 0
    buffer_load_dwordx4 v237, s[8:11], s28 offen lds
    s_add_u32 m0, s32, 34816
    s_nop 0
    buffer_load_dwordx4 v238, s[8:11], s28 offen lds
    s_add_u32 m0, s32, 35840
    s_nop 0
    buffer_load_dwordx4 v239, s[8:11], s28 offen lds
    s_add_u32 m0, s32, 36864
    s_nop 0
    buffer_load_dwordx4 v240, s[8:11], s28 offen lds
    s_add_u32 m0, s32, 37888
    s_nop 0
    buffer_load_dwordx4 v241, s[8:11], s28 offen lds
    s_add_u32 m0, s32, 38912
    s_nop 0
    buffer_load_dwordx4 v242, s[8:11], s28 offen lds
    s_add_u32 m0, s32, 39936
    s_nop 0
    buffer_load_dwordx4 v243, s[8:11], s28 offen lds
    s_add_u32 s28, s28, 0x80000
    v_mov_b32 v0, 0
    v_mov_b32 v1, 0
    v_mov_b32 v2, 0
    v_mov_b32 v3, 0
    v_mov_b32 v4, 0
    v_mov_b32 v5, 0
    v_mov_b32 v6, 0
    v_mov_b32 v7, 0
    v_mov_b32 v8, 0
    v_mov_b32 v9, 0
    v_mov_b32 v10, 0
    v_mov_b32 v11, 0
    v_mov_b32 v12, 0
    v_mov_b32 v13, 0
    v_mov_b32 v14, 0
    v_mov_b32 v15, 0
    v_mov_b32 v16, 0
    v_mov_b32 v17, 0
    v_mov_b32 v18, 0
    v_mov_b32 v19, 0
    v_mov_b32 v20, 0
    v_mov_b32 v21, 0
    v_mov_b32 v22, 0
    v_mov_b32 v23, 0
    v_mov_b32 v24, 0
    v_mov_b32 v25, 0
    v_mov_b32 v26, 0
    v_mov_b32 v27, 0
    v_mov_b32 v28, 0
    v_mov_b32 v29, 0
    v_mov_b32 v30, 0
    v_mov_b32 v31, 0
    v_mov_b32 v32, 0
    v_mov_b32 v33, 0
    v_mov_b32 v34, 0
    v_mov_b32 v35, 0
    v_mov_b32 v36, 0
    v_mov_b32 v37, 0
    v_mov_b32 v38, 0
    v_mov_b32 v39, 0
    v_mov_b32 v40, 0
    v_mov_b32 v41, 0
    v_mov_b32 v42, 0
    v_mov_b32 v43, 0
    v_mov_b32 v44, 0
    v_mov_b32 v45, 0
    v_mov_b32 v46, 0
    v_mov_b32 v47, 0
    v_mov_b32 v48, 0
    v_mov_b32 v49, 0
    v_mov_b32 v50, 0
    v_mov_b32 v51, 0
    v_mov_b32 v52, 0
    v_mov_b32 v53, 0
    v_mov_b32 v54, 0
    v_mov_b32 v55, 0
    v_mov_b32 v56, 0
    v_mov_b32 v57, 0
    v_mov_b32 v58, 0
    v_mov_b32 v59, 0
    v_mov_b32 v60, 0
    v_mov_b32 v61, 0
    v_mov_b32 v62, 0
    v_mov_b32 v63, 0
    v_mov_b32 v64, 0
    v_mov_b32 v65, 0
    v_mov_b32 v66, 0
    v_mov_b32 v67, 0
    v_mov_b32 v68, 0
    v_mov_b32 v69, 0
    v_mov_b32 v70, 0
    v_mov_b32 v71, 0
    v_mov_b32 v72, 0
    v_mov_b32 v73, 0
    v_mov_b32 v74, 0
    v_mov_b32 v75, 0
    v_mov_b32 v76, 0
    v_mov_b32 v77, 0
    v_mov_b32 v78, 0
    v_mov_b32 v79, 0
    v_mov_b32 v80, 0
    v_mov_b32 v81, 0
    v_mov_b32 v82, 0
    v_mov_b32 v83, 0
    v_mov_b32 v84, 0
    v_mov_b32 v85, 0
    v_mov_b32 v86, 0
    v_mov_b32 v87, 0
    v_mov_b32 v88, 0
    v_mov_b32 v89, 0
    v_mov_b32 v90, 0
    v_mov_b32 v91, 0
    v_mov_b32 v92, 0
    v_mov_b32 v93, 0
    v_mov_b32 v94, 0
    v_mov_b32 v95, 0
    v_mov_b32 v96, 0
    v_mov_b32 v97, 0
    v_mov_b32 v98, 0
    v_mov_b32 v99, 0
    v_mov_b32 v100, 0
    v_mov_b32 v101, 0
    v_mov_b32 v102, 0
    v_mov_b32 v103, 0
    v_mov_b32 v104, 0
    v_mov_b32 v105, 0
    v_mov_b32 v106, 0
    v_mov_b32 v107, 0
    v_mov_b32 v108, 0
    v_mov_b32 v109, 0
    v_mov_b32 v110, 0
    v_mov_b32 v111, 0
    v_mov_b32 v112, 0
    v_mov_b32 v113, 0
    v_mov_b32 v114, 0
    v_mov_b32 v115, 0
    v_mov_b32 v116, 0
    v_mov_b32 v117, 0
    v_mov_b32 v118, 0
    v_mov_b32 v119, 0
    v_mov_b32 v120, 0
    v_mov_b32 v121, 0
    v_mov_b32 v122, 0
    v_mov_b32 v123, 0
    v_mov_b32 v124, 0
    v_mov_b32 v125, 0
    v_mov_b32 v126, 0
    v_mov_b32 v127, 0
    s_waitcnt vmcnt(16)
    s_cmp_lt_i32 s38, 0
    s_cbranch_scc1 L_attn_go
    s_lshl_b32 s30, s38, 7
    s_lshl_b32 s31, s24, 5
    s_add_u32 s30, s30, s31
    v_add_u32 v208, s30, v254
    v_lshlrev_b32 v208, 13, v208
    v_lshl_add_u32 v208, v253, 4, v208
    s_lshl_b32 s31, s25, 9
    buffer_load_dwordx4 a[96:99], v208, s[4:7], s31 offen offset:0
    buffer_load_dwordx4 a[100:103], v208, s[4:7], s31 offen offset:32
    buffer_load_dwordx4 a[104:107], v208, s[4:7], s31 offen offset:64
    buffer_load_dwordx4 a[108:111], v208, s[4:7], s31 offen offset:96
    buffer_load_dwordx4 a[112:115], v208, s[4:7], s31 offen offset:128
    buffer_load_dwordx4 a[116:119], v208, s[4:7], s31 offen offset:160
    buffer_load_dwordx4 a[120:123], v208, s[4:7], s31 offen offset:192
    buffer_load_dwordx4 a[124:127], v208, s[4:7], s31 offen offset:224
    buffer_load_dwordx4 a[128:131], v208, s[4:7], s31 offen offset:256
    buffer_load_dwordx4 a[132:135], v208, s[4:7], s31 offen offset:288
    buffer_load_dwordx4 a[136:139], v208, s[4:7], s31 offen offset:320
    buffer_load_dwordx4 a[140:143], v208, s[4:7], s31 offen offset:352
    buffer_load_dwordx4 a[144:147], v208, s[4:7], s31 offen offset:384
    buffer_load_dwordx4 a[148:151], v208, s[4:7], s31 offen offset:416
    buffer_load_dwordx4 a[152:155], v208, s[4:7], s31 offen offset:448
    buffer_load_dwordx4 a[156:159], v208, s[4:7], s31 offen offset:480
L_attn_go:
    s_barrier
    ds_read_b128 a[64:67], v224 offset:0
    ds_read_b128 a[68:71], v224 offset:16384
    ds_read_b128 a[72:75], v225 offset:0
    ds_read_b128 a[76:79], v225 offset:16384
    ds_read_b128 a[80:83], v226 offset:0
    ds_read_b128 a[84:87], v226 offset:16384
    s_waitcnt lgkmcnt(5)
    v_mfma_f32_32x32x16_bf16 v[128:143], a[64:67], a[0:3], 0
    ds_read_b128 a[88:91], v227 offset:0
    s_waitcnt lgkmcnt(5)
    v_mfma_f32_32x32x16_bf16 v[144:159], a[68:71], a[0:3], 0
    ds_read_b128 a[92:95], v227 offset:16384
    s_waitcnt lgkmcnt(5)
    v_mfma_f32_32x32x16_bf16 v[128:143], a[72:75], a[4:7], v[128:143]
    ds_read_b128 a[64:67], v228 offset:0
    s_waitcnt lgkmcnt(5)
    v_mfma_f32_32x32x16_bf16 v[144:159], a[76:79], a[4:7], v[144:159]
    ds_read_b128 a[68:71], v228 offset:16384
    s_waitcnt lgkmcnt(5)
    v_mfma_f32_32x32x16_bf16 v[128:143], a[80:83], a[8:11], v[128:143]
    ds_read_b128 a[72:75], v229 offset:0
    s_waitcnt lgkmcnt(5)
    v_mfma_f32_32x32x16_bf16 v[144:159], a[84:87], a[8:11], v[144:159]
    ds_read_b128 a[76:79], v229 offset:16384
    s_waitcnt lgkmcnt(5)
    v_mfma_f32_32x32x16_bf16 v[128:143], a[88:91], a[12:15], v[128:143]
    ds_read_b128 a[80:83], v230 offset:0
    s_waitcnt lgkmcnt(5)
    v_mfma_f32_32x32x16_bf16 v[144:159], a[92:95], a[12:15], v[144:159]
    ds_read_b128 a[84:87], v230 offset:16384
    s_waitcnt lgkmcnt(5)
    v_mfma_f32_32x32x16_bf16 v[128:143], a[64:67], a[16:19], v[128:143]
    ds_read_b128 a[88:91], v231 offset:0
    s_waitcnt lgkmcnt(5)
    v_mfma_f32_32x32x16_bf16 v[144:159], a[68:71], a[16:19], v[144:159]
    ds_read_b128 a[92:95], v231 offset:16384
    s_waitcnt lgkmcnt(5)
    v_mfma_f32_32x32x16_bf16 v[128:143], a[72:75], a[20:23], v[128:143]
    ds_read_b128 a[64:67], v224 offset:256
    s_waitcnt lgkmcnt(5)
    v_mfma_f32_32x32x16_bf16 v[144:159], a[76:79], a[20:23], v[144:159]
    ds_read_b128 a[68:71], v224 offset:16640
    s_waitcnt lgkmcnt(5)
    v_mfma_f32_32x32x16_bf16 v[128:143], a[80:83], a[24:27], v[128:143]
    ds_read_b128 a[72:75], v225 offset:256
    s_waitcnt lgkmcnt(5)
    v_mfma_f32_32x32x16_bf16 v[144:159], a[84:87], a[24:27], v[144:159]
    ds_read_b128 a[76:79], v225 offset:16640
    s_waitcnt lgkmcnt(5)
    v_mfma_f32_32x32x16_bf16 v[128:143], a[88:91], a[28:31], v[128:143]
    ds_read_b128 a[80:83], v226 offset:256
    s_waitcnt lgkmcnt(5)
    v_mfma_f32_32x32x16_bf16 v[144:159], a[92:95], a[28:31], v[144:159]
    ds_read_b128 a[84:87], v226 offset:16640
    s_waitcnt lgkmcnt(5)
    v_mfma_f32_32x32x16_bf16 v[128:143], a[64:67], a[32:35], v[128:143]
    ds_read_b128 a[88:91], v227 offset:256
    s_waitcnt lgkmcnt(5)
    v_mfma_f32_32x32x16_bf16 v[144:159], a[68:71], a[32:35], v[144:159]
    ds_read_b128 a[92:95], v227 offset:16640
    s_waitcnt lgkmcnt(5)
    v_mfma_f32_32x32x16_bf16 v[128:143], a[72:75], a[36:39], v[128:143]
    ds_read_b128 a[64:67], v228 offset:256
    s_waitcnt lgkmcnt(5)
    v_mfma_f32_32x32x16_bf16 v[144:159], a[76:79], a[36:39], v[144:159]
    ds_read_b128 a[68:71], v228 offset:16640
    s_waitcnt lgkmcnt(5)
    v_mfma_f32_32x32x16_bf16 v[128:143], a[80:83], a[40:43], v[128:143]
    ds_read_b128 a[72:75], v229 offset:256
    s_waitcnt lgkmcnt(5)
    v_mfma_f32_32x32x16_bf16 v[144:159], a[84:87], a[40:43], v[144:159]
    ds_read_b128 a[76:79], v229 offset:16640
    s_waitcnt lgkmcnt(5)
    v_mfma_f32_32x32x16_bf16 v[128:143], a[88:91], a[44:47], v[128:143]
    ds_read_b128 a[80:83], v230 offset:256
    s_waitcnt lgkmcnt(5)
    v_mfma_f32_32x32x16_bf16 v[144:159], a[92:95], a[44:47], v[144:159]
    ds_read_b128 a[84:87], v230 offset:16640
    s_waitcnt lgkmcnt(5)
    v_mfma_f32_32x32x16_bf16 v[128:143], a[64:67], a[48:51], v[128:143]
    ds_read_b128 a[88:91], v231 offset:256
    s_waitcnt lgkmcnt(5)
    v_mfma_f32_32x32x16_bf16 v[144:159], a[68:71], a[48:51], v[144:159]
    ds_read_b128 a[92:95], v231 offset:16640
    s_waitcnt lgkmcnt(5)
    v_mfma_f32_32x32x16_bf16 v[128:143], a[72:75], a[52:55], v[128:143]
    s_waitcnt lgkmcnt(4)
    v_mfma_f32_32x32x16_bf16 v[144:159], a[76:79], a[52:55], v[144:159]
    s_waitcnt lgkmcnt(3)
    v_mfma_f32_32x32x16_bf16 v[128:143], a[80:83], a[56:59], v[128:143]
    s_waitcnt lgkmcnt(2)
    v_mfma_f32_32x32x16_bf16 v[144:159], a[84:87], a[56:59], v[144:159]
    s_waitcnt lgkmcnt(1)
    v_mfma_f32_32x32x16_bf16 v[128:143], a[88:91], a[60:63], v[128:143]
    s_waitcnt lgkmcnt(0)
    v_mfma_f32_32x32x16_bf16 v[144:159], a[92:95], a[60:63], v[144:159]
    s_nop 15
    s_mov_b32 s27, s36
    s_cmp_eq_u32 s27, 0
    s_cbranch_scc1 L_attn_tail
L_attn_loop:
    s_waitcnt vmcnt(0)
    s_barrier
    ds_read_b128 a[64:67], v224 offset:32768
    ds_read_b128 a[68:71], v224 offset:49152
    ds_read_b128 a[72:75], v225 offset:32768
    ds_read_b128 a[76:79], v225 offset:49152
    ds_read_b128 a[80:83], v226 offset:32768
    ds_read_b128 a[84:87], v226 offset:49152
    s_waitcnt lgkmcnt(5)
    v_mfma_f32_32x32x16_bf16 v[160:175], a[64:67], a[0:3], 0
    s_add_u32 m0, s32, 0
    ds_read_b128 a[88:91], v227 offset:32768
    buffer_load_dwordx4 v236, s[8:11], s28 offen lds
    v_max3_f32 v208, v128, v129, v130
    s_waitcnt lgkmcnt(5)
    v_mfma_f32_32x32x16_bf16 v[176:191], a[68:71], a[0:3], 0
    ds_read_b128 a[92:95], v227 offset:49152
    v_max3_f32 v209, v136, v137, v138
    v_max3_f32 v210, v144, v145, v146
    s_waitcnt lgkmcnt(5)
    v_mfma_f32_32x32x16_bf16 v[160:175], a[72:75], a[4:7], v[160:175]
    s_add_u32 m0, s32, 1024
    ds_read_b128 a[64:67], v228 offset:32768
    buffer_load_dwordx4 v237, s[8:11], s28 offen lds
    v_max3_f32 v211, v152, v153, v154
    s_waitcnt lgkmcnt(5)
    v_mfma_f32_32x32x16_bf16 v[176:191], a[76:79], a[4:7], v[176:191]
    ds_read_b128 a[68:71], v228 offset:49152
    s_add_u32 m0, s32, 2048
    v_max3_f32 v208, v208, v131, v132
    buffer_load_dwordx4 v238, s[8:11], s28 offen lds
    s_waitcnt lgkmcnt(5)
    v_mfma_f32_32x32x16_bf16 v[160:175], a[80:83], a[8:11], v[160:175]
    ds_read_b128 a[72:75], v229 offset:32768
    v_max3_f32 v209, v209, v139, v140
    v_max3_f32 v210, v210, v147, v148
    s_waitcnt lgkmcnt(5)
    v_mfma_f32_32x32x16_bf16 v[176:191], a[84:87], a[8:11], v[176:191]
    s_add_u32 m0, s32, 3072
    ds_read_b128 a[76:79], v229 offset:49152
    buffer_load_dwordx4 v239, s[8:11], s28 offen lds
    v_max3_f32 v211, v211, v155, v156
    s_waitcnt lgkmcnt(5)
    v_mfma_f32_32x32x16_bf16 v[160:175], a[88:91], a[12:15], v[160:175]
    ds_read_b128 a[80:83], v230 offset:32768
    s_add_u32 m0, s32, 4096
    v_max3_f32 v208, v208, v133, v134
    buffer_load_dwordx4 v240, s[8:11], s28 offen lds
    s_waitcnt lgkmcnt(5)
    v_mfma_f32_32x32x16_bf16 v[176:191], a[92:95], a[12:15], v[176:191]
    ds_read_b128 a[84:87], v230 offset:49152
    v_max3_f32 v209, v209, v141, v142
    v_max3_f32 v210, v210, v149, v150
    v_max3_f32 v211, v211, v157, v158
    s_waitcnt lgkmcnt(5)
    v_mfma_f32_32x32x16_bf16 v[160:175], a[64:67], a[16:19], v[160:175]
    s_add_u32 m0, s32, 5120
    ds_read_b128 a[88:91], v231 offset:32768
    buffer_load_dwordx4 v241, s[8:11], s28 offen lds
    v_max3_f32 v208, v208, v135, v143
    s_waitcnt lgkmcnt(5)
    v_mfma_f32_32x32x16_bf16 v[176:191], a[68:71], a[16:19], v[176:191]
    ds_read_b128 a[92:95], v231 offset:49152
    s_add_u32 m0, s32, 6144
    v_max3_f32 v210, v210, v151, v159
    buffer_load_dwordx4 v242, s[8:11], s28 offen lds
    s_waitcnt lgkmcnt(5)
    v_mfma_f32_32x32x16_bf16 v[160:175], a[72:75], a[20:23], v[160:175]
    ds_read_b128 a[64:67], v224 offset:33024
    v_max3_f32 v208, v208, v209, v211
    v_max_f32 v208, v208, v210
    s_waitcnt lgkmcnt(5)
    v_mfma_f32_32x32x16_bf16 v[176:191], a[76:79], a[20:23], v[176:191]
    s_add_u32 m0, s32, 7168
    ds_read_b128 a[68:71], v224 offset:49408
    buffer_load_dwordx4 v243, s[8:11], s28 offen lds
    s_waitcnt lgkmcnt(5)
    v_mfma_f32_32x32x16_bf16 v[160:175], a[80:83], a[24:27], v[160:175]
    ds_read_b128 a[72:75], v225 offset:33024
    v_mov_b32 v209, v208
    s_nop 1
    v_permlane32_swap_b32 v208, v209
    v_max_f32 v208, v208, v209
    v_sub_f32 v209, v208, v220
    v_cmp_lt_f32 vcc, s49, v209
    s_nop 4
    s_cbranch_vccnz L_attn_rs1
L_attn_rs1_ret:
    s_waitcnt lgkmcnt(5)
    v_mfma_f32_32x32x16_bf16 v[176:191], a[84:87], a[24:27], v[176:191]
    ds_read_b128 a[76:79], v225 offset:49408
    v_fma_f32 v128, v128, s34, -v255
    s_add_u32 s28, s28, 0x80000
    v_fma_f32 v129, v129, s34, -v255
    v_fma_f32 v130, v130, s34, -v255
    s_waitcnt lgkmcnt(5)
    v_mfma_f32_32x32x16_bf16 v[160:175], a[88:91], a[28:31], v[160:175]
    s_add_u32 m0, s32, 98304
    ds_read_b128 a[80:83], v226 offset:33024
    buffer_load_dwordx4 v244, s[12:15], s29 offen lds
    v_fma_f32 v131, v131, s34, -v255
    s_waitcnt lgkmcnt(5)
    v_mfma_f32_32x32x16_bf16 v[176:191], a[92:95], a[28:31], v[176:191]
    ds_read_b128 a[84:87], v226 offset:49408
    v_fma_f32 v132, v132, s34, -v255
    v_fma_f32 v133, v133, s34, -v255
    s_waitcnt lgkmcnt(5)
    v_mfma_f32_32x32x16_bf16 v[160:175], a[64:67], a[32:35], v[160:175]
    s_add_u32 m0, s32, 99328
    ds_read_b128 a[88:91], v227 offset:33024
    buffer_load_dwordx4 v245, s[12:15], s29 offen lds
    v_fma_f32 v134, v134, s34, -v255
    s_waitcnt lgkmcnt(5)
    v_mfma_f32_32x32x16_bf16 v[176:191], a[68:71], a[32:35], v[176:191]
    ds_read_b128 a[92:95], v227 offset:49408
    s_add_u32 m0, s32, 100352
    v_fma_f32 v135, v135, s34, -v255
    buffer_load_dwordx4 v246, s[12:15], s29 offen lds
    s_waitcnt lgkmcnt(5)
    v_mfma_f32_32x32x16_bf16 v[160:175], a[72:75], a[36:39], v[160:175]
    ds_read_b128 a[64:67], v228 offset:33024
    v_exp_f32 v128, v128
    v_exp_f32 v129, v129
    s_waitcnt lgkmcnt(5)
    v_mfma_f32_32x32x16_bf16 v[176:191], a[76:79], a[36:39], v[176:191]
    s_add_u32 m0, s32, 101376
    ds_read_b128 a[68:71], v228 offset:49408
    buffer_load_dwordx4 v247, s[12:15], s29 offen lds
    s_waitcnt lgkmcnt(5)
    v_mfma_f32_32x32x16_bf16 v[160:175], a[80:83], a[40:43], v[160:175]
    ds_read_b128 a[72:75], v229 offset:33024
    v_exp_f32 v130, v130
    v_exp_f32 v131, v131
    s_waitcnt lgkmcnt(5)
    v_mfma_f32_32x32x16_bf16 v[176:191], a[84:87], a[40:43], v[176:191]
    s_add_u32 m0, s32, 102400
    ds_read_b128 a[76:79], v229 offset:49408
    buffer_load_dwordx4 v248, s[12:15], s29 offen lds
    s_waitcnt lgkmcnt(5)
    v_mfma_f32_32x32x16_bf16 v[160:175], a[88:91], a[44:47], v[160:175]
    ds_read_b128 a[80:83], v230 offset:33024
    v_exp_f32 v132, v132
    v_exp_f32 v133, v133
    s_waitcnt lgkmcnt(5)
    v_mfma_f32_32x32x16_bf16 v[176:191], a[92:95], a[44:47], v[176:191]
    ds_read_b128 a[84:87], v230 offset:49408
    v_exp_f32 v134, v134
    s_waitcnt lgkmcnt(5)
    v_mfma_f32_32x32x16_bf16 v[160:175], a[64:67], a[48:51], v[160:175]
    s_add_u32 m0, s32, 103424
    ds_read_b128 a[88:91], v231 offset:33024
    buffer_load_dwordx4 v249, s[12:15], s29 offen lds
    s_waitcnt lgkmcnt(5)
    v_mfma_f32_32x32x16_bf16 v[176:191], a[68:71], a[48:51], v[176:191]
    ds_read_b128 a[92:95], v231 offset:49408
    v_exp_f32 v135, v135
    v_add_f32 v212, v128, v129
    s_waitcnt lgkmcnt(5)
    v_mfma_f32_32x32x16_bf16 v[160:175], a[72:75], a[52:55], v[160:175]
    s_add_u32 m0, s32, 104448
    ds_read_b128 a[64:67], v232 offset:0
    buffer_load_dwordx4 v250, s[12:15], s29 offen lds
    v_add_f32 v213, v130, v131
    s_waitcnt lgkmcnt(5)
    v_mfma_f32_32x32x16_bf16 v[176:191], a[76:79], a[52:55], v[176:191]
    ds_read_b128 a[68:71], v232 offset:4096
    s_add_u32 m0, s32, 105472
    v_cvt_pk_bf16_f32 v192, v128, v129
    buffer_load_dwordx4 v251, s[12:15], s29 offen lds
    s_waitcnt lgkmcnt(5)
    v_mfma_f32_32x32x16_bf16 v[160:175], a[80:83], a[56:59], v[160:175]
    ds_read_b128 a[72:75], v232 offset:8192
    v_cvt_pk_bf16_f32 v193, v130, v131
    v_add_f32 v212, v212, v132
    s_add_u32 s29, s29, 128
    v_add_f32 v213, v213, v133
    v_cvt_pk_bf16_f32 v194, v132, v133
    s_waitcnt lgkmcnt(5)
    v_mfma_f32_32x32x16_bf16 v[176:191], a[84:87], a[56:59], v[176:191]
    ds_read_b128 a[76:79], v232 offset:12288
    v_add_f32 v212, v212, v134
    v_add_f32 v213, v213, v135
    v_cvt_pk_bf16_f32 v195, v134, v135
    v_add_f32 v221, v221, v212
    v_add_f32 v221, v221, v213
    s_waitcnt lgkmcnt(5)
    v_mfma_f32_32x32x16_bf16 v[160:175], a[88:91], a[60:63], v[160:175]
    ds_read_b128 a[80:83], v232 offset:16384
    v_fma_f32 v136, v136, s34, -v255
    v_fma_f32 v137, v137, s34, -v255
    v_fma_f32 v138, v138, s34, -v255
    v_fma_f32 v139, v139, s34, -v255
    v_fma_f32 v140, v140, s34, -v255
    s_waitcnt lgkmcnt(5)
    v_mfma_f32_32x32x16_bf16 v[176:191], a[92:95], a[60:63], v[176:191]
    ds_read_b128 a[84:87], v232 offset:20480
    v_fma_f32 v141, v141, s34, -v255
    v_fma_f32 v142, v142, s34, -v255
    v_fma_f32 v143, v143, s34, -v255
    v_exp_f32 v136, v136
    s_waitcnt lgkmcnt(5)
    v_mfma_f32_32x32x16_bf16 v[0:15], a[64:67], v[192:195], v[0:15]
    ds_read_b128 a[88:91], v232 offset:24576
    v_exp_f32 v137, v137
    v_exp_f32 v138, v138
    s_waitcnt lgkmcnt(5)
    v_mfma_f32_32x32x16_bf16 v[16:31], a[68:71], v[192:195], v[16:31]
    ds_read_b128 a[92:95], v232 offset:28672
    v_exp_f32 v139, v139
    v_exp_f32 v140, v140
    s_waitcnt lgkmcnt(5)
    v_mfma_f32_32x32x16_bf16 v[32:47], a[72:75], v[192:195], v[32:47]
    ds_read_b128 a[64:67], v233 offset:0
    v_exp_f32 v141, v141
    v_exp_f32 v142, v142
    s_waitcnt lgkmcnt(5)
    v_mfma_f32_32x32x16_bf16 v[48:63], a[76:79], v[192:195], v[48:63]
    ds_read_b128 a[68:71], v233 offset:4096
    v_exp_f32 v143, v143
    v_add_f32 v212, v136, v137
    v_add_f32 v213, v138, v139
    v_cvt_pk_bf16_f32 v196, v136, v137
    s_waitcnt lgkmcnt(5)
    v_mfma_f32_32x32x16_bf16 v[64:79], a[80:83], v[192:195], v[64:79]
    ds_read_b128 a[72:75], v233 offset:8192
    v_cvt_pk_bf16_f32 v197, v138, v139
    v_add_f32 v212, v212, v140
    v_add_f32 v213, v213, v141
    v_cvt_pk_bf16_f32 v198, v140, v141
    v_add_f32 v212, v212, v142
    s_waitcnt lgkmcnt(5)
    v_mfma_f32_32x32x16_bf16 v[80:95], a[84:87], v[192:195], v[80:95]
    ds_read_b128 a[76:79], v233 offset:12288
    v_add_f32 v213, v213, v143
    v_cvt_pk_bf16_f32 v199, v142, v143
    v_add_f32 v221, v221, v212
    v_add_f32 v221, v221, v213
    v_fma_f32 v144, v144, s34, -v255
    s_waitcnt lgkmcnt(5)
    v_mfma_f32_32x32x16_bf16 v[96:111], a[88:91], v[192:195], v[96:111]
    ds_read_b128 a[80:83], v233 offset:16384
    v_fma_f32 v145, v145, s34, -v255
    v_fma_f32 v146, v146, s34, -v255
    v_fma_f32 v147, v147, s34, -v255
    v_fma_f32 v148, v148, s34, -v255
    v_fma_f32 v149, v149, s34, -v255
    s_waitcnt lgkmcnt(5)
    v_mfma_f32_32x32x16_bf16 v[112:127], a[92:95], v[192:195], v[112:127]
    ds_read_b128 a[84:87], v233 offset:20480
    v_fma_f32 v150, v150, s34, -v255
    v_fma_f32 v151, v151, s34, -v255
    v_exp_f32 v144, v144
    s_waitcnt lgkmcnt(5)
    v_mfma_f32_32x32x16_bf16 v[0:15], a[64:67], v[196:199], v[0:15]
    ds_read_b128 a[88:91], v233 offset:24576
    v_exp_f32 v145, v145
    v_exp_f32 v146, v146
    s_waitcnt lgkmcnt(5)
    v_mfma_f32_32x32x16_bf16 v[16:31], a[68:71], v[196:199], v[16:31]
    ds_read_b128 a[92:95], v233 offset:28672
    v_exp_f32 v147, v147
    v_exp_f32 v148, v148
    s_waitcnt lgkmcnt(5)
    v_mfma_f32_32x32x16_bf16 v[32:47], a[72:75], v[196:199], v[32:47]
    ds_read_b128 a[64:67], v234 offset:0
    v_exp_f32 v149, v149
    v_exp_f32 v150, v150
    s_waitcnt lgkmcnt(5)
    v_mfma_f32_32x32x16_bf16 v[48:63], a[76:79], v[196:199], v[48:63]
    ds_read_b128 a[68:71], v234 offset:4096
    v_exp_f32 v151, v151
    v_add_f32 v212, v144, v145
    v_add_f32 v213, v146, v147
    v_cvt_pk_bf16_f32 v200, v144, v145
    s_waitcnt lgkmcnt(5)
    v_mfma_f32_32x32x16_bf16 v[64:79], a[80:83], v[196:199], v[64:79]
    ds_read_b128 a[72:75], v234 offset:8192
    v_cvt_pk_bf16_f32 v201, v146, v147
    v_add_f32 v212, v212, v148
    v_add_f32 v213, v213, v149
    v_cvt_pk_bf16_f32 v202, v148, v149
    v_add_f32 v212, v212, v150
    s_waitcnt lgkmcnt(5)
    v_mfma_f32_32x32x16_bf16 v[80:95], a[84:87], v[196:199], v[80:95]
    ds_read_b128 a[76:79], v234 offset:12288
    v_add_f32 v213, v213, v151
    v_cvt_pk_bf16_f32 v203, v150, v151
    v_add_f32 v221, v221, v212
    v_add_f32 v221, v221, v213
    v_fma_f32 v152, v152, s34, -v255
    s_waitcnt lgkmcnt(5)
    v_mfma_f32_32x32x16_bf16 v[96:111], a[88:91], v[196:199], v[96:111]
    ds_read_b128 a[80:83], v234 offset:16384
    v_fma_f32 v153, v153, s34, -v255
    v_fma_f32 v154, v154, s34, -v255
    v_fma_f32 v155, v155, s34, -v255
    v_fma_f32 v156, v156, s34, -v255
    v_fma_f32 v157, v157, s34, -v255
    s_waitcnt lgkmcnt(5)
    v_mfma_f32_32x32x16_bf16 v[112:127], a[92:95], v[196:199], v[112:127]
    ds_read_b128 a[84:87], v234 offset:20480
    v_fma_f32 v158, v158, s34, -v255
    v_fma_f32 v159, v159, s34, -v255
    v_exp_f32 v152, v152
    s_waitcnt lgkmcnt(5)
    v_mfma_f32_32x32x16_bf16 v[0:15], a[64:67], v[200:203], v[0:15]
    ds_read_b128 a[88:91], v234 offset:24576
    v_exp_f32 v153, v153
    v_exp_f32 v154, v154
    s_waitcnt lgkmcnt(5)
    v_mfma_f32_32x32x16_bf16 v[16:31], a[68:71], v[200:203], v[16:31]
    ds_read_b128 a[92:95], v234 offset:28672
    v_exp_f32 v155, v155
    v_exp_f32 v156, v156
    s_waitcnt lgkmcnt(5)
    v_mfma_f32_32x32x16_bf16 v[32:47], a[72:75], v[200:203], v[32:47]
    ds_read_b128 a[64:67], v235 offset:0
    v_exp_f32 v157, v157
    v_exp_f32 v158, v158
    s_waitcnt lgkmcnt(5)
    v_mfma_f32_32x32x16_bf16 v[48:63], a[76:79], v[200:203], v[48:63]
    ds_read_b128 a[68:71], v235 offset:4096
    v_exp_f32 v159, v159
    v_add_f32 v212, v152, v153
    v_add_f32 v213, v154, v155
    v_cvt_pk_bf16_f32 v204, v152, v153
    s_waitcnt lgkmcnt(5)
    v_mfma_f32_32x32x16_bf16 v[64:79], a[80:83], v[200:203], v[64:79]
    ds_read_b128 a[72:75], v235 offset:8192
    v_cvt_pk_bf16_f32 v205, v154, v155
    v_add_f32 v212, v212, v156
    v_add_f32 v213, v213, v157
    v_cvt_pk_bf16_f32 v206, v156, v157
    v_add_f32 v212, v212, v158
    s_waitcnt lgkmcnt(5)
    v_mfma_f32_32x32x16_bf16 v[80:95], a[84:87], v[200:203], v[80:95]
    ds_read_b128 a[76:79], v235 offset:12288
    v_add_f32 v213, v213, v159
    v_cvt_pk_bf16_f32 v207, v158, v159
    v_add_f32 v221, v221, v212
    v_add_f32 v221, v221, v213
    s_waitcnt lgkmcnt(5)
    v_mfma_f32_32x32x16_bf16 v[96:111], a[88:91], v[200:203], v[96:111]
    ds_read_b128 a[80:83], v235 offset:16384
    s_waitcnt lgkmcnt(5)
    v_mfma_f32_32x32x16_bf16 v[112:127], a[92:95], v[200:203], v[112:127]
    ds_read_b128 a[84:87], v235 offset:20480
    s_waitcnt lgkmcnt(5)
    v_mfma_f32_32x32x16_bf16 v[0:15], a[64:67], v[204:207], v[0:15]
    ds_read_b128 a[88:91], v235 offset:24576
    s_waitcnt lgkmcnt(5)
    v_mfma_f32_32x32x16_bf16 v[16:31], a[68:71], v[204:207], v[16:31]
    ds_read_b128 a[92:95], v235 offset:28672
    s_waitcnt lgkmcnt(5)
    v_mfma_f32_32x32x16_bf16 v[32:47], a[72:75], v[204:207], v[32:47]
    s_waitcnt lgkmcnt(4)
    v_mfma_f32_32x32x16_bf16 v[48:63], a[76:79], v[204:207], v[48:63]
    s_waitcnt lgkmcnt(3)
    v_mfma_f32_32x32x16_bf16 v[64:79], a[80:83], v[204:207], v[64:79]
    s_waitcnt lgkmcnt(2)
    v_mfma_f32_32x32x16_bf16 v[80:95], a[84:87], v[204:207], v[80:95]
    s_waitcnt lgkmcnt(1)
    v_mfma_f32_32x32x16_bf16 v[96:111], a[88:91], v[204:207], v[96:111]
    s_waitcnt lgkmcnt(0)
    v_mfma_f32_32x32x16_bf16 v[112:127], a[92:95], v[204:207], v[112:127]
    s_waitcnt vmcnt(0)
    s_barrier
    ds_read_b128 a[64:67], v224 offset:0
    ds_read_b128 a[68:71], v224 offset:16384
    ds_read_b128 a[72:75], v225 offset:0
    ds_read_b128 a[76:79], v225 offset:16384
    ds_read_b128 a[80:83], v226 offset:0
    ds_read_b128 a[84:87], v226 offset:16384
    s_waitcnt lgkmcnt(5)
    v_mfma_f32_32x32x16_bf16 v[128:143], a[64:67], a[0:3], 0
    s_add_u32 m0, s32, 32768
    ds_read_b128 a[88:91], v227 offset:0
    buffer_load_dwordx4 v236, s[8:11], s28 offen lds
    v_max3_f32 v208, v160, v161, v162
    s_waitcnt lgkmcnt(5)
    v_mfma_f32_32x32x16_bf16 v[144:159], a[68:71], a[0:3], 0
    ds_read_b128 a[92:95], v227 offset:16384
    v_max3_f32 v209, v168, v169, v170
    v_max3_f32 v210, v176, v177, v178
    s_waitcnt lgkmcnt(5)
    v_mfma_f32_32x32x16_bf16 v[128:143], a[72:75], a[4:7], v[128:143]
    s_add_u32 m0, s32, 33792
    ds_read_b128 a[64:67], v228 offset:0
    buffer_load_dwordx4 v237, s[8:11], s28 offen lds
    v_max3_f32 v211, v184, v185, v186
    s_waitcnt lgkmcnt(5)
    v_mfma_f32_32x32x16_bf16 v[144:159], a[76:79], a[4:7], v[144:159]
    ds_read_b128 a[68:71], v228 offset:16384
    s_add_u32 m0, s32, 34816
    v_max3_f32 v208, v208, v163, v164
    buffer_load_dwordx4 v238, s[8:11], s28 offen lds
    s_waitcnt lgkmcnt(5)
    v_mfma_f32_32x32x16_bf16 v[128:143], a[80:83], a[8:11], v[128:143]
    ds_read_b128 a[72:75], v229 offset:0
    v_max3_f32 v209, v209, v171, v172
    v_max3_f32 v210, v210, v179, v180
    s_waitcnt lgkmcnt(5)
    v_mfma_f32_32x32x16_bf16 v[144:159], a[84:87], a[8:11], v[144:159]
    s_add_u32 m0, s32, 35840
    ds_read_b128 a[76:79], v229 offset:16384
    buffer_load_dwordx4 v239, s[8:11], s28 offen lds
    v_max3_f32 v211, v211, v187, v188
    s_waitcnt lgkmcnt(5)
    v_mfma_f32_32x32x16_bf16 v[128:143], a[88:91], a[12:15], v[128:143]
    ds_read_b128 a[80:83], v230 offset:0
    s_add_u32 m0, s32, 36864
    v_max3_f32 v208, v208, v165, v166
    buffer_load_dwordx4 v240, s[8:11], s28 offen lds
    s_waitcnt lgkmcnt(5)
    v_mfma_f32_32x32x16_bf16 v[144:159], a[92:95], a[12:15], v[144:159]
    ds_read_b128 a[84:87], v230 offset:16384
    v_max3_f32 v209, v209, v173, v174
    v_max3_f32 v210, v210, v181, v182
    v_max3_f32 v211, v211, v189, v190
    s_waitcnt lgkmcnt(5)
    v_mfma_f32_32x32x16_bf16 v[128:143], a[64:67], a[16:19], v[128:143]
    s_add_u32 m0, s32, 37888
    ds_read_b128 a[88:91], v231 offset:0
    buffer_load_dwordx4 v241, s[8:11], s28 offen lds
    v_max3_f32 v208, v208, v167, v175
    s_waitcnt lgkmcnt(5)
    v_mfma_f32_32x32x16_bf16 v[144:159], a[68:71], a[16:19], v[144:159]
    ds_read_b128 a[92:95], v231 offset:16384
    s_add_u32 m0, s32, 38912
    v_max3_f32 v210, v210, v183, v191
    buffer_load_dwordx4 v242, s[8:11], s28 offen lds
    s_waitcnt lgkmcnt(5)
    v_mfma_f32_32x32x16_bf16 v[128:143], a[72:75], a[20:23], v[128:143]
    ds_read_b128 a[64:67], v224 offset:256
    v_max3_f32 v208, v208, v209, v211
    v_max_f32 v208, v208, v210
    s_waitcnt lgkmcnt(5)
    v_mfma_f32_32x32x16_bf16 v[144:159], a[76:79], a[20:23], v[144:159]
    s_add_u32 m0, s32, 39936
    ds_read_b128 a[68:71], v224 offset:16640
    buffer_load_dwordx4 v243, s[8:11], s28 offen lds
    s_waitcnt lgkmcnt(5)
    v_mfma_f32_32x32x16_bf16 v[128:143], a[80:83], a[24:27], v[128:143]
    ds_read_b128 a[72:75], v225 offset:256
    v_mov_b32 v209, v208
    s_nop 1
    v_permlane32_swap_b32 v208, v209
    v_max_f32 v208, v208, v209
    v_sub_f32 v209, v208, v220
    v_cmp_lt_f32 vcc, s49, v209
    s_nop 4
    s_cbranch_vccnz L_attn_rs2
L_attn_rs2_ret:
    s_waitcnt lgkmcnt(5)
    v_mfma_f32_32x32x16_bf16 v[144:159], a[84:87], a[24:27], v[144:159]
    ds_read_b128 a[76:79], v225 offset:16640
    v_fma_f32 v160, v160, s34, -v255
    s_add_u32 s28, s28, 0x80000
    v_fma_f32 v161, v161, s34, -v255
    v_fma_f32 v162, v162, s34, -v255
    s_waitcnt lgkmcnt(5)
    v_mfma_f32_32x32x16_bf16 v[128:143], a[88:91], a[28:31], v[128:143]
    s_add_u32 m0, s32, 65536
    ds_read_b128 a[80:83], v226 offset:256
    buffer_load_dwordx4 v244, s[12:15], s29 offen lds
    v_fma_f32 v163, v163, s34, -v255
    s_waitcnt lgkmcnt(5)
    v_mfma_f32_32x32x16_bf16 v[144:159], a[92:95], a[28:31], v[144:159]
    ds_read_b128 a[84:87], v226 offset:16640
    v_fma_f32 v164, v164, s34, -v255
    v_fma_f32 v165, v165, s34, -v255
    s_waitcnt lgkmcnt(5)
    v_mfma_f32_32x32x16_bf16 v[128:143], a[64:67], a[32:35], v[128:143]
    s_add_u32 m0, s32, 66560
    ds_read_b128 a[88:91], v227 offset:256
    buffer_load_dwordx4 v245, s[12:15], s29 offen lds
    v_fma_f32 v166, v166, s34, -v255
    s_waitcnt lgkmcnt(5)
    v_mfma_f32_32x32x16_bf16 v[144:159], a[68:71], a[32:35], v[144:159]
    ds_read_b128 a[92:95], v227 offset:16640
    s_add_u32 m0, s32, 67584
    v_fma_f32 v167, v167, s34, -v255
    buffer_load_dwordx4 v246, s[12:15], s29 offen lds
    s_waitcnt lgkmcnt(5)
    v_mfma_f32_32x32x16_bf16 v[128:143], a[72:75], a[36:39], v[128:143]
    ds_read_b128 a[64:67], v228 offset:256
    v_exp_f32 v160, v160
    v_exp_f32 v161, v161
    s_waitcnt lgkmcnt(5)
    v_mfma_f32_32x32x16_bf16 v[144:159], a[76:79], a[36:39], v[144:159]
    s_add_u32 m0, s32, 68608
    ds_read_b128 a[68:71], v228 offset:16640
    buffer_load_dwordx4 v247, s[12:15], s29 offen lds
    s_waitcnt lgkmcnt(5)
    v_mfma_f32_32x32x16_bf16 v[128:143], a[80:83], a[40:43], v[128:143]
    ds_read_b128 a[72:75], v229 offset:256
    v_exp_f32 v162, v162
    v_exp_f32 v163, v163
    s_waitcnt lgkmcnt(5)
    v_mfma_f32_32x32x16_bf16 v[144:159], a[84:87], a[40:43], v[144:159]
    s_add_u32 m0, s32, 69632
    ds_read_b128 a[76:79], v229 offset:16640
    buffer_load_dwordx4 v248, s[12:15], s29 offen lds
    s_waitcnt lgkmcnt(5)
    v_mfma_f32_32x32x16_bf16 v[128:143], a[88:91], a[44:47], v[128:143]
    ds_read_b128 a[80:83], v230 offset:256
    v_exp_f32 v164, v164
    v_exp_f32 v165, v165
    s_waitcnt lgkmcnt(5)
    v_mfma_f32_32x32x16_bf16 v[144:159], a[92:95], a[44:47], v[144:159]
    ds_read_b128 a[84:87], v230 offset:16640
    v_exp_f32 v166, v166
    s_waitcnt lgkmcnt(5)
    v_mfma_f32_32x32x16_bf16 v[128:143], a[64:67], a[48:51], v[128:143]
    s_add_u32 m0, s32, 70656
    ds_read_b128 a[88:91], v231 offset:256
    buffer_load_dwordx4 v249, s[12:15], s29 offen lds
    s_waitcnt lgkmcnt(5)
    v_mfma_f32_32x32x16_bf16 v[144:159], a[68:71], a[48:51], v[144:159]
    ds_read_b128 a[92:95], v231 offset:16640
    v_exp_f32 v167, v167
    v_add_f32 v212, v160, v161
    s_waitcnt lgkmcnt(5)
    v_mfma_f32_32x32x16_bf16 v[128:143], a[72:75], a[52:55], v[128:143]
    s_add_u32 m0, s32, 71680
    ds_read_b128 a[64:67], v232 offset:32768
    buffer_load_dwordx4 v250, s[12:15], s29 offen lds
    v_add_f32 v213, v162, v163
    s_waitcnt lgkmcnt(5)
    v_mfma_f32_32x32x16_bf16 v[144:159], a[76:79], a[52:55], v[144:159]
    ds_read_b128 a[68:71], v232 offset:36864
    s_add_u32 m0, s32, 72704
    v_cvt_pk_bf16_f32 v192, v160, v161
    buffer_load_dwordx4 v251, s[12:15], s29 offen lds
    s_waitcnt lgkmcnt(5)
    v_mfma_f32_32x32x16_bf16 v[128:143], a[80:83], a[56:59], v[128:143]
    ds_read_b128 a[72:75], v232 offset:40960
    v_cvt_pk_bf16_f32 v193, v162, v163
    v_add_f32 v212, v212, v164
    s_add_u32 s29, s29, 128
    v_add_f32 v213, v213, v165
    v_cvt_pk_bf16_f32 v194, v164, v165
    s_waitcnt lgkmcnt(5)
    v_mfma_f32_32x32x16_bf16 v[144:159], a[84:87], a[56:59], v[144:159]
    ds_read_b128 a[76:79], v232 offset:45056
    v_add_f32 v212, v212, v166
    v_add_f32 v213, v213, v167
    v_cvt_pk_bf16_f32 v195, v166, v167
    v_add_f32 v221, v221, v212
    v_add_f32 v221, v221, v213
    s_waitcnt lgkmcnt(5)
    v_mfma_f32_32x32x16_bf16 v[128:143], a[88:91], a[60:63], v[128:143]
    ds_read_b128 a[80:83], v232 offset:49152
    v_fma_f32 v168, v168, s34, -v255
    v_fma_f32 v169, v169, s34, -v255
    v_fma_f32 v170, v170, s34, -v255
    v_fma_f32 v171, v171, s34, -v255
    v_fma_f32 v172, v172, s34, -v255
    s_waitcnt lgkmcnt(5)
    v_mfma_f32_32x32x16_bf16 v[144:159], a[92:95], a[60:63], v[144:159]
    ds_read_b128 a[84:87], v232 offset:53248
    v_fma_f32 v173, v173, s34, -v255
    v_fma_f32 v174, v174, s34, -v255
    v_fma_f32 v175, v175, s34, -v255
    v_exp_f32 v168, v168
    s_waitcnt lgkmcnt(5)
    v_mfma_f32_32x32x16_bf16 v[0:15], a[64:67], v[192:195], v[0:15]
    ds_read_b128 a[88:91], v232 offset:57344
    v_exp_f32 v169, v169
    v_exp_f32 v170, v170
    s_waitcnt lgkmcnt(5)
    v_mfma_f32_32x32x16_bf16 v[16:31], a[68:71], v[192:195], v[16:31]
    ds_read_b128 a[92:95], v232 offset:61440
    v_exp_f32 v171, v171
    v_exp_f32 v172, v172
    s_waitcnt lgkmcnt(5)
    v_mfma_f32_32x32x16_bf16 v[32:47], a[72:75], v[192:195], v[32:47]
    ds_read_b128 a[64:67], v233 offset:32768
    v_exp_f32 v173, v173
    v_exp_f32 v174, v174
    s_waitcnt lgkmcnt(5)
    v_mfma_f32_32x32x16_bf16 v[48:63], a[76:79], v[192:195], v[48:63]
    ds_read_b128 a[68:71], v233 offset:36864
    v_exp_f32 v175, v175
    v_add_f32 v212, v168, v169
    v_add_f32 v213, v170, v171
    v_cvt_pk_bf16_f32 v196, v168, v169
    s_waitcnt lgkmcnt(5)
    v_mfma_f32_32x32x16_bf16 v[64:79], a[80:83], v[192:195], v[64:79]
    ds_read_b128 a[72:75], v233 offset:40960
    v_cvt_pk_bf16_f32 v197, v170, v171
    v_add_f32 v212, v212, v172
    v_add_f32 v213, v213, v173
    v_cvt_pk_bf16_f32 v198, v172, v173
    v_add_f32 v212, v212, v174
    s_waitcnt lgkmcnt(5)
    v_mfma_f32_32x32x16_bf16 v[80:95], a[84:87], v[192:195], v[80:95]
    ds_read_b128 a[76:79], v233 offset:45056
    v_add_f32 v213, v213, v175
    v_cvt_pk_bf16_f32 v199, v174, v175
    v_add_f32 v221, v221, v212
    v_add_f32 v221, v221, v213
    v_fma_f32 v176, v176, s34, -v255
    s_waitcnt lgkmcnt(5)
    v_mfma_f32_32x32x16_bf16 v[96:111], a[88:91], v[192:195], v[96:111]
    ds_read_b128 a[80:83], v233 offset:49152
    v_fma_f32 v177, v177, s34, -v255
    v_fma_f32 v178, v178, s34, -v255
    v_fma_f32 v179, v179, s34, -v255
    v_fma_f32 v180, v180, s34, -v255
    v_fma_f32 v181, v181, s34, -v255
    s_waitcnt lgkmcnt(5)
    v_mfma_f32_32x32x16_bf16 v[112:127], a[92:95], v[192:195], v[112:127]
    ds_read_b128 a[84:87], v233 offset:53248
    v_fma_f32 v182, v182, s34, -v255
    v_fma_f32 v183, v183, s34, -v255
    v_exp_f32 v176, v176
    s_waitcnt lgkmcnt(5)
    v_mfma_f32_32x32x16_bf16 v[0:15], a[64:67], v[196:199], v[0:15]
    ds_read_b128 a[88:91], v233 offset:57344
    v_exp_f32 v177, v177
    v_exp_f32 v178, v178
    s_waitcnt lgkmcnt(5)
    v_mfma_f32_32x32x16_bf16 v[16:31], a[68:71], v[196:199], v[16:31]
    ds_read_b128 a[92:95], v233 offset:61440
    v_exp_f32 v179, v179
    v_exp_f32 v180, v180
    s_waitcnt lgkmcnt(5)
    v_mfma_f32_32x32x16_bf16 v[32:47], a[72:75], v[196:199], v[32:47]
    ds_read_b128 a[64:67], v234 offset:32768
    v_exp_f32 v181, v181
    v_exp_f32 v182, v182
    s_waitcnt lgkmcnt(5)
    v_mfma_f32_32x32x16_bf16 v[48:63], a[76:79], v[196:199], v[48:63]
    ds_read_b128 a[68:71], v234 offset:36864
    v_exp_f32 v183, v183
    v_add_f32 v212, v176, v177
    v_add_f32 v213, v178, v179
    v_cvt_pk_bf16_f32 v200, v176, v177
    s_waitcnt lgkmcnt(5)
    v_mfma_f32_32x32x16_bf16 v[64:79], a[80:83], v[196:199], v[64:79]
    ds_read_b128 a[72:75], v234 offset:40960
    v_cvt_pk_bf16_f32 v201, v178, v179
    v_add_f32 v212, v212, v180
    v_add_f32 v213, v213, v181
    v_cvt_pk_bf16_f32 v202, v180, v181
    v_add_f32 v212, v212, v182
    s_waitcnt lgkmcnt(5)
    v_mfma_f32_32x32x16_bf16 v[80:95], a[84:87], v[196:199], v[80:95]
    ds_read_b128 a[76:79], v234 offset:45056
    v_add_f32 v213, v213, v183
    v_cvt_pk_bf16_f32 v203, v182, v183
    v_add_f32 v221, v221, v212
    v_add_f32 v221, v221, v213
    v_fma_f32 v184, v184, s34, -v255
    s_waitcnt lgkmcnt(5)
    v_mfma_f32_32x32x16_bf16 v[96:111], a[88:91], v[196:199], v[96:111]
    ds_read_b128 a[80:83], v234 offset:49152
    v_fma_f32 v185, v185, s34, -v255
    v_fma_f32 v186, v186, s34, -v255
    v_fma_f32 v187, v187, s34, -v255
    v_fma_f32 v188, v188, s34, -v255
    v_fma_f32 v189, v189, s34, -v255
    s_waitcnt lgkmcnt(5)
    v_mfma_f32_32x32x16_bf16 v[112:127], a[92:95], v[196:199], v[112:127]
    ds_read_b128 a[84:87], v234 offset:53248
    v_fma_f32 v190, v190, s34, -v255
    v_fma_f32 v191, v191, s34, -v255
    v_exp_f32 v184, v184
    s_waitcnt lgkmcnt(5)
    v_mfma_f32_32x32x16_bf16 v[0:15], a[64:67], v[200:203], v[0:15]
    ds_read_b128 a[88:91], v234 offset:57344
    v_exp_f32 v185, v185
    v_exp_f32 v186, v186
    s_waitcnt lgkmcnt(5)
    v_mfma_f32_32x32x16_bf16 v[16:31], a[68:71], v[200:203], v[16:31]
    ds_read_b128 a[92:95], v234 offset:61440
    v_exp_f32 v187, v187
    v_exp_f32 v188, v188
    s_waitcnt lgkmcnt(5)
    v_mfma_f32_32x32x16_bf16 v[32:47], a[72:75], v[200:203], v[32:47]
    ds_read_b128 a[64:67], v235 offset:32768
    v_exp_f32 v189, v189
    v_exp_f32 v190, v190
    s_waitcnt lgkmcnt(5)
    v_mfma_f32_32x32x16_bf16 v[48:63], a[76:79], v[200:203], v[48:63]
    ds_read_b128 a[68:71], v235 offset:36864
    v_exp_f32 v191, v191
    v_add_f32 v212, v184, v185
    v_add_f32 v213, v186, v187
    v_cvt_pk_bf16_f32 v204, v184, v185
    s_waitcnt lgkmcnt(5)
    v_mfma_f32_32x32x16_bf16 v[64:79], a[80:83], v[200:203], v[64:79]
    ds_read_b128 a[72:75], v235 offset:40960
    v_cvt_pk_bf16_f32 v205, v186, v187
    v_add_f32 v212, v212, v188
    v_add_f32 v213, v213, v189
    v_cvt_pk_bf16_f32 v206, v188, v189
    v_add_f32 v212, v212, v190
    s_waitcnt lgkmcnt(5)
    v_mfma_f32_32x32x16_bf16 v[80:95], a[84:87], v[200:203], v[80:95]
    ds_read_b128 a[76:79], v235 offset:45056
    v_add_f32 v213, v213, v191
    v_cvt_pk_bf16_f32 v207, v190, v191
    v_add_f32 v221, v221, v212
    v_add_f32 v221, v221, v213
    s_waitcnt lgkmcnt(5)
    v_mfma_f32_32x32x16_bf16 v[96:111], a[88:91], v[200:203], v[96:111]
    ds_read_b128 a[80:83], v235 offset:49152
    s_waitcnt lgkmcnt(5)
    v_mfma_f32_32x32x16_bf16 v[112:127], a[92:95], v[200:203], v[112:127]
    ds_read_b128 a[84:87], v235 offset:53248
    s_waitcnt lgkmcnt(5)
    v_mfma_f32_32x32x16_bf16 v[0:15], a[64:67], v[204:207], v[0:15]
    ds_read_b128 a[88:91], v235 offset:57344
    s_waitcnt lgkmcnt(5)
    v_mfma_f32_32x32x16_bf16 v[16:31], a[68:71], v[204:207], v[16:31]
    ds_read_b128 a[92:95], v235 offset:61440
    s_waitcnt lgkmcnt(5)
    v_mfma_f32_32x32x16_bf16 v[32:47], a[72:75], v[204:207], v[32:47]
    s_waitcnt lgkmcnt(4)
    v_mfma_f32_32x32x16_bf16 v[48:63], a[76:79], v[204:207], v[48:63]
    s_waitcnt lgkmcnt(3)
    v_mfma_f32_32x32x16_bf16 v[64:79], a[80:83], v[204:207], v[64:79]
    s_waitcnt lgkmcnt(2)
    v_mfma_f32_32x32x16_bf16 v[80:95], a[84:87], v[204:207], v[80:95]
    s_waitcnt lgkmcnt(1)
    v_mfma_f32_32x32x16_bf16 v[96:111], a[88:91], v[204:207], v[96:111]
    s_waitcnt lgkmcnt(0)
    v_mfma_f32_32x32x16_bf16 v[112:127], a[92:95], v[204:207], v[112:127]
    s_sub_u32 s27, s27, 1
    s_cmp_lg_u32 s27, 0
    s_cbranch_scc1 L_attn_loop
L_attn_tail:
    s_mul_i32 s61, s25, 7
    s_add_u32 s61, s61, 15
    s_sub_u32 s61, s61, s26
    s_mov_b32 s63, s37
    s_cmp_lt_u32 s26, 9
    s_cbranch_scc1 L_attn_t0
    s_cmp_eq_u32 s37, 1
    s_cbranch_scc1 L_attn_t0
    s_mov_b32 s63, 2
    s_lshr_b32 s31, s61, 5
    s_lshl_b32 s31, s31, 2
    v_mov_b32 v219, 0
    buffer_load_dword v218, v219, s[16:19], s31 offen sc1
L_attn_t0:
    s_mov_b32 s28, 0
    s_waitcnt vmcnt(0)
    s_barrier
    ds_read_b128 a[64:67], v224 offset:32768
    ds_read_b128 a[68:71], v224 offset:49152
    ds_read_b128 a[72:75], v225 offset:32768
    ds_read_b128 a[76:79], v225 offset:49152
    ds_read_b128 a[80:83], v226 offset:32768
    ds_read_b128 a[84:87], v226 offset:49152
    s_waitcnt lgkmcnt(5)
    v_mfma_f32_32x32x16_bf16 v[160:175], a[64:67], a[0:3], 0
    s_add_u32 m0, s32, 0
    ds_read_b128 a[88:91], v227 offset:32768
    buffer_load_dwordx4 v236, s[8:11], s28 offen lds
    v_cmp_gt_i32 s[40:41], 0, v222
    v_cmp_gt_i32 s[42:43], 1, v222
    v_cmp_gt_i32 s[44:45], 2, v222
    s_waitcnt lgkmcnt(5)
    v_mfma_f32_32x32x16_bf16 v[176:191], a[68:71], a[0:3], 0
    s_add_u32 m0, s32, 1024
    ds_read_b128 a[92:95], v227 offset:49152
    buffer_load_dwordx4 v237, s[8:11], s28 offen lds
    v_cmp_gt_i32 s[46:47], 3, v222
    v_cndmask_b32 v128, v128, v223, s[40:41]
    s_waitcnt lgkmcnt(5)
    v_mfma_f32_32x32x16_bf16 v[160:175], a[72:75], a[4:7], v[160:175]
    s_add_u32 m0, s32, 2048
    ds_read_b128 a[64:67], v228 offset:32768
    buffer_load_dwordx4 v238, s[8:11], s28 offen lds
    v_cmp_gt_i32 s[40:41], 8, v222
    v_cndmask_b32 v129, v129, v223, s[42:43]
    s_waitcnt lgkmcnt(5)
    v_mfma_f32_32x32x16_bf16 v[176:191], a[76:79], a[4:7], v[176:191]
    s_add_u32 m0, s32, 3072
    ds_read_b128 a[68:71], v228 offset:49152
    buffer_load_dwordx4 v239, s[8:11], s28 offen lds
    v_cmp_gt_i32 s[42:43], 9, v222
    v_cndmask_b32 v130, v130, v223, s[44:45]
    s_waitcnt lgkmcnt(5)
    v_mfma_f32_32x32x16_bf16 v[160:175], a[80:83], a[8:11], v[160:175]
    s_add_u32 m0, s32, 4096
    ds_read_b128 a[72:75], v229 offset:32768
    buffer_load_dwordx4 v240, s[8:11], s28 offen lds
    v_cmp_gt_i32 s[44:45], 10, v222
    v_cndmask_b32 v131, v131, v223, s[46:47]
    v_cmp_gt_i32 s[46:47], 11, v222
    s_waitcnt lgkmcnt(5)
    v_mfma_f32_32x32x16_bf16 v[176:191], a[84:87], a[8:11], v[176:191]
    s_add_u32 m0, s32, 5120
    ds_read_b128 a[76:79], v229 offset:49152
    buffer_load_dwordx4 v241, s[8:11], s28 offen lds
    v_cndmask_b32 v132, v132, v223, s[40:41]
    v_cmp_gt_i32 s[40:41], 16, v222
    s_waitcnt lgkmcnt(5)
    v_mfma_f32_32x32x16_bf16 v[160:175], a[88:91], a[12:15], v[160:175]
    s_add_u32 m0, s32, 6144
    ds_read_b128 a[80:83], v230 offset:32768
    buffer_load_dwordx4 v242, s[8:11], s28 offen lds
    v_cndmask_b32 v133, v133, v223, s[42:43]
    v_cmp_gt_i32 s[42:43], 17, v222
    s_waitcnt lgkmcnt(5)
    v_mfma_f32_32x32x16_bf16 v[176:191], a[92:95], a[12:15], v[176:191]
    s_add_u32 m0, s32, 7168
    ds_read_b128 a[84:87], v230 offset:49152
    buffer_load_dwordx4 v243, s[8:11], s28 offen lds
    v_cndmask_b32 v134, v134, v223, s[44:45]
    v_cmp_gt_i32 s[44:45], 18, v222
    s_add_u32 s28, s28, 0x80000
    s_waitcnt lgkmcnt(5)
    v_mfma_f32_32x32x16_bf16 v[160:175], a[64:67], a[16:19], v[160:175]
    ds_read_b128 a[88:91], v231 offset:32768
    v_cndmask_b32 v135, v135, v223, s[46:47]
    v_cmp_gt_i32 s[46:47], 19, v222
    s_add_u32 m0, s32, 98304
    s_nop 0
    buffer_load_dwordx4 v244, s[12:15], s29 offen lds
    v_cndmask_b32 v136, v136, v223, s[40:41]
    s_waitcnt lgkmcnt(5)
    v_mfma_f32_32x32x16_bf16 v[176:191], a[68:71], a[16:19], v[176:191]
    ds_read_b128 a[92:95], v231 offset:49152
    v_cmp_gt_i32 s[40:41], 24, v222
    s_add_u32 m0, s32, 99328
    v_cndmask_b32 v137, v137, v223, s[42:43]
    buffer_load_dwordx4 v245, s[12:15], s29 offen lds
    v_cmp_gt_i32 s[42:43], 25, v222
    s_waitcnt lgkmcnt(5)
    v_mfma_f32_32x32x16_bf16 v[160:175], a[72:75], a[20:23], v[160:175]
    ds_read_b128 a[64:67], v224 offset:33024
    s_add_u32 m0, s32, 100352
    v_cndmask_b32 v138, v138, v223, s[44:45]
    buffer_load_dwordx4 v246, s[12:15], s29 offen lds
    v_cmp_gt_i32 s[44:45], 26, v222
    v_cndmask_b32 v139, v139, v223, s[46:47]
    s_waitcnt lgkmcnt(5)
    v_mfma_f32_32x32x16_bf16 v[176:191], a[76:79], a[20:23], v[176:191]
    s_add_u32 m0, s32, 101376
    ds_read_b128 a[68:71], v224 offset:49408
    buffer_load_dwordx4 v247, s[12:15], s29 offen lds
    v_cmp_gt_i32 s[46:47], 27, v222
    v_cndmask_b32 v140, v140, v223, s[40:41]
    s_waitcnt lgkmcnt(5)
    v_mfma_f32_32x32x16_bf16 v[160:175], a[80:83], a[24:27], v[160:175]
    s_add_u32 m0, s32, 102400
    ds_read_b128 a[72:75], v225 offset:33024
    buffer_load_dwordx4 v248, s[12:15], s29 offen lds
    v_cmp_gt_i32 s[40:41], 32, v222
    v_cndmask_b32 v141, v141, v223, s[42:43]
    v_cmp_gt_i32 s[42:43], 33, v222
    s_waitcnt lgkmcnt(5)
    v_mfma_f32_32x32x16_bf16 v[176:191], a[84:87], a[24:27], v[176:191]
    s_add_u32 m0, s32, 103424
    ds_read_b128 a[76:79], v225 offset:49408
    buffer_load_dwordx4 v249, s[12:15], s29 offen lds
    v_cndmask_b32 v142, v142, v223, s[44:45]
    v_cmp_gt_i32 s[44:45], 34, v222
    s_waitcnt lgkmcnt(5)
    v_mfma_f32_32x32x16_bf16 v[160:175], a[88:91], a[28:31], v[160:175]
    s_add_u32 m0, s32, 104448
    ds_read_b128 a[80:83], v226 offset:33024
    buffer_load_dwordx4 v250, s[12:15], s29 offen lds
    v_cndmask_b32 v143, v143, v223, s[46:47]
    v_cmp_gt_i32 s[46:47], 35, v222
    s_waitcnt lgkmcnt(5)
    v_mfma_f32_32x32x16_bf16 v[176:191], a[92:95], a[28:31], v[176:191]
    s_add_u32 m0, s32, 105472
    ds_read_b128 a[84:87], v226 offset:49408
    buffer_load_dwordx4 v251, s[12:15], s29 offen lds
    v_cndmask_b32 v144, v144, v223, s[40:41]
    v_cmp_gt_i32 s[40:41], 40, v222
    s_add_u32 s29, s29, 128
    s_waitcnt lgkmcnt(5)
    v_mfma_f32_32x32x16_bf16 v[160:175], a[64:67], a[32:35], v[160:175]
    ds_read_b128 a[88:91], v227 offset:33024
    v_cndmask_b32 v145, v145, v223, s[42:43]
    v_cmp_gt_i32 s[42:43], 41, v222
    v_cndmask_b32 v146, v146, v223, s[44:45]
    v_cmp_gt_i32 s[44:45], 42, v222
    v_cndmask_b32 v147, v147, v223, s[46:47]
    v_cmp_gt_i32 s[46:47], 43, v222
    v_cndmask_b32 v148, v148, v223, s[40:41]
    s_waitcnt lgkmcnt(5)
    v_mfma_f32_32x32x16_bf16 v[176:191], a[68:71], a[32:35], v[176:191]
    ds_read_b128 a[92:95], v227 offset:49408
    v_cmp_gt_i32 s[40:41], 48, v222
    v_cndmask_b32 v149, v149, v223, s[42:43]
    v_cmp_gt_i32 s[42:43], 49, v222
    v_cndmask_b32 v150, v150, v223, s[44:45]
    v_cmp_gt_i32 s[44:45], 50, v222
    v_cndmask_b32 v151, v151, v223, s[46:47]
    v_cmp_gt_i32 s[46:47], 51, v222
    s_waitcnt lgkmcnt(5)
    v_mfma_f32_32x32x16_bf16 v[160:175], a[72:75], a[36:39], v[160:175]
    ds_read_b128 a[64:67], v228 offset:33024
    v_cndmask_b32 v152, v152, v223, s[40:41]
    v_cmp_gt_i32 s[40:41], 56, v222
    v_cndmask_b32 v153, v153, v223, s[42:43]
    v_cmp_gt_i32 s[42:43], 57, v222
    v_cndmask_b32 v154, v154, v223, s[44:45]
    v_cmp_gt_i32 s[44:45], 58, v222
    v_cndmask_b32 v155, v155, v223, s[46:47]
    s_waitcnt lgkmcnt(5)
    v_mfma_f32_32x32x16_bf16 v[176:191], a[76:79], a[36:39], v[176:191]
    ds_read_b128 a[68:71], v228 offset:49408
    v_cmp_gt_i32 s[46:47], 59, v222
    v_cndmask_b32 v156, v156, v223, s[40:41]
    s_nop 1
    v_cndmask_b32 v157, v157, v223, s[42:43]
    v_cndmask_b32 v158, v158, v223, s[44:45]
    v_cndmask_b32 v159, v159, v223, s[46:47]
    s_waitcnt lgkmcnt(5)
    v_mfma_f32_32x32x16_bf16 v[160:175], a[80:83], a[40:43], v[160:175]
    ds_read_b128 a[72:75], v229 offset:33024
    v_max3_f32 v208, v128, v129, v130
    v_max3_f32 v209, v136, v137, v138
    v_max3_f32 v210, v144, v145, v146
    v_max3_f32 v211, v152, v153, v154
    v_max3_f32 v208, v208, v131, v132
    v_max3_f32 v209, v209, v139, v140
    v_max3_f32 v210, v210, v147, v148
    s_waitcnt lgkmcnt(5)
    v_mfma_f32_32x32x16_bf16 v[176:191], a[84:87], a[40:43], v[176:191]
    ds_read_b128 a[76:79], v229 offset:49408
    v_max3_f32 v211, v211, v155, v156
    v_max3_f32 v208, v208, v133, v134
    v_max3_f32 v209, v209, v141, v142
    v_max3_f32 v210, v210, v149, v150
    v_max3_f32 v211, v211, v157, v158
    v_max3_f32 v208, v208, v135, v143
    v_max3_f32 v210, v210, v151, v159
    s_waitcnt lgkmcnt(5)
    v_mfma_f32_32x32x16_bf16 v[160:175], a[88:91], a[44:47], v[160:175]
    ds_read_b128 a[80:83], v230 offset:33024
    v_max3_f32 v208, v208, v209, v211
    v_max_f32 v208, v208, v210
    s_waitcnt lgkmcnt(5)
    v_mfma_f32_32x32x16_bf16 v[176:191], a[92:95], a[44:47], v[176:191]
    ds_read_b128 a[84:87], v230 offset:49408
    v_mov_b32 v209, v208
    s_nop 1
    v_permlane32_swap_b32 v208, v209
    v_max_f32 v208, v208, v209
    v_sub_f32 v209, v208, v220
    v_cmp_lt_f32 vcc, s49, v209
    s_nop 4
    s_cbranch_vccnz L_attn_rs3
L_attn_rs3_ret:
    s_waitcnt lgkmcnt(5)
    v_mfma_f32_32x32x16_bf16 v[160:175], a[64:67], a[48:51], v[160:175]
    ds_read_b128 a[88:91], v231 offset:33024
    v_fma_f32 v128, v128, s34, -v255
    v_fma_f32 v129, v129, s34, -v255
    v_fma_f32 v130, v130, s34, -v255
    v_fma_f32 v131, v131, s34, -v255
    v_fma_f32 v132, v132, s34, -v255
    v_fma_f32 v133, v133, s34, -v255
    v_fma_f32 v134, v134, s34, -v255
    s_waitcnt lgkmcnt(5)
    v_mfma_f32_32x32x16_bf16 v[176:191], a[68:71], a[48:51], v[176:191]
    ds_read_b128 a[92:95], v231 offset:49408
    v_fma_f32 v135, v135, s34, -v255
    v_exp_f32 v128, v128
    v_exp_f32 v129, v129
    v_exp_f32 v130, v130
    s_waitcnt lgkmcnt(5)
    v_mfma_f32_32x32x16_bf16 v[160:175], a[72:75], a[52:55], v[160:175]
    ds_read_b128 a[64:67], v232 offset:0
    v_exp_f32 v131, v131
    v_exp_f32 v132, v132
    v_exp_f32 v133, v133
    s_waitcnt lgkmcnt(5)
    v_mfma_f32_32x32x16_bf16 v[176:191], a[76:79], a[52:55], v[176:191]
    ds_read_b128 a[68:71], v232 offset:4096
    v_exp_f32 v134, v134
    v_exp_f32 v135, v135
    v_add_f32 v212, v128, v129
    v_add_f32 v213, v130, v131
    v_cvt_pk_bf16_f32 v192, v128, v129
    s_waitcnt lgkmcnt(5)
    v_mfma_f32_32x32x16_bf16 v[160:175], a[80:83], a[56:59], v[160:175]
    ds_read_b128 a[72:75], v232 offset:8192
    v_cvt_pk_bf16_f32 v193, v130, v131
    v_add_f32 v212, v212, v132
    v_add_f32 v213, v213, v133
    v_cvt_pk_bf16_f32 v194, v132, v133
    v_add_f32 v212, v212, v134
    v_add_f32 v213, v213, v135
    v_cvt_pk_bf16_f32 v195, v134, v135
    s_waitcnt lgkmcnt(5)
    v_mfma_f32_32x32x16_bf16 v[176:191], a[84:87], a[56:59], v[176:191]
    ds_read_b128 a[76:79], v232 offset:12288
    v_add_f32 v221, v221, v212
    v_add_f32 v221, v221, v213
    v_fma_f32 v136, v136, s34, -v255
    v_fma_f32 v137, v137, s34, -v255
    v_fma_f32 v138, v138, s34, -v255
    v_fma_f32 v139, v139, s34, -v255
    v_fma_f32 v140, v140, s34, -v255
    s_waitcnt lgkmcnt(5)
    v_mfma_f32_32x32x16_bf16 v[160:175], a[88:91], a[60:63], v[160:175]
    ds_read_b128 a[80:83], v232 offset:16384
    v_fma_f32 v141, v141, s34, -v255
    v_fma_f32 v142, v142, s34, -v255
    v_fma_f32 v143, v143, s34, -v255
    v_exp_f32 v136, v136
    v_exp_f32 v137, v137
    s_waitcnt lgkmcnt(5)
    v_mfma_f32_32x32x16_bf16 v[176:191], a[92:95], a[60:63], v[176:191]
    ds_read_b128 a[84:87], v232 offset:20480
    v_exp_f32 v138, v138
    v_exp_f32 v139, v139
    v_exp_f32 v140, v140
    s_waitcnt lgkmcnt(5)
    v_mfma_f32_32x32x16_bf16 v[0:15], a[64:67], v[192:195], v[0:15]
    ds_read_b128 a[88:91], v232 offset:24576
    v_exp_f32 v141, v141
    v_exp_f32 v142, v142
    v_exp_f32 v143, v143
    v_add_f32 v212, v136, v137
    s_waitcnt lgkmcnt(5)
    v_mfma_f32_32x32x16_bf16 v[16:31], a[68:71], v[192:195], v[16:31]
    ds_read_b128 a[92:95], v232 offset:28672
    v_add_f32 v213, v138, v139
    v_cvt_pk_bf16_f32 v196, v136, v137
    v_cvt_pk_bf16_f32 v197, v138, v139
    v_add_f32 v212, v212, v140
    v_add_f32 v213, v213, v141
    v_cvt_pk_bf16_f32 v198, v140, v141
    v_add_f32 v212, v212, v142
    s_waitcnt lgkmcnt(5)
    v_mfma_f32_32x32x16_bf16 v[32:47], a[72:75], v[192:195], v[32:47]
    ds_read_b128 a[64:67], v233 offset:0
    v_add_f32 v213, v213, v143
    v_cvt_pk_bf16_f32 v199, v142, v143
    v_add_f32 v221, v221, v212
    v_add_f32 v221, v221, v213
    v_fma_f32 v144, v144, s34, -v255
    v_fma_f32 v145, v145, s34, -v255
    v_fma_f32 v146, v146, s34, -v255
    s_waitcnt lgkmcnt(5)
    v_mfma_f32_32x32x16_bf16 v[48:63], a[76:79], v[192:195], v[48:63]
    ds_read_b128 a[68:71], v233 offset:4096
    v_fma_f32 v147, v147, s34, -v255
    v_fma_f32 v148, v148, s34, -v255
    v_fma_f32 v149, v149, s34, -v255
    v_fma_f32 v150, v150, s34, -v255
    v_fma_f32 v151, v151, s34, -v255
    v_exp_f32 v144, v144
    s_waitcnt lgkmcnt(5)
    v_mfma_f32_32x32x16_bf16 v[64:79], a[80:83], v[192:195], v[64:79]
    ds_read_b128 a[72:75], v233 offset:8192
    v_exp_f32 v145, v145
    v_exp_f32 v146, v146
    v_exp_f32 v147, v147
    s_waitcnt lgkmcnt(5)
    v_mfma_f32_32x32x16_bf16 v[80:95], a[84:87], v[192:195], v[80:95]
    ds_read_b128 a[76:79], v233 offset:12288
    v_exp_f32 v148, v148
    v_exp_f32 v149, v149
    v_exp_f32 v150, v150
    s_waitcnt lgkmcnt(5)
    v_mfma_f32_32x32x16_bf16 v[96:111], a[88:91], v[192:195], v[96:111]
    ds_read_b128 a[80:83], v233 offset:16384
    v_exp_f32 v151, v151
    v_add_f32 v212, v144, v145
    v_add_f32 v213, v146, v147
    v_cvt_pk_bf16_f32 v200, v144, v145
    v_cvt_pk_bf16_f32 v201, v146, v147
    v_add_f32 v212, v212, v148
    s_waitcnt lgkmcnt(5)
    v_mfma_f32_32x32x16_bf16 v[112:127], a[92:95], v[192:195], v[112:127]
    ds_read_b128 a[84:87], v233 offset:20480
    v_add_f32 v213, v213, v149
    v_cvt_pk_bf16_f32 v202, v148, v149
    v_add_f32 v212, v212, v150
    v_add_f32 v213, v213, v151
    v_cvt_pk_bf16_f32 v203, v150, v151
    v_add_f32 v221, v221, v212
    v_add_f32 v221, v221, v213
    s_waitcnt lgkmcnt(5)
    v_mfma_f32_32x32x16_bf16 v[0:15], a[64:67], v[196:199], v[0:15]
    ds_read_b128 a[88:91], v233 offset:24576
    v_fma_f32 v152, v152, s34, -v255
    v_fma_f32 v153, v153, s34, -v255
    v_fma_f32 v154, v154, s34, -v255
    v_fma_f32 v155, v155, s34, -v255
    v_fma_f32 v156, v156, s34, -v255
    v_fma_f32 v157, v157, s34, -v255
    v_fma_f32 v158, v158, s34, -v255
    s_waitcnt lgkmcnt(5)
    v_mfma_f32_32x32x16_bf16 v[16:31], a[68:71], v[196:199], v[16:31]
    ds_read_b128 a[92:95], v233 offset:28672
    v_fma_f32 v159, v159, s34, -v255
    v_exp_f32 v152, v152
    v_exp_f32 v153, v153
    v_exp_f32 v154, v154
    s_waitcnt lgkmcnt(5)
    v_mfma_f32_32x32x16_bf16 v[32:47], a[72:75], v[196:199], v[32:47]
    ds_read_b128 a[64:67], v234 offset:0
    v_exp_f32 v155, v155
    v_exp_f32 v156, v156
    v_exp_f32 v157, v157
    s_waitcnt lgkmcnt(5)
    v_mfma_f32_32x32x16_bf16 v[48:63], a[76:79], v[196:199], v[48:63]
    ds_read_b128 a[68:71], v234 offset:4096
    v_exp_f32 v158, v158
    v_exp_f32 v159, v159
    v_add_f32 v212, v152, v153
    v_add_f32 v213, v154, v155
    v_cvt_pk_bf16_f32 v204, v152, v153
    s_waitcnt lgkmcnt(5)
    v_mfma_f32_32x32x16_bf16 v[64:79], a[80:83], v[196:199], v[64:79]
    ds_read_b128 a[72:75], v234 offset:8192
    v_cvt_pk_bf16_f32 v205, v154, v155
    v_add_f32 v212, v212, v156
    v_add_f32 v213, v213, v157
    v_cvt_pk_bf16_f32 v206, v156, v157
    v_add_f32 v212, v212, v158
    v_add_f32 v213, v213, v159
    v_cvt_pk_bf16_f32 v207, v158, v159
    s_waitcnt lgkmcnt(5)
    v_mfma_f32_32x32x16_bf16 v[80:95], a[84:87], v[196:199], v[80:95]
    ds_read_b128 a[76:79], v234 offset:12288
    v_add_f32 v221, v221, v212
    v_add_f32 v221, v221, v213
    s_waitcnt lgkmcnt(5)
    v_mfma_f32_32x32x16_bf16 v[96:111], a[88:91], v[196:199], v[96:111]
    ds_read_b128 a[80:83], v234 offset:16384
    s_waitcnt lgkmcnt(5)
    v_mfma_f32_32x32x16_bf16 v[112:127], a[92:95], v[196:199], v[112:127]
    ds_read_b128 a[84:87], v234 offset:20480
    s_waitcnt lgkmcnt(5)
    v_mfma_f32_32x32x16_bf16 v[0:15], a[64:67], v[200:203], v[0:15]
    ds_read_b128 a[88:91], v234 offset:24576
    s_waitcnt lgkmcnt(5)
    v_mfma_f32_32x32x16_bf16 v[16:31], a[68:71], v[200:203], v[16:31]
    ds_read_b128 a[92:95], v234 offset:28672
    s_waitcnt lgkmcnt(5)
    v_mfma_f32_32x32x16_bf16 v[32:47], a[72:75], v[200:203], v[32:47]
    ds_read_b128 a[64:67], v235 offset:0
    s_waitcnt lgkmcnt(5)
    v_mfma_f32_32x32x16_bf16 v[48:63], a[76:79], v[200:203], v[48:63]
    ds_read_b128 a[68:71], v235 offset:4096
    s_waitcnt lgkmcnt(5)
    v_mfma_f32_32x32x16_bf16 v[64:79], a[80:83], v[200:203], v[64:79]
    ds_read_b128 a[72:75], v235 offset:8192
    s_waitcnt lgkmcnt(5)
    v_mfma_f32_32x32x16_bf16 v[80:95], a[84:87], v[200:203], v[80:95]
    ds_read_b128 a[76:79], v235 offset:12288
    s_waitcnt lgkmcnt(5)
    v_mfma_f32_32x32x16_bf16 v[96:111], a[88:91], v[200:203], v[96:111]
    ds_read_b128 a[80:83], v235 offset:16384
    s_waitcnt lgkmcnt(5)
    v_mfma_f32_32x32x16_bf16 v[112:127], a[92:95], v[200:203], v[112:127]
    ds_read_b128 a[84:87], v235 offset:20480
    s_waitcnt lgkmcnt(5)
    v_mfma_f32_32x32x16_bf16 v[0:15], a[64:67], v[204:207], v[0:15]
    ds_read_b128 a[88:91], v235 offset:24576
    s_waitcnt lgkmcnt(5)
    v_mfma_f32_32x32x16_bf16 v[16:31], a[68:71], v[204:207], v[16:31]
    ds_read_b128 a[92:95], v235 offset:28672
    s_waitcnt lgkmcnt(5)
    v_mfma_f32_32x32x16_bf16 v[32:47], a[72:75], v[204:207], v[32:47]
    s_waitcnt lgkmcnt(4)
    v_mfma_f32_32x32x16_bf16 v[48:63], a[76:79], v[204:207], v[48:63]
    s_waitcnt lgkmcnt(3)
    v_mfma_f32_32x32x16_bf16 v[64:79], a[80:83], v[204:207], v[64:79]
    s_waitcnt lgkmcnt(2)
    v_mfma_f32_32x32x16_bf16 v[80:95], a[84:87], v[204:207], v[80:95]
    s_waitcnt lgkmcnt(1)
    v_mfma_f32_32x32x16_bf16 v[96:111], a[88:91], v[204:207], v[96:111]
    s_waitcnt lgkmcnt(0)
    v_mfma_f32_32x32x16_bf16 v[112:127], a[92:95], v[204:207], v[112:127]
    s_mov_b32 s29, 0
    s_waitcnt vmcnt(0)
    s_cmp_lg_u32 s63, 2
    s_cbranch_scc1 L_attn_t1
    v_readfirstlane_b32 s30, v218
    s_and_b32 s31, s61, 31
    s_lshr_b32 s30, s30, s31
    s_and_b32 s30, s30, 1
    s_cbranch_scc0 L_attn_t1
    s_mov_b32 s63, 3
    s_mul_i32 s30, s61, 69632
    s_add_u32 s30, s30, 0x1000000
    s_lshl_b32 s31, s24, 8
    s_add_u32 s31, s31, s30
    s_add_u32 s31, s31, 65536
    s_lshl_b32 s60, s24, 14
    s_add_u32 s30, s30, s60
    v_lshlrev_b32 v218, 4, v252
    v_lshlrev_b32 v219, 3, v254
    buffer_load_dwordx2 a[160:161], v219, s[20:23], s31 offen sc1
    buffer_load_dwordx4 a[96:99], v218, s[20:23], s30 offen offset:0 sc1
    buffer_load_dwordx4 a[100:103], v218, s[20:23], s30 offen offset:1024 sc1
    buffer_load_dwordx4 a[104:107], v218, s[20:23], s30 offen offset:2048 sc1
    buffer_load_dwordx4 a[108:111], v218, s[20:23], s30 offen offset:3072 sc1
    s_add_u32 s30, s30, 4096
    buffer_load_dwordx4 a[112:115], v218, s[20:23], s30 offen offset:0 sc1
    buffer_load_dwordx4 a[116:119], v218, s[20:23], s30 offen offset:1024 sc1
    buffer_load_dwordx4 a[120:123], v218, s[20:23], s30 offen offset:2048 sc1
    buffer_load_dwordx4 a[124:127], v218, s[20:23], s30 offen offset:3072 sc1
    s_add_u32 s30, s30, 4096
    buffer_load_dwordx4 a[128:131], v218, s[20:23], s30 offen offset:0 sc1
    buffer_load_dwordx4 a[132:135], v218, s[20:23], s30 offen offset:1024 sc1
    buffer_load_dwordx4 a[136:139], v218, s[20:23], s30 offen offset:2048 sc1
    buffer_load_dwordx4 a[140:143], v218, s[20:23], s30 offen offset:3072 sc1
    s_add_u32 s30, s30, 4096
    buffer_load_dwordx4 a[144:147], v218, s[20:23], s30 offen offset:0 sc1
    buffer_load_dwordx4 a[148:151], v218, s[20:23], s30 offen offset:1024 sc1
    buffer_load_dwordx4 a[152:155], v218, s[20:23], s30 offen offset:2048 sc1
    buffer_load_dwordx4 a[156:159], v218, s[20:23], s30 offen offset:3072 sc1
L_attn_t1:
    s_waitcnt vmcnt(17)
    s_barrier
    ds_read_b128 a[64:67], v232 offset:32768
    ds_read_b128 a[68:71], v232 offset:36864
    ds_read_b128 a[72:75], v232 offset:40960
    ds_read_b128 a[76:79], v232 offset:45056
    ds_read_b128 a[80:83], v232 offset:49152
    s_add_u32 m0, s32, 32768
    ds_read_b128 a[84:87], v232 offset:53248
    buffer_load_dwordx4 v236, s[8:11], s28 offen lds
    s_add_u32 m0, s32, 33792
    s_nop 0
    buffer_load_dwordx4 v237, s[8:11], s28 offen lds
    s_add_u32 m0, s32, 34816
    s_nop 0
    buffer_load_dwordx4 v238, s[8:11], s28 offen lds
    s_add_u32 m0, s32, 35840
    s_nop 0
    buffer_load_dwordx4 v239, s[8:11], s28 offen lds
    s_add_u32 m0, s32, 36864
    s_nop 0
    buffer_load_dwordx4 v240, s[8:11], s28 offen lds
    s_add_u32 m0, s32, 37888
    s_nop 0
    buffer_load_dwordx4 v241, s[8:11], s28 offen lds
    s_add_u32 m0, s32, 38912
    s_nop 0
    buffer_load_dwordx4 v242, s[8:11], s28 offen lds
    s_add_u32 m0, s32, 39936
    s_nop 0
    buffer_load_dwordx4 v243, s[8:11], s28 offen lds
    s_add_u32 s28, s28, 0x80000
    s_add_u32 m0, s32, 65536
    s_nop 0
    buffer_load_dwordx4 v244, s[12:15], s29 offen lds
    s_add_u32 m0, s32, 66560
    s_nop 0
    buffer_load_dwordx4 v245, s[12:15], s29 offen lds
    s_add_u32 m0, s32, 67584
    s_nop 0
    buffer_load_dwordx4 v246, s[12:15], s29 offen lds
    s_add_u32 m0, s32, 68608
    s_nop 0
    buffer_load_dwordx4 v247, s[12:15], s29 offen lds
    s_add_u32 m0, s32, 69632
    s_nop 0
    buffer_load_dwordx4 v248, s[12:15], s29 offen lds
    s_add_u32 m0, s32, 70656
    s_nop 0
    buffer_load_dwordx4 v249, s[12:15], s29 offen lds
    s_add_u32 m0, s32, 71680
    s_nop 0
    buffer_load_dwordx4 v250, s[12:15], s29 offen lds
    s_add_u32 m0, s32, 72704
    s_nop 0
    buffer_load_dwordx4 v251, s[12:15], s29 offen lds
    s_add_u32 s29, s29, 128
    v_cmp_gt_i32 s[40:41], 64, v222
    s_mov_b32 s30, 65
    v_cmp_gt_i32 s[42:43], s30, v222
    s_mov_b32 s30, 66
    v_cmp_gt_i32 s[44:45], s30, v222
    s_mov_b32 s30, 67
    v_cmp_gt_i32 s[46:47], s30, v222
    v_cndmask_b32 v160, v160, v223, s[40:41]
    s_mov_b32 s30, 72
    v_cmp_gt_i32 s[40:41], s30, v222
    v_cndmask_b32 v161, v161, v223, s[42:43]
    s_mov_b32 s30, 73
    v_cmp_gt_i32 s[42:43], s30, v222
    v_cndmask_b32 v162, v162, v223, s[44:45]
    s_mov_b32 s30, 74
    v_cmp_gt_i32 s[44:45], s30, v222
    v_cndmask_b32 v163, v163, v223, s[46:47]
    s_mov_b32 s30, 75
    v_cmp_gt_i32 s[46:47], s30, v222
    v_cndmask_b32 v164, v164, v223, s[40:41]
    s_mov_b32 s30, 80
    v_cmp_gt_i32 s[40:41], s30, v222
    v_cndmask_b32 v165, v165, v223, s[42:43]
    s_mov_b32 s30, 81
    v_cmp_gt_i32 s[42:43], s30, v222
    v_cndmask_b32 v166, v166, v223, s[44:45]
    s_mov_b32 s30, 82
    v_cmp_gt_i32 s[44:45], s30, v222
    v_cndmask_b32 v167, v167, v223, s[46:47]
    s_mov_b32 s30, 83
    v_cmp_gt_i32 s[46:47], s30, v222
    v_cndmask_b32 v168, v168, v223, s[40:41]
    s_mov_b32 s30, 88
    v_cmp_gt_i32 s[40:41], s30, v222
    v_cndmask_b32 v169, v169, v223, s[42:43]
    s_mov_b32 s30, 89
    v_cmp_gt_i32 s[42:43], s30, v222
    v_cndmask_b32 v170, v170, v223, s[44:45]
    s_mov_b32 s30, 90
    v_cmp_gt_i32 s[44:45], s30, v222
    v_cndmask_b32 v171, v171, v223, s[46:47]
    s_mov_b32 s30, 91
    v_cmp_gt_i32 s[46:47], s30, v222
    v_cndmask_b32 v172, v172, v223, s[40:41]
    s_mov_b32 s30, 96
    v_cmp_gt_i32 s[40:41], s30, v222
    v_cndmask_b32 v173, v173, v223, s[42:43]
    s_mov_b32 s30, 97
    v_cmp_gt_i32 s[42:43], s30, v222
    v_cndmask_b32 v174, v174, v223, s[44:45]
    s_mov_b32 s30, 98
    v_cmp_gt_i32 s[44:45], s30, v222
    v_cndmask_b32 v175, v175, v223, s[46:47]
    s_mov_b32 s30, 99
    v_cmp_gt_i32 s[46:47], s30, v222
    v_cndmask_b32 v176, v176, v223, s[40:41]
    s_mov_b32 s30, 104
    v_cmp_gt_i32 s[40:41], s30, v222
    v_cndmask_b32 v177, v177, v223, s[42:43]
    s_mov_b32 s30, 105
    v_cmp_gt_i32 s[42:43], s30, v222
    v_cndmask_b32 v178, v178, v223, s[44:45]
    s_mov_b32 s30, 106
    v_cmp_gt_i32 s[44:45], s30, v222
    v_cndmask_b32 v179, v179, v223, s[46:47]
    s_mov_b32 s30, 107
    v_cmp_gt_i32 s[46:47], s30, v222
    v_cndmask_b32 v180, v180, v223, s[40:41]
    s_mov_b32 s30, 112
    v_cmp_gt_i32 s[40:41], s30, v222
    v_cndmask_b32 v181, v181, v223, s[42:43]
    s_mov_b32 s30, 113
    v_cmp_gt_i32 s[42:43], s30, v222
    v_cndmask_b32 v182, v182, v223, s[44:45]
    s_mov_b32 s30, 114
    v_cmp_gt_i32 s[44:45], s30, v222
    v_cndmask_b32 v183, v183, v223, s[46:47]
    s_mov_b32 s30, 115
    v_cmp_gt_i32 s[46:47], s30, v222
    v_cndmask_b32 v184, v184, v223, s[40:41]
    s_mov_b32 s30, 120
    v_cmp_gt_i32 s[40:41], s30, v222
    v_cndmask_b32 v185, v185, v223, s[42:43]
    s_mov_b32 s30, 121
    v_cmp_gt_i32 s[42:43], s30, v222
    v_cndmask_b32 v186, v186, v223, s[44:45]
    s_mov_b32 s30, 122
    v_cmp_gt_i32 s[44:45], s30, v222
    v_cndmask_b32 v187, v187, v223, s[46:47]
    s_mov_b32 s30, 123
    v_cmp_gt_i32 s[46:47], s30, v222
    v_cndmask_b32 v188, v188, v223, s[40:41]
    s_nop 1
    v_cndmask_b32 v189, v189, v223, s[42:43]
    v_cndmask_b32 v190, v190, v223, s[44:45]
    v_cndmask_b32 v191, v191, v223, s[46:47]
    v_max3_f32 v208, v160, v161, v162
    v_max3_f32 v209, v168, v169, v170
    v_max3_f32 v210, v176, v177, v178
    v_max3_f32 v211, v184, v185, v186
    v_max3_f32 v208, v208, v163, v164
    v_max3_f32 v209, v209, v171, v172
    v_max3_f32 v210, v210, v179, v180
    v_max3_f32 v211, v211, v187, v188
    v_max3_f32 v208, v208, v165, v166
    v_max3_f32 v209, v209, v173, v174
    v_max3_f32 v210, v210, v181, v182
    v_max3_f32 v211, v211, v189, v190
    v_max3_f32 v208, v208, v167, v175
    v_max3_f32 v210, v210, v183, v191
    v_max3_f32 v208, v208, v209, v211
    v_max_f32 v208, v208, v210
    v_mov_b32 v209, v208
    s_nop 1
    v_permlane32_swap_b32 v208, v209
    v_max_f32 v208, v208, v209
    v_sub_f32 v209, v208, v220
    v_cmp_lt_f32 vcc, s49, v209
    s_nop 4
    s_cbranch_vccnz L_attn_rs4
L_attn_rs4_ret:
    v_fma_f32 v160, v160, s34, -v255
    v_fma_f32 v161, v161, s34, -v255
    v_fma_f32 v162, v162, s34, -v255
    v_fma_f32 v163, v163, s34, -v255
    v_fma_f32 v164, v164, s34, -v255
    v_fma_f32 v165, v165, s34, -v255
    v_fma_f32 v166, v166, s34, -v255
    v_fma_f32 v167, v167, s34, -v255
    v_exp_f32 v160, v160
    v_exp_f32 v161, v161
    v_exp_f32 v162, v162
    v_exp_f32 v163, v163
    v_exp_f32 v164, v164
    v_exp_f32 v165, v165
    v_exp_f32 v166, v166
    v_exp_f32 v167, v167
    v_add_f32 v212, v160, v161
    v_add_f32 v213, v162, v163
    v_cvt_pk_bf16_f32 v192, v160, v161
    v_cvt_pk_bf16_f32 v193, v162, v163
    v_add_f32 v212, v212, v164
    v_add_f32 v213, v213, v165
    v_cvt_pk_bf16_f32 v194, v164, v165
    v_add_f32 v212, v212, v166
    v_add_f32 v213, v213, v167
    v_cvt_pk_bf16_f32 v195, v166, v167
    v_add_f32 v221, v221, v212
    v_add_f32 v221, v221, v213
    s_nop 1
    s_waitcnt lgkmcnt(5)
    v_mfma_f32_32x32x16_bf16 v[0:15], a[64:67], v[192:195], v[0:15]
    ds_read_b128 a[88:91], v232 offset:57344
    v_fma_f32 v168, v168, s34, -v255
    v_fma_f32 v169, v169, s34, -v255
    v_fma_f32 v170, v170, s34, -v255
    v_fma_f32 v171, v171, s34, -v255
    v_fma_f32 v172, v172, s34, -v255
    v_fma_f32 v173, v173, s34, -v255
    v_fma_f32 v174, v174, s34, -v255
    s_waitcnt lgkmcnt(5)
    v_mfma_f32_32x32x16_bf16 v[16:31], a[68:71], v[192:195], v[16:31]
    ds_read_b128 a[92:95], v232 offset:61440
    v_fma_f32 v175, v175, s34, -v255
    v_exp_f32 v168, v168
    v_exp_f32 v169, v169
    v_exp_f32 v170, v170
    s_waitcnt lgkmcnt(5)
    v_mfma_f32_32x32x16_bf16 v[32:47], a[72:75], v[192:195], v[32:47]
    ds_read_b128 a[64:67], v233 offset:32768
    v_exp_f32 v171, v171
    v_exp_f32 v172, v172
    v_exp_f32 v173, v173
    s_waitcnt lgkmcnt(5)
    v_mfma_f32_32x32x16_bf16 v[48:63], a[76:79], v[192:195], v[48:63]
    ds_read_b128 a[68:71], v233 offset:36864
    v_exp_f32 v174, v174
    v_exp_f32 v175, v175
    v_add_f32 v212, v168, v169
    v_add_f32 v213, v170, v171
    v_cvt_pk_bf16_f32 v196, v168, v169
    s_waitcnt lgkmcnt(5)
    v_mfma_f32_32x32x16_bf16 v[64:79], a[80:83], v[192:195], v[64:79]
    ds_read_b128 a[72:75], v233 offset:40960
    v_cvt_pk_bf16_f32 v197, v170, v171
    v_add_f32 v212, v212, v172
    v_add_f32 v213, v213, v173
    v_cvt_pk_bf16_f32 v198, v172, v173
    v_add_f32 v212, v212, v174
    v_add_f32 v213, v213, v175
    v_cvt_pk_bf16_f32 v199, v174, v175
    s_waitcnt lgkmcnt(5)
    v_mfma_f32_32x32x16_bf16 v[80:95], a[84:87], v[192:195], v[80:95]
    ds_read_b128 a[76:79], v233 offset:45056
    v_add_f32 v221, v221, v212
    v_add_f32 v221, v221, v213
    v_fma_f32 v176, v176, s34, -v255
    v_fma_f32 v177, v177, s34, -v255
    v_fma_f32 v178, v178, s34, -v255
    v_fma_f32 v179, v179, s34, -v255
    v_fma_f32 v180, v180, s34, -v255
    s_waitcnt lgkmcnt(5)
    v_mfma_f32_32x32x16_bf16 v[96:111], a[88:91], v[192:195], v[96:111]
    ds_read_b128 a[80:83], v233 offset:49152
    v_fma_f32 v181, v181, s34, -v255
    v_fma_f32 v182, v182, s34, -v255
    v_fma_f32 v183, v183, s34, -v255
    v_exp_f32 v176, v176
    v_exp_f32 v177, v177
    s_waitcnt lgkmcnt(5)
    v_mfma_f32_32x32x16_bf16 v[112:127], a[92:95], v[192:195], v[112:127]
    ds_read_b128 a[84:87], v233 offset:53248
    v_exp_f32 v178, v178
    v_exp_f32 v179, v179
    v_exp_f32 v180, v180
    s_waitcnt lgkmcnt(5)
    v_mfma_f32_32x32x16_bf16 v[0:15], a[64:67], v[196:199], v[0:15]
    ds_read_b128 a[88:91], v233 offset:57344
    v_exp_f32 v181, v181
    v_exp_f32 v182, v182
    v_exp_f32 v183, v183
    v_add_f32 v212, v176, v177
    s_waitcnt lgkmcnt(5)
    v_mfma_f32_32x32x16_bf16 v[16:31], a[68:71], v[196:199], v[16:31]
    ds_read_b128 a[92:95], v233 offset:61440
    v_add_f32 v213, v178, v179
    v_cvt_pk_bf16_f32 v200, v176, v177
    v_cvt_pk_bf16_f32 v201, v178, v179
    v_add_f32 v212, v212, v180
    v_add_f32 v213, v213, v181
    v_cvt_pk_bf16_f32 v202, v180, v181
    v_add_f32 v212, v212, v182
    s_waitcnt lgkmcnt(5)
    v_mfma_f32_32x32x16_bf16 v[32:47], a[72:75], v[196:199], v[32:47]
    ds_read_b128 a[64:67], v234 offset:32768
    v_add_f32 v213, v213, v183
    v_cvt_pk_bf16_f32 v203, v182, v183
    v_add_f32 v221, v221, v212
    v_add_f32 v221, v221, v213
    v_fma_f32 v184, v184, s34, -v255
    v_fma_f32 v185, v185, s34, -v255
    v_fma_f32 v186, v186, s34, -v255
    s_waitcnt lgkmcnt(5)
    v_mfma_f32_32x32x16_bf16 v[48:63], a[76:79], v[196:199], v[48:63]
    ds_read_b128 a[68:71], v234 offset:36864
    v_fma_f32 v187, v187, s34, -v255
    v_fma_f32 v188, v188, s34, -v255
    v_fma_f32 v189, v189, s34, -v255
    v_fma_f32 v190, v190, s34, -v255
    v_fma_f32 v191, v191, s34, -v255
    v_exp_f32 v184, v184
    s_waitcnt lgkmcnt(5)
    v_mfma_f32_32x32x16_bf16 v[64:79], a[80:83], v[196:199], v[64:79]
    ds_read_b128 a[72:75], v234 offset:40960
    v_exp_f32 v185, v185
    v_exp_f32 v186, v186
    v_exp_f32 v187, v187
    s_waitcnt lgkmcnt(5)
    v_mfma_f32_32x32x16_bf16 v[80:95], a[84:87], v[196:199], v[80:95]
    ds_read_b128 a[76:79], v234 offset:45056
    v_exp_f32 v188, v188
    v_exp_f32 v189, v189
    v_exp_f32 v190, v190
    s_waitcnt lgkmcnt(5)
    v_mfma_f32_32x32x16_bf16 v[96:111], a[88:91], v[196:199], v[96:111]
    ds_read_b128 a[80:83], v234 offset:49152
    v_exp_f32 v191, v191
    v_add_f32 v212, v184, v185
    v_add_f32 v213, v186, v187
    v_cvt_pk_bf16_f32 v204, v184, v185
    v_cvt_pk_bf16_f32 v205, v186, v187
    v_add_f32 v212, v212, v188
    s_waitcnt lgkmcnt(5)
    v_mfma_f32_32x32x16_bf16 v[112:127], a[92:95], v[196:199], v[112:127]
    ds_read_b128 a[84:87], v234 offset:53248
    v_add_f32 v213, v213, v189
    v_cvt_pk_bf16_f32 v206, v188, v189
    v_add_f32 v212, v212, v190
    v_add_f32 v213, v213, v191
    v_cvt_pk_bf16_f32 v207, v190, v191
    v_add_f32 v221, v221, v212
    v_add_f32 v221, v221, v213
    s_waitcnt lgkmcnt(5)
    v_mfma_f32_32x32x16_bf16 v[0:15], a[64:67], v[200:203], v[0:15]
    ds_read_b128 a[88:91], v234 offset:57344
    s_waitcnt lgkmcnt(5)
    v_mfma_f32_32x32x16_bf16 v[16:31], a[68:71], v[200:203], v[16:31]
    ds_read_b128 a[92:95], v234 offset:61440
    s_waitcnt lgkmcnt(5)
    v_mfma_f32_32x32x16_bf16 v[32:47], a[72:75], v[200:203], v[32:47]
    ds_read_b128 a[64:67], v235 offset:32768
    s_waitcnt lgkmcnt(5)
    v_mfma_f32_32x32x16_bf16 v[48:63], a[76:79], v[200:203], v[48:63]
    ds_read_b128 a[68:71], v235 offset:36864
    s_waitcnt lgkmcnt(5)
    v_mfma_f32_32x32x16_bf16 v[64:79], a[80:83], v[200:203], v[64:79]
    ds_read_b128 a[72:75], v235 offset:40960
    s_waitcnt lgkmcnt(5)
    v_mfma_f32_32x32x16_bf16 v[80:95], a[84:87], v[200:203], v[80:95]
    ds_read_b128 a[76:79], v235 offset:45056
    s_waitcnt lgkmcnt(5)
    v_mfma_f32_32x32x16_bf16 v[96:111], a[88:91], v[200:203], v[96:111]
    ds_read_b128 a[80:83], v235 offset:49152
    s_waitcnt lgkmcnt(5)
    v_mfma_f32_32x32x16_bf16 v[112:127], a[92:95], v[200:203], v[112:127]
    ds_read_b128 a[84:87], v235 offset:53248
    s_waitcnt lgkmcnt(5)
    v_mfma_f32_32x32x16_bf16 v[0:15], a[64:67], v[204:207], v[0:15]
    ds_read_b128 a[88:91], v235 offset:57344
    s_waitcnt lgkmcnt(5)
    v_mfma_f32_32x32x16_bf16 v[16:31], a[68:71], v[204:207], v[16:31]
    ds_read_b128 a[92:95], v235 offset:61440
    s_waitcnt lgkmcnt(5)
    v_mfma_f32_32x32x16_bf16 v[32:47], a[72:75], v[204:207], v[32:47]
    s_waitcnt lgkmcnt(4)
    v_mfma_f32_32x32x16_bf16 v[48:63], a[76:79], v[204:207], v[48:63]
    s_waitcnt lgkmcnt(3)
    v_mfma_f32_32x32x16_bf16 v[64:79], a[80:83], v[204:207], v[64:79]
    s_waitcnt lgkmcnt(2)
    v_mfma_f32_32x32x16_bf16 v[80:95], a[84:87], v[204:207], v[80:95]
    s_waitcnt lgkmcnt(1)
    v_mfma_f32_32x32x16_bf16 v[96:111], a[88:91], v[204:207], v[96:111]
    s_waitcnt lgkmcnt(0)
    v_mfma_f32_32x32x16_bf16 v[112:127], a[92:95], v[204:207], v[112:127]
    s_nop 15
    v_mov_b32 v208, v221
    s_nop 1
    v_permlane32_swap_b32 v208, v221
    v_add_f32 v209, v208, v221
    v_rcp_f32 v210, v209
    v_mov_b32 v208, v255
    s_mov_b32 s62, s37
    s_cmp_eq_u32 s63, 0
    s_cbranch_scc1 L_attn_store
    s_cmp_eq_u32 s63, 1
    s_cbranch_scc1 L_attn_first
    s_cmp_eq_u32 s63, 3
    s_cbranch_scc1 L_attn_merge
    s_lshr_b32 s31, s61, 5
    s_lshl_b32 s31, s31, 2
    s_and_b32 s30, s61, 31
    v_mov_b32 v219, 0
L_attn_poll:
    buffer_load_dword v218, v219, s[16:19], s31 offen sc1
    s_waitcnt vmcnt(0)
    v_readfirstlane_b32 s60, v218
    s_nop 3
    s_lshr_b32 s60, s60, s30
    s_and_b32 s60, s60, 1
    s_cbranch_scc1 L_attn_pl1
    s_sleep 4
    s_branch L_attn_poll
L_attn_pl1:
    s_mul_i32 s30, s61, 69632
    s_add_u32 s30, s30, 0x1000000
    s_lshl_b32 s31, s24, 8
    s_add_u32 s31, s31, s30
    s_add_u32 s31, s31, 65536
    s_lshl_b32 s60, s24, 14
    s_add_u32 s30, s30, s60
    v_lshlrev_b32 v218, 4, v252
    v_lshlrev_b32 v219, 3, v254
    buffer_load_dwordx2 a[160:161], v219, s[20:23], s31 offen sc1
    buffer_load_dwordx4 a[96:99], v218, s[20:23], s30 offen offset:0 sc1
    buffer_load_dwordx4 a[100:103], v218, s[20:23], s30 offen offset:1024 sc1
    buffer_load_dwordx4 a[104:107], v218, s[20:23], s30 offen offset:2048 sc1
    buffer_load_dwordx4 a[108:111], v218, s[20:23], s30 offen offset:3072 sc1
    s_add_u32 s30, s30, 4096
    buffer_load_dwordx4 a[112:115], v218, s[20:23], s30 offen offset:0 sc1
    buffer_load_dwordx4 a[116:119], v218, s[20:23], s30 offen offset:1024 sc1
    buffer_load_dwordx4 a[120:123], v218, s[20:23], s30 offen offset:2048 sc1
    buffer_load_dwordx4 a[124:127], v218, s[20:23], s30 offen offset:3072 sc1
    s_add_u32 s30, s30, 4096
    buffer_load_dwordx4 a[128:131], v218, s[20:23], s30 offen offset:0 sc1
    buffer_load_dwordx4 a[132:135], v218, s[20:23], s30 offen offset:1024 sc1
    buffer_load_dwordx4 a[136:139], v218, s[20:23], s30 offen offset:2048 sc1
    buffer_load_dwordx4 a[140:143], v218, s[20:23], s30 offen offset:3072 sc1
    s_add_u32 s30, s30, 4096
    buffer_load_dwordx4 a[144:147], v218, s[20:23], s30 offen offset:0 sc1
    buffer_load_dwordx4 a[148:151], v218, s[20:23], s30 offen offset:1024 sc1
    buffer_load_dwordx4 a[152:155], v218, s[20:23], s30 offen offset:2048 sc1
    buffer_load_dwordx4 a[156:159], v218, s[20:23], s30 offen offset:3072 sc1
L_attn_merge:
    s_waitcnt vmcnt(0)
    v_accvgpr_read_b32 v214, a160
    v_accvgpr_read_b32 v215, a161
    v_max_f32 v216, v208, v214
    v_sub_f32 v217, v208, v216
    v_sub_f32 v218, v214, v216
    v_exp_f32 v217, v217
    v_exp_f32 v218, v218
    s_nop 0
    v_mul_f32 v218, v218, v215
    v_fma_f32 v216, v217, v209, v218
    v_rcp_f32 v216, v216
    s_nop 0
    v_mul_f32 v217, v217, v216
    v_mul_f32 v218, v218, v216
    v_mov_b32 v210, 1.0
    v_accvgpr_read_b32 v128, a96
    v_accvgpr_read_b32 v129, a97
    v_accvgpr_read_b32 v130, a98
    v_accvgpr_read_b32 v131, a99
    v_accvgpr_read_b32 v132, a100
    v_accvgpr_read_b32 v133, a101
    v_accvgpr_read_b32 v134, a102
    v_accvgpr_read_b32 v135, a103
    v_accvgpr_read_b32 v136, a104
    v_accvgpr_read_b32 v137, a105
    v_accvgpr_read_b32 v138, a106
    v_accvgpr_read_b32 v139, a107
    v_accvgpr_read_b32 v140, a108
    v_accvgpr_read_b32 v141, a109
    v_accvgpr_read_b32 v142, a110
    v_accvgpr_read_b32 v143, a111
    v_accvgpr_read_b32 v144, a112
    v_accvgpr_read_b32 v145, a113
    v_accvgpr_read_b32 v146, a114
    v_accvgpr_read_b32 v147, a115
    v_accvgpr_read_b32 v148, a116
    v_accvgpr_read_b32 v149, a117
    v_accvgpr_read_b32 v150, a118
    v_accvgpr_read_b32 v151, a119
    v_accvgpr_read_b32 v152, a120
    v_accvgpr_read_b32 v153, a121
    v_accvgpr_read_b32 v154, a122
    v_accvgpr_read_b32 v155, a123
    v_accvgpr_read_b32 v156, a124
    v_accvgpr_read_b32 v157, a125
    v_accvgpr_read_b32 v158, a126
    v_accvgpr_read_b32 v159, a127
    v_accvgpr_read_b32 v160, a128
    v_accvgpr_read_b32 v161, a129
    v_accvgpr_read_b32 v162, a130
    v_accvgpr_read_b32 v163, a131
    v_accvgpr_read_b32 v164, a132
    v_accvgpr_read_b32 v165, a133
    v_accvgpr_read_b32 v166, a134
    v_accvgpr_read_b32 v167, a135
    v_accvgpr_read_b32 v168, a136
    v_accvgpr_read_b32 v169, a137
    v_accvgpr_read_b32 v170, a138
    v_accvgpr_read_b32 v171, a139
    v_accvgpr_read_b32 v172, a140
    v_accvgpr_read_b32 v173, a141
    v_accvgpr_read_b32 v174, a142
    v_accvgpr_read_b32 v175, a143
    v_accvgpr_read_b32 v176, a144
    v_accvgpr_read_b32 v177, a145
    v_accvgpr_read_b32 v178, a146
    v_accvgpr_read_b32 v179, a147
    v_accvgpr_read_b32 v180, a148
    v_accvgpr_read_b32 v181, a149
    v_accvgpr_read_b32 v182, a150
    v_accvgpr_read_b32 v183, a151
    v_accvgpr_read_b32 v184, a152
    v_accvgpr_read_b32 v185, a153
    v_accvgpr_read_b32 v186, a154
    v_accvgpr_read_b32 v187, a155
    v_accvgpr_read_b32 v188, a156
    v_accvgpr_read_b32 v189, a157
    v_accvgpr_read_b32 v190, a158
    v_accvgpr_read_b32 v191, a159
    v_mul_f32 v0, v0, v217
    v_mul_f32 v1, v1, v217
    v_mul_f32 v2, v2, v217
    v_mul_f32 v3, v3, v217
    v_mul_f32 v4, v4, v217
    v_mul_f32 v5, v5, v217
    v_mul_f32 v6, v6, v217
    v_mul_f32 v7, v7, v217
    v_mul_f32 v8, v8, v217
    v_mul_f32 v9, v9, v217
    v_mul_f32 v10, v10, v217
    v_mul_f32 v11, v11, v217
    v_mul_f32 v12, v12, v217
    v_mul_f32 v13, v13, v217
    v_mul_f32 v14, v14, v217
    v_mul_f32 v15, v15, v217
    v_mul_f32 v16, v16, v217
    v_mul_f32 v17, v17, v217
    v_mul_f32 v18, v18, v217
    v_mul_f32 v19, v19, v217
    v_mul_f32 v20, v20, v217
    v_mul_f32 v21, v21, v217
    v_mul_f32 v22, v22, v217
    v_mul_f32 v23, v23, v217
    v_mul_f32 v24, v24, v217
    v_mul_f32 v25, v25, v217
    v_mul_f32 v26, v26, v217
    v_mul_f32 v27, v27, v217
    v_mul_f32 v28, v28, v217
    v_mul_f32 v29, v29, v217
    v_mul_f32 v30, v30, v217
    v_mul_f32 v31, v31, v217
    v_mul_f32 v32, v32, v217
    v_mul_f32 v33, v33, v217
    v_mul_f32 v34, v34, v217
    v_mul_f32 v35, v35, v217
    v_mul_f32 v36, v36, v217
    v_mul_f32 v37, v37, v217
    v_mul_f32 v38, v38, v217
    v_mul_f32 v39, v39, v217
    v_mul_f32 v40, v40, v217
    v_mul_f32 v41, v41, v217
    v_mul_f32 v42, v42, v217
    v_mul_f32 v43, v43, v217
    v_mul_f32 v44, v44, v217
    v_mul_f32 v45, v45, v217
    v_mul_f32 v46, v46, v217
    v_mul_f32 v47, v47, v217
    v_mul_f32 v48, v48, v217
    v_mul_f32 v49, v49, v217
    v_mul_f32 v50, v50, v217
    v_mul_f32 v51, v51, v217
    v_mul_f32 v52, v52, v217
    v_mul_f32 v53, v53, v217
    v_mul_f32 v54, v54, v217
    v_mul_f32 v55, v55, v217
    v_mul_f32 v56, v56, v217
    v_mul_f32 v57, v57, v217
    v_mul_f32 v58, v58, v217
    v_mul_f32 v59, v59, v217
    v_mul_f32 v60, v60, v217
    v_mul_f32 v61, v61, v217
    v_mul_f32 v62, v62, v217
    v_mul_f32 v63, v63, v217
    v_mul_f32 v64, v64, v217
    v_mul_f32 v65, v65, v217
    v_mul_f32 v66, v66, v217
    v_mul_f32 v67, v67, v217
    v_mul_f32 v68, v68, v217
    v_mul_f32 v69, v69, v217
    v_mul_f32 v70, v70, v217
    v_mul_f32 v71, v71, v217
    v_mul_f32 v72, v72, v217
    v_mul_f32 v73, v73, v217
    v_mul_f32 v74, v74, v217
    v_mul_f32 v75, v75, v217
    v_mul_f32 v76, v76, v217
    v_mul_f32 v77, v77, v217
    v_mul_f32 v78, v78, v217
    v_mul_f32 v79, v79, v217
    v_mul_f32 v80, v80, v217
    v_mul_f32 v81, v81, v217
    v_mul_f32 v82, v82, v217
    v_mul_f32 v83, v83, v217
    v_mul_f32 v84, v84, v217
    v_mul_f32 v85, v85, v217
    v_mul_f32 v86, v86, v217
    v_mul_f32 v87, v87, v217
    v_mul_f32 v88, v88, v217
    v_mul_f32 v89, v89, v217
    v_mul_f32 v90, v90, v217
    v_mul_f32 v91, v91, v217
    v_mul_f32 v92, v92, v217
    v_mul_f32 v93, v93, v217
    v_mul_f32 v94, v94, v217
    v_mul_f32 v95, v95, v217
    v_mul_f32 v96, v96, v217
    v_mul_f32 v97, v97, v217
    v_mul_f32 v98, v98, v217
    v_mul_f32 v99, v99, v217
    v_mul_f32 v100, v100, v217
    v_mul_f32 v101, v101, v217
    v_mul_f32 v102, v102, v217
    v_mul_f32 v103, v103, v217
    v_mul_f32 v104, v104, v217
    v_mul_f32 v105, v105, v217
    v_mul_f32 v106, v106, v217
    v_mul_f32 v107, v107, v217
    v_mul_f32 v108, v108, v217
    v_mul_f32 v109, v109, v217
    v_mul_f32 v110, v110, v217
    v_mul_f32 v111, v111, v217
    v_mul_f32 v112, v112, v217
    v_mul_f32 v113, v113, v217
    v_mul_f32 v114, v114, v217
    v_mul_f32 v115, v115, v217
    v_mul_f32 v116, v116, v217
    v_mul_f32 v117, v117, v217
    v_mul_f32 v118, v118, v217
    v_mul_f32 v119, v119, v217
    v_mul_f32 v120, v120, v217
    v_mul_f32 v121, v121, v217
    v_mul_f32 v122, v122, v217
    v_mul_f32 v123, v123, v217
    v_mul_f32 v124, v124, v217
    v_mul_f32 v125, v125, v217
    v_mul_f32 v126, v126, v217
    v_mul_f32 v127, v127, v217
    v_lshlrev_b32 v192, 16, v128
    v_and_b32 v193, 0xffff0000, v128
    v_lshlrev_b32 v194, 16, v129
    v_and_b32 v195, 0xffff0000, v129
    v_lshlrev_b32 v196, 16, v130
    v_and_b32 v197, 0xffff0000, v130
    v_lshlrev_b32 v198, 16, v131
    v_and_b32 v199, 0xffff0000, v131
    v_fma_f32 v0, v192, v218, v0
    v_fma_f32 v1, v193, v218, v1
    v_fma_f32 v2, v194, v218, v2
    v_fma_f32 v3, v195, v218, v3
    v_fma_f32 v4, v196, v218, v4
    v_fma_f32 v5, v197, v218, v5
    v_fma_f32 v6, v198, v218, v6
    v_fma_f32 v7, v199, v218, v7
    v_lshlrev_b32 v192, 16, v132
    v_and_b32 v193, 0xffff0000, v132
    v_lshlrev_b32 v194, 16, v133
    v_and_b32 v195, 0xffff0000, v133
    v_lshlrev_b32 v196, 16, v134
    v_and_b32 v197, 0xffff0000, v134
    v_lshlrev_b32 v198, 16, v135
    v_and_b32 v199, 0xffff0000, v135
    v_fma_f32 v8, v192, v218, v8
    v_fma_f32 v9, v193, v218, v9
    v_fma_f32 v10, v194, v218, v10
    v_fma_f32 v11, v195, v218, v11
    v_fma_f32 v12, v196, v218, v12
    v_fma_f32 v13, v197, v218, v13
    v_fma_f32 v14, v198, v218, v14
    v_fma_f32 v15, v199, v218, v15
    v_lshlrev_b32 v192, 16, v136
    v_and_b32 v193, 0xffff0000, v136
    v_lshlrev_b32 v194, 16, v137
    v_and_b32 v195, 0xffff0000, v137
    v_lshlrev_b32 v196, 16, v138
    v_and_b32 v197, 0xffff0000, v138
    v_lshlrev_b32 v198, 16, v139
    v_and_b32 v199, 0xffff0000, v139
    v_fma_f32 v16, v192, v218, v16
    v_fma_f32 v17, v193, v218, v17
    v_fma_f32 v18, v194, v218, v18
    v_fma_f32 v19, v195, v218, v19
    v_fma_f32 v20, v196, v218, v20
    v_fma_f32 v21, v197, v218, v21
    v_fma_f32 v22, v198, v218, v22
    v_fma_f32 v23, v199, v218, v23
    v_lshlrev_b32 v192, 16, v140
    v_and_b32 v193, 0xffff0000, v140
    v_lshlrev_b32 v194, 16, v141
    v_and_b32 v195, 0xffff0000, v141
    v_lshlrev_b32 v196, 16, v142
    v_and_b32 v197, 0xffff0000, v142
    v_lshlrev_b32 v198, 16, v143
    v_and_b32 v199, 0xffff0000, v143
    v_fma_f32 v24, v192, v218, v24
    v_fma_f32 v25, v193, v218, v25
    v_fma_f32 v26, v194, v218, v26
    v_fma_f32 v27, v195, v218, v27
    v_fma_f32 v28, v196, v218, v28
    v_fma_f32 v29, v197, v218, v29
    v_fma_f32 v30, v198, v218, v30
    v_fma_f32 v31, v199, v218, v31
    v_lshlrev_b32 v192, 16, v144
    v_and_b32 v193, 0xffff0000, v144
    v_lshlrev_b32 v194, 16, v145
    v_and_b32 v195, 0xffff0000, v145
    v_lshlrev_b32 v196, 16, v146
    v_and_b32 v197, 0xffff0000, v146
    v_lshlrev_b32 v198, 16, v147
    v_and_b32 v199, 0xffff0000, v147
    v_fma_f32 v32, v192, v218, v32
    v_fma_f32 v33, v193, v218, v33
    v_fma_f32 v34, v194, v218, v34
    v_fma_f32 v35, v195, v218, v35
    v_fma_f32 v36, v196, v218, v36
    v_fma_f32 v37, v197, v218, v37
    v_fma_f32 v38, v198, v218, v38
    v_fma_f32 v39, v199, v218, v39
    v_lshlrev_b32 v192, 16, v148
    v_and_b32 v193, 0xffff0000, v148
    v_lshlrev_b32 v194, 16, v149
    v_and_b32 v195, 0xffff0000, v149
    v_lshlrev_b32 v196, 16, v150
    v_and_b32 v197, 0xffff0000, v150
    v_lshlrev_b32 v198, 16, v151
    v_and_b32 v199, 0xffff0000, v151
    v_fma_f32 v40, v192, v218, v40
    v_fma_f32 v41, v193, v218, v41
    v_fma_f32 v42, v194, v218, v42
    v_fma_f32 v43, v195, v218, v43
    v_fma_f32 v44, v196, v218, v44
    v_fma_f32 v45, v197, v218, v45
    v_fma_f32 v46, v198, v218, v46
    v_fma_f32 v47, v199, v218, v47
    v_lshlrev_b32 v192, 16, v152
    v_and_b32 v193, 0xffff0000, v152
    v_lshlrev_b32 v194, 16, v153
    v_and_b32 v195, 0xffff0000, v153
    v_lshlrev_b32 v196, 16, v154
    v_and_b32 v197, 0xffff0000, v154
    v_lshlrev_b32 v198, 16, v155
    v_and_b32 v199, 0xffff0000, v155
    v_fma_f32 v48, v192, v218, v48
    v_fma_f32 v49, v193, v218, v49
    v_fma_f32 v50, v194, v218, v50
    v_fma_f32 v51, v195, v218, v51
    v_fma_f32 v52, v196, v218, v52
    v_fma_f32 v53, v197, v218, v53
    v_fma_f32 v54, v198, v218, v54
    v_fma_f32 v55, v199, v218, v55
    v_lshlrev_b32 v192, 16, v156
    v_and_b32 v193, 0xffff0000, v156
    v_lshlrev_b32 v194, 16, v157
    v_and_b32 v195, 0xffff0000, v157
    v_lshlrev_b32 v196, 16, v158
    v_and_b32 v197, 0xffff0000, v158
    v_lshlrev_b32 v198, 16, v159
    v_and_b32 v199, 0xffff0000, v159
    v_fma_f32 v56, v192, v218, v56
    v_fma_f32 v57, v193, v218, v57
    v_fma_f32 v58, v194, v218, v58
    v_fma_f32 v59, v195, v218, v59
    v_fma_f32 v60, v196, v218, v60
    v_fma_f32 v61, v197, v218, v61
    v_fma_f32 v62, v198, v218, v62
    v_fma_f32 v63, v199, v218, v63
    v_lshlrev_b32 v192, 16, v160
    v_and_b32 v193, 0xffff0000, v160
    v_lshlrev_b32 v194, 16, v161
    v_and_b32 v195, 0xffff0000, v161
    v_lshlrev_b32 v196, 16, v162
    v_and_b32 v197, 0xffff0000, v162
    v_lshlrev_b32 v198, 16, v163
    v_and_b32 v199, 0xffff0000, v163
    v_fma_f32 v64, v192, v218, v64
    v_fma_f32 v65, v193, v218, v65
    v_fma_f32 v66, v194, v218, v66
    v_fma_f32 v67, v195, v218, v67
    v_fma_f32 v68, v196, v218, v68
    v_fma_f32 v69, v197, v218, v69
    v_fma_f32 v70, v198, v218, v70
    v_fma_f32 v71, v199, v218, v71
    v_lshlrev_b32 v192, 16, v164
    v_and_b32 v193, 0xffff0000, v164
    v_lshlrev_b32 v194, 16, v165
    v_and_b32 v195, 0xffff0000, v165
    v_lshlrev_b32 v196, 16, v166
    v_and_b32 v197, 0xffff0000, v166
    v_lshlrev_b32 v198, 16, v167
    v_and_b32 v199, 0xffff0000, v167
    v_fma_f32 v72, v192, v218, v72
    v_fma_f32 v73, v193, v218, v73
    v_fma_f32 v74, v194, v218, v74
    v_fma_f32 v75, v195, v218, v75
    v_fma_f32 v76, v196, v218, v76
    v_fma_f32 v77, v197, v218, v77
    v_fma_f32 v78, v198, v218, v78
    v_fma_f32 v79, v199, v218, v79
    v_lshlrev_b32 v192, 16, v168
    v_and_b32 v193, 0xffff0000, v168
    v_lshlrev_b32 v194, 16, v169
    v_and_b32 v195, 0xffff0000, v169
    v_lshlrev_b32 v196, 16, v170
    v_and_b32 v197, 0xffff0000, v170
    v_lshlrev_b32 v198, 16, v171
    v_and_b32 v199, 0xffff0000, v171
    v_fma_f32 v80, v192, v218, v80
    v_fma_f32 v81, v193, v218, v81
    v_fma_f32 v82, v194, v218, v82
    v_fma_f32 v83, v195, v218, v83
    v_fma_f32 v84, v196, v218, v84
    v_fma_f32 v85, v197, v218, v85
    v_fma_f32 v86, v198, v218, v86
    v_fma_f32 v87, v199, v218, v87
    v_lshlrev_b32 v192, 16, v172
    v_and_b32 v193, 0xffff0000, v172
    v_lshlrev_b32 v194, 16, v173
    v_and_b32 v195, 0xffff0000, v173
    v_lshlrev_b32 v196, 16, v174
    v_and_b32 v197, 0xffff0000, v174
    v_lshlrev_b32 v198, 16, v175
    v_and_b32 v199, 0xffff0000, v175
    v_fma_f32 v88, v192, v218, v88
    v_fma_f32 v89, v193, v218, v89
    v_fma_f32 v90, v194, v218, v90
    v_fma_f32 v91, v195, v218, v91
    v_fma_f32 v92, v196, v218, v92
    v_fma_f32 v93, v197, v218, v93
    v_fma_f32 v94, v198, v218, v94
    v_fma_f32 v95, v199, v218, v95
    v_lshlrev_b32 v192, 16, v176
    v_and_b32 v193, 0xffff0000, v176
    v_lshlrev_b32 v194, 16, v177
    v_and_b32 v195, 0xffff0000, v177
    v_lshlrev_b32 v196, 16, v178
    v_and_b32 v197, 0xffff0000, v178
    v_lshlrev_b32 v198, 16, v179
    v_and_b32 v199, 0xffff0000, v179
    v_fma_f32 v96, v192, v218, v96
    v_fma_f32 v97, v193, v218, v97
    v_fma_f32 v98, v194, v218, v98
    v_fma_f32 v99, v195, v218, v99
    v_fma_f32 v100, v196, v218, v100
    v_fma_f32 v101, v197, v218, v101
    v_fma_f32 v102, v198, v218, v102
    v_fma_f32 v103, v199, v218, v103
    v_lshlrev_b32 v192, 16, v180
    v_and_b32 v193, 0xffff0000, v180
    v_lshlrev_b32 v194, 16, v181
    v_and_b32 v195, 0xffff0000, v181
    v_lshlrev_b32 v196, 16, v182
    v_and_b32 v197, 0xffff0000, v182
    v_lshlrev_b32 v198, 16, v183
    v_and_b32 v199, 0xffff0000, v183
    v_fma_f32 v104, v192, v218, v104
    v_fma_f32 v105, v193, v218, v105
    v_fma_f32 v106, v194, v218, v106
    v_fma_f32 v107, v195, v218, v107
    v_fma_f32 v108, v196, v218, v108
    v_fma_f32 v109, v197, v218, v109
    v_fma_f32 v110, v198, v218, v110
    v_fma_f32 v111, v199, v218, v111
    v_lshlrev_b32 v192, 16, v184
    v_and_b32 v193, 0xffff0000, v184
    v_lshlrev_b32 v194, 16, v185
    v_and_b32 v195, 0xffff0000, v185
    v_lshlrev_b32 v196, 16, v186
    v_and_b32 v197, 0xffff0000, v186
    v_lshlrev_b32 v198, 16, v187
    v_and_b32 v199, 0xffff0000, v187
    v_fma_f32 v112, v192, v218, v112
    v_fma_f32 v113, v193, v218, v113
    v_fma_f32 v114, v194, v218, v114
    v_fma_f32 v115, v195, v218, v115
    v_fma_f32 v116, v196, v218, v116
    v_fma_f32 v117, v197, v218, v117
    v_fma_f32 v118, v198, v218, v118
    v_fma_f32 v119, v199, v218, v119
    v_lshlrev_b32 v192, 16, v188
    v_and_b32 v193, 0xffff0000, v188
    v_lshlrev_b32 v194, 16, v189
    v_and_b32 v195, 0xffff0000, v189
    v_lshlrev_b32 v196, 16, v190
    v_and_b32 v197, 0xffff0000, v190
    v_lshlrev_b32 v198, 16, v191
    v_and_b32 v199, 0xffff0000, v191
    v_fma_f32 v120, v192, v218, v120
    v_fma_f32 v121, v193, v218, v121
    v_fma_f32 v122, v194, v218, v122
    v_fma_f32 v123, v195, v218, v123
    v_fma_f32 v124, v196, v218, v124
    v_fma_f32 v125, v197, v218, v125
    v_fma_f32 v126, v198, v218, v126
    v_fma_f32 v127, v199, v218, v127
    s_branch L_attn_store
L_attn_first:
    s_mul_i32 s30, s61, 69632
    s_add_u32 s30, s30, 0x1000000
    s_lshl_b32 s31, s24, 8
    s_add_u32 s31, s31, s30
    s_add_u32 s31, s31, 65536
    s_lshl_b32 s60, s24, 14
    s_add_u32 s30, s30, s60
    v_lshlrev_b32 v218, 4, v252
    v_lshlrev_b32 v219, 3, v254
    buffer_store_dwordx2 v[208:209], v219, s[20:23], s31 offen sc1
    v_mul_f32 v0, v0, v210
    v_mul_f32 v1, v1, v210
    v_mul_f32 v2, v2, v210
    v_mul_f32 v3, v3, v210
    v_mul_f32 v4, v4, v210
    v_mul_f32 v5, v5, v210
    v_mul_f32 v6, v6, v210
    v_mul_f32 v7, v7, v210
    v_cvt_pk_bf16_f32 v128, v0, v1
    v_cvt_pk_bf16_f32 v129, v2, v3
    v_cvt_pk_bf16_f32 v130, v4, v5
    v_cvt_pk_bf16_f32 v131, v6, v7
    buffer_store_dwordx4 v[128:131], v218, s[20:23], s30 offen offset:0 sc1
    v_mul_f32 v8, v8, v210
    v_mul_f32 v9, v9, v210
    v_mul_f32 v10, v10, v210
    v_mul_f32 v11, v11, v210
    v_mul_f32 v12, v12, v210
    v_mul_f32 v13, v13, v210
    v_mul_f32 v14, v14, v210
    v_mul_f32 v15, v15, v210
    v_cvt_pk_bf16_f32 v132, v8, v9
    v_cvt_pk_bf16_f32 v133, v10, v11
    v_cvt_pk_bf16_f32 v134, v12, v13
    v_cvt_pk_bf16_f32 v135, v14, v15
    buffer_store_dwordx4 v[132:135], v218, s[20:23], s30 offen offset:1024 sc1
    v_mul_f32 v16, v16, v210
    v_mul_f32 v17, v17, v210
    v_mul_f32 v18, v18, v210
    v_mul_f32 v19, v19, v210
    v_mul_f32 v20, v20, v210
    v_mul_f32 v21, v21, v210
    v_mul_f32 v22, v22, v210
    v_mul_f32 v23, v23, v210
    v_cvt_pk_bf16_f32 v136, v16, v17
    v_cvt_pk_bf16_f32 v137, v18, v19
    v_cvt_pk_bf16_f32 v138, v20, v21
    v_cvt_pk_bf16_f32 v139, v22, v23
    buffer_store_dwordx4 v[136:139], v218, s[20:23], s30 offen offset:2048 sc1
    v_mul_f32 v24, v24, v210
    v_mul_f32 v25, v25, v210
    v_mul_f32 v26, v26, v210
    v_mul_f32 v27, v27, v210
    v_mul_f32 v28, v28, v210
    v_mul_f32 v29, v29, v210
    v_mul_f32 v30, v30, v210
    v_mul_f32 v31, v31, v210
    v_cvt_pk_bf16_f32 v140, v24, v25
    v_cvt_pk_bf16_f32 v141, v26, v27
    v_cvt_pk_bf16_f32 v142, v28, v29
    v_cvt_pk_bf16_f32 v143, v30, v31
    buffer_store_dwordx4 v[140:143], v218, s[20:23], s30 offen offset:3072 sc1
    s_add_u32 s30, s30, 4096
    v_mul_f32 v32, v32, v210
    v_mul_f32 v33, v33, v210
    v_mul_f32 v34, v34, v210
    v_mul_f32 v35, v35, v210
    v_mul_f32 v36, v36, v210
    v_mul_f32 v37, v37, v210
    v_mul_f32 v38, v38, v210
    v_mul_f32 v39, v39, v210
    v_cvt_pk_bf16_f32 v144, v32, v33
    v_cvt_pk_bf16_f32 v145, v34, v35
    v_cvt_pk_bf16_f32 v146, v36, v37
    v_cvt_pk_bf16_f32 v147, v38, v39
    buffer_store_dwordx4 v[144:147], v218, s[20:23], s30 offen offset:0 sc1
    v_mul_f32 v40, v40, v210
    v_mul_f32 v41, v41, v210
    v_mul_f32 v42, v42, v210
    v_mul_f32 v43, v43, v210
    v_mul_f32 v44, v44, v210
    v_mul_f32 v45, v45, v210
    v_mul_f32 v46, v46, v210
    v_mul_f32 v47, v47, v210
    v_cvt_pk_bf16_f32 v148, v40, v41
    v_cvt_pk_bf16_f32 v149, v42, v43
    v_cvt_pk_bf16_f32 v150, v44, v45
    v_cvt_pk_bf16_f32 v151, v46, v47
    buffer_store_dwordx4 v[148:151], v218, s[20:23], s30 offen offset:1024 sc1
    v_mul_f32 v48, v48, v210
    v_mul_f32 v49, v49, v210
    v_mul_f32 v50, v50, v210
    v_mul_f32 v51, v51, v210
    v_mul_f32 v52, v52, v210
    v_mul_f32 v53, v53, v210
    v_mul_f32 v54, v54, v210
    v_mul_f32 v55, v55, v210
    v_cvt_pk_bf16_f32 v152, v48, v49
    v_cvt_pk_bf16_f32 v153, v50, v51
    v_cvt_pk_bf16_f32 v154, v52, v53
    v_cvt_pk_bf16_f32 v155, v54, v55
    buffer_store_dwordx4 v[152:155], v218, s[20:23], s30 offen offset:2048 sc1
    v_mul_f32 v56, v56, v210
    v_mul_f32 v57, v57, v210
    v_mul_f32 v58, v58, v210
    v_mul_f32 v59, v59, v210
    v_mul_f32 v60, v60, v210
    v_mul_f32 v61, v61, v210
    v_mul_f32 v62, v62, v210
    v_mul_f32 v63, v63, v210
    v_cvt_pk_bf16_f32 v156, v56, v57
    v_cvt_pk_bf16_f32 v157, v58, v59
    v_cvt_pk_bf16_f32 v158, v60, v61
    v_cvt_pk_bf16_f32 v159, v62, v63
    buffer_store_dwordx4 v[156:159], v218, s[20:23], s30 offen offset:3072 sc1
    s_add_u32 s30, s30, 4096
    v_mul_f32 v64, v64, v210
    v_mul_f32 v65, v65, v210
    v_mul_f32 v66, v66, v210
    v_mul_f32 v67, v67, v210
    v_mul_f32 v68, v68, v210
    v_mul_f32 v69, v69, v210
    v_mul_f32 v70, v70, v210
    v_mul_f32 v71, v71, v210
    v_cvt_pk_bf16_f32 v160, v64, v65
    v_cvt_pk_bf16_f32 v161, v66, v67
    v_cvt_pk_bf16_f32 v162, v68, v69
    v_cvt_pk_bf16_f32 v163, v70, v71
    buffer_store_dwordx4 v[160:163], v218, s[20:23], s30 offen offset:0 sc1
    v_mul_f32 v72, v72, v210
    v_mul_f32 v73, v73, v210
    v_mul_f32 v74, v74, v210
    v_mul_f32 v75, v75, v210
    v_mul_f32 v76, v76, v210
    v_mul_f32 v77, v77, v210
    v_mul_f32 v78, v78, v210
    v_mul_f32 v79, v79, v210
    v_cvt_pk_bf16_f32 v164, v72, v73
    v_cvt_pk_bf16_f32 v165, v74, v75
    v_cvt_pk_bf16_f32 v166, v76, v77
    v_cvt_pk_bf16_f32 v167, v78, v79
    buffer_store_dwordx4 v[164:167], v218, s[20:23], s30 offen offset:1024 sc1
    v_mul_f32 v80, v80, v210
    v_mul_f32 v81, v81, v210
    v_mul_f32 v82, v82, v210
    v_mul_f32 v83, v83, v210
    v_mul_f32 v84, v84, v210
    v_mul_f32 v85, v85, v210
    v_mul_f32 v86, v86, v210
    v_mul_f32 v87, v87, v210
    v_cvt_pk_bf16_f32 v168, v80, v81
    v_cvt_pk_bf16_f32 v169, v82, v83
    v_cvt_pk_bf16_f32 v170, v84, v85
    v_cvt_pk_bf16_f32 v171, v86, v87
    buffer_store_dwordx4 v[168:171], v218, s[20:23], s30 offen offset:2048 sc1
    v_mul_f32 v88, v88, v210
    v_mul_f32 v89, v89, v210
    v_mul_f32 v90, v90, v210
    v_mul_f32 v91, v91, v210
    v_mul_f32 v92, v92, v210
    v_mul_f32 v93, v93, v210
    v_mul_f32 v94, v94, v210
    v_mul_f32 v95, v95, v210
    v_cvt_pk_bf16_f32 v172, v88, v89
    v_cvt_pk_bf16_f32 v173, v90, v91
    v_cvt_pk_bf16_f32 v174, v92, v93
    v_cvt_pk_bf16_f32 v175, v94, v95
    buffer_store_dwordx4 v[172:175], v218, s[20:23], s30 offen offset:3072 sc1
    s_add_u32 s30, s30, 4096
    v_mul_f32 v96, v96, v210
    v_mul_f32 v97, v97, v210
    v_mul_f32 v98, v98, v210
    v_mul_f32 v99, v99, v210
    v_mul_f32 v100, v100, v210
    v_mul_f32 v101, v101, v210
    v_mul_f32 v102, v102, v210
    v_mul_f32 v103, v103, v210
    v_cvt_pk_bf16_f32 v176, v96, v97
    v_cvt_pk_bf16_f32 v177, v98, v99
    v_cvt_pk_bf16_f32 v178, v100, v101
    v_cvt_pk_bf16_f32 v179, v102, v103
    buffer_store_dwordx4 v[176:179], v218, s[20:23], s30 offen offset:0 sc1
    v_mul_f32 v104, v104, v210
    v_mul_f32 v105, v105, v210
    v_mul_f32 v106, v106, v210
    v_mul_f32 v107, v107, v210
    v_mul_f32 v108, v108, v210
    v_mul_f32 v109, v109, v210
    v_mul_f32 v110, v110, v210
    v_mul_f32 v111, v111, v210
    v_cvt_pk_bf16_f32 v180, v104, v105
    v_cvt_pk_bf16_f32 v181, v106, v107
    v_cvt_pk_bf16_f32 v182, v108, v109
    v_cvt_pk_bf16_f32 v183, v110, v111
    buffer_store_dwordx4 v[180:183], v218, s[20:23], s30 offen offset:1024 sc1
    v_mul_f32 v112, v112, v210
    v_mul_f32 v113, v113, v210
    v_mul_f32 v114, v114, v210
    v_mul_f32 v115, v115, v210
    v_mul_f32 v116, v116, v210
    v_mul_f32 v117, v117, v210
    v_mul_f32 v118, v118, v210
    v_mul_f32 v119, v119, v210
    v_cvt_pk_bf16_f32 v184, v112, v113
    v_cvt_pk_bf16_f32 v185, v114, v115
    v_cvt_pk_bf16_f32 v186, v116, v117
    v_cvt_pk_bf16_f32 v187, v118, v119
    buffer_store_dwordx4 v[184:187], v218, s[20:23], s30 offen offset:2048 sc1
    v_mul_f32 v120, v120, v210
    v_mul_f32 v121, v121, v210
    v_mul_f32 v122, v122, v210
    v_mul_f32 v123, v123, v210
    v_mul_f32 v124, v124, v210
    v_mul_f32 v125, v125, v210
    v_mul_f32 v126, v126, v210
    v_mul_f32 v127, v127, v210
    v_cvt_pk_bf16_f32 v188, v120, v121
    v_cvt_pk_bf16_f32 v189, v122, v123
    v_cvt_pk_bf16_f32 v190, v124, v125
    v_cvt_pk_bf16_f32 v191, v126, v127
    buffer_store_dwordx4 v[188:191], v218, s[20:23], s30 offen offset:3072 sc1
    s_branch L_attn_stored
L_attn_store:
    s_lshl_b32 s30, s24, 13
    s_add_u32 s30, s30, 0x20000
    v_lshlrev_b32 v212, 8, v254
    v_lshl_add_u32 v212, v253, 3, v212
    v_add_u32 v212, s30, v212
    v_and_b32 v215, 15, v254
    v_lshlrev_b32 v215, 4, v215
    v_lshrrev_b32 v213, 4, v252
    v_and_b32 v214, 15, v252
    s_lshl_b32 s31, s26, 7
    s_lshl_b32 s39, s24, 5
    s_add_u32 s31, s31, s39
    s_lshl_b32 s31, s31, 13
    s_lshl_b32 s39, s25, 9
    s_add_u32 s31, s31, s39
    s_lshl_b32 s39, s62, 24
    s_add_u32 s39, s39, s31
    v_lshlrev_b32 v216, 13, v213
    v_lshl_add_u32 v216, v214, 4, v216
    v_mul_f32 v0, v0, v210
    v_mul_f32 v1, v1, v210
    v_mul_f32 v2, v2, v210
    v_mul_f32 v3, v3, v210
    v_cvt_pk_bf16_f32 v192, v0, v1
    v_cvt_pk_bf16_f32 v193, v2, v3
    v_xor_b32 v217, 0, v215
    v_add_u32 v217, v217, v212
    ds_write_b64 v217, v[192:193]
    v_mul_f32 v4, v4, v210
    v_mul_f32 v5, v5, v210
    v_mul_f32 v6, v6, v210
    v_mul_f32 v7, v7, v210
    v_cvt_pk_bf16_f32 v194, v4, v5
    v_cvt_pk_bf16_f32 v195, v6, v7
    v_xor_b32 v217, 16, v215
    v_add_u32 v217, v217, v212
    ds_write_b64 v217, v[194:195]
    v_mul_f32 v8, v8, v210
    v_mul_f32 v9, v9, v210
    v_mul_f32 v10, v10, v210
    v_mul_f32 v11, v11, v210
    v_cvt_pk_bf16_f32 v196, v8, v9
    v_cvt_pk_bf16_f32 v197, v10, v11
    v_xor_b32 v217, 32, v215
    v_add_u32 v217, v217, v212
    ds_write_b64 v217, v[196:197]
    v_mul_f32 v12, v12, v210
    v_mul_f32 v13, v13, v210
    v_mul_f32 v14, v14, v210
    v_mul_f32 v15, v15, v210
    v_cvt_pk_bf16_f32 v198, v12, v13
    v_cvt_pk_bf16_f32 v199, v14, v15
    v_xor_b32 v217, 48, v215
    v_add_u32 v217, v217, v212
    ds_write_b64 v217, v[198:199]
    v_mul_f32 v16, v16, v210
    v_mul_f32 v17, v17, v210
    v_mul_f32 v18, v18, v210
    v_mul_f32 v19, v19, v210
    v_cvt_pk_bf16_f32 v200, v16, v17
    v_cvt_pk_bf16_f32 v201, v18, v19
    v_xor_b32 v217, 64, v215
    v_add_u32 v217, v217, v212
    ds_write_b64 v217, v[200:201]
    v_mul_f32 v20, v20, v210
    v_mul_f32 v21, v21, v210
    v_mul_f32 v22, v22, v210
    v_mul_f32 v23, v23, v210
    v_cvt_pk_bf16_f32 v202, v20, v21
    v_cvt_pk_bf16_f32 v203, v22, v23
    v_xor_b32 v217, 80, v215
    v_add_u32 v217, v217, v212
    ds_write_b64 v217, v[202:203]
    v_mul_f32 v24, v24, v210
    v_mul_f32 v25, v25, v210
    v_mul_f32 v26, v26, v210
    v_mul_f32 v27, v27, v210
    v_cvt_pk_bf16_f32 v204, v24, v25
    v_cvt_pk_bf16_f32 v205, v26, v27
    v_xor_b32 v217, 96, v215
    v_add_u32 v217, v217, v212
    ds_write_b64 v217, v[204:205]
    v_mul_f32 v28, v28, v210
    v_mul_f32 v29, v29, v210
    v_mul_f32 v30, v30, v210
    v_mul_f32 v31, v31, v210
    v_cvt_pk_bf16_f32 v206, v28, v29
    v_cvt_pk_bf16_f32 v207, v30, v31
    v_xor_b32 v217, 112, v215
    v_add_u32 v217, v217, v212
    ds_write_b64 v217, v[206:207]
    v_mul_f32 v32, v32, v210
    v_mul_f32 v33, v33, v210
    v_mul_f32 v34, v34, v210
    v_mul_f32 v35, v35, v210
    v_cvt_pk_bf16_f32 v192, v32, v33
    v_cvt_pk_bf16_f32 v193, v34, v35
    v_xor_b32 v217, 128, v215
    v_add_u32 v217, v217, v212
    ds_write_b64 v217, v[192:193]
    v_mul_f32 v36, v36, v210
    v_mul_f32 v37, v37, v210
    v_mul_f32 v38, v38, v210
    v_mul_f32 v39, v39, v210
    v_cvt_pk_bf16_f32 v194, v36, v37
    v_cvt_pk_bf16_f32 v195, v38, v39
    v_xor_b32 v217, 144, v215
    v_add_u32 v217, v217, v212
    ds_write_b64 v217, v[194:195]
    v_mul_f32 v40, v40, v210
    v_mul_f32 v41, v41, v210
    v_mul_f32 v42, v42, v210
    v_mul_f32 v43, v43, v210
    v_cvt_pk_bf16_f32 v196, v40, v41
    v_cvt_pk_bf16_f32 v197, v42, v43
    v_xor_b32 v217, 160, v215
    v_add_u32 v217, v217, v212
    ds_write_b64 v217, v[196:197]
    v_mul_f32 v44, v44, v210
    v_mul_f32 v45, v45, v210
    v_mul_f32 v46, v46, v210
    v_mul_f32 v47, v47, v210
    v_cvt_pk_bf16_f32 v198, v44, v45
    v_cvt_pk_bf16_f32 v199, v46, v47
    v_xor_b32 v217, 176, v215
    v_add_u32 v217, v217, v212
    ds_write_b64 v217, v[198:199]
    v_mul_f32 v48, v48, v210
    v_mul_f32 v49, v49, v210
    v_mul_f32 v50, v50, v210
    v_mul_f32 v51, v51, v210
    v_cvt_pk_bf16_f32 v200, v48, v49
    v_cvt_pk_bf16_f32 v201, v50, v51
    v_xor_b32 v217, 192, v215
    v_add_u32 v217, v217, v212
    ds_write_b64 v217, v[200:201]
    v_mul_f32 v52, v52, v210
    v_mul_f32 v53, v53, v210
    v_mul_f32 v54, v54, v210
    v_mul_f32 v55, v55, v210
    v_cvt_pk_bf16_f32 v202, v52, v53
    v_cvt_pk_bf16_f32 v203, v54, v55
    v_xor_b32 v217, 208, v215
    v_add_u32 v217, v217, v212
    ds_write_b64 v217, v[202:203]
    v_mul_f32 v56, v56, v210
    v_mul_f32 v57, v57, v210
    v_mul_f32 v58, v58, v210
    v_mul_f32 v59, v59, v210
    v_cvt_pk_bf16_f32 v204, v56, v57
    v_cvt_pk_bf16_f32 v205, v58, v59
    v_xor_b32 v217, 224, v215
    v_add_u32 v217, v217, v212
    ds_write_b64 v217, v[204:205]
    v_mul_f32 v60, v60, v210
    v_mul_f32 v61, v61, v210
    v_mul_f32 v62, v62, v210
    v_mul_f32 v63, v63, v210
    v_cvt_pk_bf16_f32 v206, v60, v61
    v_cvt_pk_bf16_f32 v207, v62, v63
    v_xor_b32 v217, 240, v215
    v_add_u32 v217, v217, v212
    ds_write_b64 v217, v[206:207]
    s_waitcnt lgkmcnt(0)
    v_add_u32 v217, 0, v213
    v_and_b32 v218, 15, v217
    v_xor_b32 v218, v218, v214
    v_lshlrev_b32 v217, 8, v217
    v_lshl_add_u32 v217, v218, 4, v217
    v_add_u32 v217, s30, v217
    ds_read_b128 v[128:131], v217
    v_add_u32 v217, 4, v213
    v_and_b32 v218, 15, v217
    v_xor_b32 v218, v218, v214
    v_lshlrev_b32 v217, 8, v217
    v_lshl_add_u32 v217, v218, 4, v217
    v_add_u32 v217, s30, v217
    ds_read_b128 v[132:135], v217
    v_add_u32 v217, 8, v213
    v_and_b32 v218, 15, v217
    v_xor_b32 v218, v218, v214
    v_lshlrev_b32 v217, 8, v217
    v_lshl_add_u32 v217, v218, 4, v217
    v_add_u32 v217, s30, v217
    ds_read_b128 v[136:139], v217
    v_add_u32 v217, 12, v213
    v_and_b32 v218, 15, v217
    v_xor_b32 v218, v218, v214
    v_lshlrev_b32 v217, 8, v217
    v_lshl_add_u32 v217, v218, 4, v217
    v_add_u32 v217, s30, v217
    ds_read_b128 v[140:143], v217
    v_add_u32 v217, 16, v213
    v_and_b32 v218, 15, v217
    v_xor_b32 v218, v218, v214
    v_lshlrev_b32 v217, 8, v217
    v_lshl_add_u32 v217, v218, 4, v217
    v_add_u32 v217, s30, v217
    ds_read_b128 v[144:147], v217
    v_add_u32 v217, 20, v213
    v_and_b32 v218, 15, v217
    v_xor_b32 v218, v218, v214
    v_lshlrev_b32 v217, 8, v217
    v_lshl_add_u32 v217, v218, 4, v217
    v_add_u32 v217, s30, v217
    ds_read_b128 v[148:151], v217
    v_add_u32 v217, 24, v213
    v_and_b32 v218, 15, v217
    v_xor_b32 v218, v218, v214
    v_lshlrev_b32 v217, 8, v217
    v_lshl_add_u32 v217, v218, 4, v217
    v_add_u32 v217, s30, v217
    ds_read_b128 v[152:155], v217
    v_add_u32 v217, 28, v213
    v_and_b32 v218, 15, v217
    v_xor_b32 v218, v218, v214
    v_lshlrev_b32 v217, 8, v217
    v_lshl_add_u32 v217, v218, 4, v217
    v_add_u32 v217, s30, v217
    ds_read_b128 v[156:159], v217
    s_waitcnt lgkmcnt(7)
    s_add_u32 s31, s39, 0
    buffer_store_dwordx4 v[128:131], v216, s[20:23], s31 offen sc1
    s_waitcnt lgkmcnt(6)
    s_add_u32 s31, s39, 32768
    buffer_store_dwordx4 v[132:135], v216, s[20:23], s31 offen sc1
    s_waitcnt lgkmcnt(5)
    s_add_u32 s31, s39, 65536
    buffer_store_dwordx4 v[136:139], v216, s[20:23], s31 offen sc1
    s_waitcnt lgkmcnt(4)
    s_add_u32 s31, s39, 98304
    buffer_store_dwordx4 v[140:143], v216, s[20:23], s31 offen sc1
    s_waitcnt lgkmcnt(3)
    s_add_u32 s31, s39, 131072
    buffer_store_dwordx4 v[144:147], v216, s[20:23], s31 offen sc1
    s_waitcnt lgkmcnt(2)
    s_add_u32 s31, s39, 163840
    buffer_store_dwordx4 v[148:151], v216, s[20:23], s31 offen sc1
    s_waitcnt lgkmcnt(1)
    s_add_u32 s31, s39, 196608
    buffer_store_dwordx4 v[152:155], v216, s[20:23], s31 offen sc1
    s_waitcnt lgkmcnt(0)
    s_add_u32 s31, s39, 229376
    buffer_store_dwordx4 v[156:159], v216, s[20:23], s31 offen sc1
    v_mul_f32 v64, v64, v210
    v_mul_f32 v65, v65, v210
    v_mul_f32 v66, v66, v210
    v_mul_f32 v67, v67, v210
    v_cvt_pk_bf16_f32 v192, v64, v65
    v_cvt_pk_bf16_f32 v193, v66, v67
    v_xor_b32 v217, 0, v215
    v_add_u32 v217, v217, v212
    ds_write_b64 v217, v[192:193]
    v_mul_f32 v68, v68, v210
    v_mul_f32 v69, v69, v210
    v_mul_f32 v70, v70, v210
    v_mul_f32 v71, v71, v210
    v_cvt_pk_bf16_f32 v194, v68, v69
    v_cvt_pk_bf16_f32 v195, v70, v71
    v_xor_b32 v217, 16, v215
    v_add_u32 v217, v217, v212
    ds_write_b64 v217, v[194:195]
    v_mul_f32 v72, v72, v210
    v_mul_f32 v73, v73, v210
    v_mul_f32 v74, v74, v210
    v_mul_f32 v75, v75, v210
    v_cvt_pk_bf16_f32 v196, v72, v73
    v_cvt_pk_bf16_f32 v197, v74, v75
    v_xor_b32 v217, 32, v215
    v_add_u32 v217, v217, v212
    ds_write_b64 v217, v[196:197]
    v_mul_f32 v76, v76, v210
    v_mul_f32 v77, v77, v210
    v_mul_f32 v78, v78, v210
    v_mul_f32 v79, v79, v210
    v_cvt_pk_bf16_f32 v198, v76, v77
    v_cvt_pk_bf16_f32 v199, v78, v79
    v_xor_b32 v217, 48, v215
    v_add_u32 v217, v217, v212
    ds_write_b64 v217, v[198:199]
    v_mul_f32 v80, v80, v210
    v_mul_f32 v81, v81, v210
    v_mul_f32 v82, v82, v210
    v_mul_f32 v83, v83, v210
    v_cvt_pk_bf16_f32 v200, v80, v81
    v_cvt_pk_bf16_f32 v201, v82, v83
    v_xor_b32 v217, 64, v215
    v_add_u32 v217, v217, v212
    ds_write_b64 v217, v[200:201]
    v_mul_f32 v84, v84, v210
    v_mul_f32 v85, v85, v210
    v_mul_f32 v86, v86, v210
    v_mul_f32 v87, v87, v210
    v_cvt_pk_bf16_f32 v202, v84, v85
    v_cvt_pk_bf16_f32 v203, v86, v87
    v_xor_b32 v217, 80, v215
    v_add_u32 v217, v217, v212
    ds_write_b64 v217, v[202:203]
    v_mul_f32 v88, v88, v210
    v_mul_f32 v89, v89, v210
    v_mul_f32 v90, v90, v210
    v_mul_f32 v91, v91, v210
    v_cvt_pk_bf16_f32 v204, v88, v89
    v_cvt_pk_bf16_f32 v205, v90, v91
    v_xor_b32 v217, 96, v215
    v_add_u32 v217, v217, v212
    ds_write_b64 v217, v[204:205]
    v_mul_f32 v92, v92, v210
    v_mul_f32 v93, v93, v210
    v_mul_f32 v94, v94, v210
    v_mul_f32 v95, v95, v210
    v_cvt_pk_bf16_f32 v206, v92, v93
    v_cvt_pk_bf16_f32 v207, v94, v95
    v_xor_b32 v217, 112, v215
    v_add_u32 v217, v217, v212
    ds_write_b64 v217, v[206:207]
    v_mul_f32 v96, v96, v210
    v_mul_f32 v97, v97, v210
    v_mul_f32 v98, v98, v210
    v_mul_f32 v99, v99, v210
    v_cvt_pk_bf16_f32 v192, v96, v97
    v_cvt_pk_bf16_f32 v193, v98, v99
    v_xor_b32 v217, 128, v215
    v_add_u32 v217, v217, v212
    ds_write_b64 v217, v[192:193]
    v_mul_f32 v100, v100, v210
    v_mul_f32 v101, v101, v210
    v_mul_f32 v102, v102, v210
    v_mul_f32 v103, v103, v210
    v_cvt_pk_bf16_f32 v194, v100, v101
    v_cvt_pk_bf16_f32 v195, v102, v103
    v_xor_b32 v217, 144, v215
    v_add_u32 v217, v217, v212
    ds_write_b64 v217, v[194:195]
    v_mul_f32 v104, v104, v210
    v_mul_f32 v105, v105, v210
    v_mul_f32 v106, v106, v210
    v_mul_f32 v107, v107, v210
    v_cvt_pk_bf16_f32 v196, v104, v105
    v_cvt_pk_bf16_f32 v197, v106, v107
    v_xor_b32 v217, 160, v215
    v_add_u32 v217, v217, v212
    ds_write_b64 v217, v[196:197]
    v_mul_f32 v108, v108, v210
    v_mul_f32 v109, v109, v210
    v_mul_f32 v110, v110, v210
    v_mul_f32 v111, v111, v210
    v_cvt_pk_bf16_f32 v198, v108, v109
    v_cvt_pk_bf16_f32 v199, v110, v111
    v_xor_b32 v217, 176, v215
    v_add_u32 v217, v217, v212
    ds_write_b64 v217, v[198:199]
    v_mul_f32 v112, v112, v210
    v_mul_f32 v113, v113, v210
    v_mul_f32 v114, v114, v210
    v_mul_f32 v115, v115, v210
    v_cvt_pk_bf16_f32 v200, v112, v113
    v_cvt_pk_bf16_f32 v201, v114, v115
    v_xor_b32 v217, 192, v215
    v_add_u32 v217, v217, v212
    ds_write_b64 v217, v[200:201]
    v_mul_f32 v116, v116, v210
    v_mul_f32 v117, v117, v210
    v_mul_f32 v118, v118, v210
    v_mul_f32 v119, v119, v210
    v_cvt_pk_bf16_f32 v202, v116, v117
    v_cvt_pk_bf16_f32 v203, v118, v119
    v_xor_b32 v217, 208, v215
    v_add_u32 v217, v217, v212
    ds_write_b64 v217, v[202:203]
    v_mul_f32 v120, v120, v210
    v_mul_f32 v121, v121, v210
    v_mul_f32 v122, v122, v210
    v_mul_f32 v123, v123, v210
    v_cvt_pk_bf16_f32 v204, v120, v121
    v_cvt_pk_bf16_f32 v205, v122, v123
    v_xor_b32 v217, 224, v215
    v_add_u32 v217, v217, v212
    ds_write_b64 v217, v[204:205]
    v_mul_f32 v124, v124, v210
    v_mul_f32 v125, v125, v210
    v_mul_f32 v126, v126, v210
    v_mul_f32 v127, v127, v210
    v_cvt_pk_bf16_f32 v206, v124, v125
    v_cvt_pk_bf16_f32 v207, v126, v127
    v_xor_b32 v217, 240, v215
    v_add_u32 v217, v217, v212
    ds_write_b64 v217, v[206:207]
    s_waitcnt lgkmcnt(0)
    v_add_u32 v217, 0, v213
    v_and_b32 v218, 15, v217
    v_xor_b32 v218, v218, v214
    v_lshlrev_b32 v217, 8, v217
    v_lshl_add_u32 v217, v218, 4, v217
    v_add_u32 v217, s30, v217
    ds_read_b128 v[128:131], v217
    v_add_u32 v217, 4, v213
    v_and_b32 v218, 15, v217
    v_xor_b32 v218, v218, v214
    v_lshlrev_b32 v217, 8, v217
    v_lshl_add_u32 v217, v218, 4, v217
    v_add_u32 v217, s30, v217
    ds_read_b128 v[132:135], v217
    v_add_u32 v217, 8, v213
    v_and_b32 v218, 15, v217
    v_xor_b32 v218, v218, v214
    v_lshlrev_b32 v217, 8, v217
    v_lshl_add_u32 v217, v218, 4, v217
    v_add_u32 v217, s30, v217
    ds_read_b128 v[136:139], v217
    v_add_u32 v217, 12, v213
    v_and_b32 v218, 15, v217
    v_xor_b32 v218, v218, v214
    v_lshlrev_b32 v217, 8, v217
    v_lshl_add_u32 v217, v218, 4, v217
    v_add_u32 v217, s30, v217
    ds_read_b128 v[140:143], v217
    v_add_u32 v217, 16, v213
    v_and_b32 v218, 15, v217
    v_xor_b32 v218, v218, v214
    v_lshlrev_b32 v217, 8, v217
    v_lshl_add_u32 v217, v218, 4, v217
    v_add_u32 v217, s30, v217
    ds_read_b128 v[144:147], v217
    v_add_u32 v217, 20, v213
    v_and_b32 v218, 15, v217
    v_xor_b32 v218, v218, v214
    v_lshlrev_b32 v217, 8, v217
    v_lshl_add_u32 v217, v218, 4, v217
    v_add_u32 v217, s30, v217
    ds_read_b128 v[148:151], v217
    v_add_u32 v217, 24, v213
    v_and_b32 v218, 15, v217
    v_xor_b32 v218, v218, v214
    v_lshlrev_b32 v217, 8, v217
    v_lshl_add_u32 v217, v218, 4, v217
    v_add_u32 v217, s30, v217
    ds_read_b128 v[152:155], v217
    v_add_u32 v217, 28, v213
    v_and_b32 v218, 15, v217
    v_xor_b32 v218, v218, v214
    v_lshlrev_b32 v217, 8, v217
    v_lshl_add_u32 v217, v218, 4, v217
    v_add_u32 v217, s30, v217
    ds_read_b128 v[156:159], v217
    s_waitcnt lgkmcnt(7)
    s_add_u32 s31, s39, 256
    buffer_store_dwordx4 v[128:131], v216, s[20:23], s31 offen sc1
    s_waitcnt lgkmcnt(6)
    s_add_u32 s31, s39, 33024
    buffer_store_dwordx4 v[132:135], v216, s[20:23], s31 offen sc1
    s_waitcnt lgkmcnt(5)
    s_add_u32 s31, s39, 65792
    buffer_store_dwordx4 v[136:139], v216, s[20:23], s31 offen sc1
    s_waitcnt lgkmcnt(4)
    s_add_u32 s31, s39, 98560
    buffer_store_dwordx4 v[140:143], v216, s[20:23], s31 offen sc1
    s_waitcnt lgkmcnt(3)
    s_add_u32 s31, s39, 131328
    buffer_store_dwordx4 v[144:147], v216, s[20:23], s31 offen sc1
    s_waitcnt lgkmcnt(2)
    s_add_u32 s31, s39, 164096
    buffer_store_dwordx4 v[148:151], v216, s[20:23], s31 offen sc1
    s_waitcnt lgkmcnt(1)
    s_add_u32 s31, s39, 196864
    buffer_store_dwordx4 v[152:155], v216, s[20:23], s31 offen sc1
    s_waitcnt lgkmcnt(0)
    s_add_u32 s31, s39, 229632
    buffer_store_dwordx4 v[156:159], v216, s[20:23], s31 offen sc1
L_attn_stored:
    s_cmp_lg_u32 s63, 1
    s_cbranch_scc1 L_attn_nopub
    s_waitcnt vmcnt(0)
    s_barrier
    s_cmp_lg_u32 s24, 0
    s_cbranch_scc1 L_attn_nopub
    s_and_b32 s30, s61, 31
    s_lshl_b32 s30, 1, s30
    v_mov_b32 v212, s30
    v_mov_b32 v211, 0
    s_lshr_b32 s31, s61, 5
    s_lshl_b32 s31, s31, 2
    s_mov_b64 s[46:47], exec
    s_mov_b64 exec, 1
    buffer_atomic_or v212, v211, s[16:19], s31 offen
    s_mov_b64 exec, s[46:47]
L_attn_nopub:
    s_cmp_lt_i32 s38, 0
    s_cbranch_scc1 L_attn_end
    s_mov_b32 s26, s38
    s_mov_b32 s36, s38
    s_mov_b32 s35, 0
    s_mov_b32 s37, 0
    s_mov_b32 s38, -1
    s_lshl_b32 s31, s24, 5
    v_add_u32 v222, s31, v254
    v_lshlrev_b32 v209, 2, v253
    v_sub_u32 v222, v222, v209
    v_mov_b32 v220, 0xf149f2ca
    v_mov_b32 v221, 0
    v_mov_b32 v255, 0
    v_accvgpr_mov_b32 a0, a96
    v_accvgpr_mov_b32 a1, a97
    v_accvgpr_mov_b32 a2, a98
    v_accvgpr_mov_b32 a3, a99
    v_accvgpr_mov_b32 a4, a100
    v_accvgpr_mov_b32 a5, a101
    v_accvgpr_mov_b32 a6, a102
    v_accvgpr_mov_b32 a7, a103
    v_accvgpr_mov_b32 a8, a104
    v_accvgpr_mov_b32 a9, a105
    v_accvgpr_mov_b32 a10, a106
    v_accvgpr_mov_b32 a11, a107
    v_accvgpr_mov_b32 a12, a108
    v_accvgpr_mov_b32 a13, a109
    v_accvgpr_mov_b32 a14, a110
    v_accvgpr_mov_b32 a15, a111
    v_accvgpr_mov_b32 a16, a112
    v_accvgpr_mov_b32 a17, a113
    v_accvgpr_mov_b32 a18, a114
    v_accvgpr_mov_b32 a19, a115
    v_accvgpr_mov_b32 a20, a116
    v_accvgpr_mov_b32 a21, a117
    v_accvgpr_mov_b32 a22, a118
    v_accvgpr_mov_b32 a23, a119
    v_accvgpr_mov_b32 a24, a120
    v_accvgpr_mov_b32 a25, a121
    v_accvgpr_mov_b32 a26, a122
    v_accvgpr_mov_b32 a27, a123
    v_accvgpr_mov_b32 a28, a124
    v_accvgpr_mov_b32 a29, a125
    v_accvgpr_mov_b32 a30, a126
    v_accvgpr_mov_b32 a31, a127
    v_accvgpr_mov_b32 a32, a128
    v_accvgpr_mov_b32 a33, a129
    v_accvgpr_mov_b32 a34, a130
    v_accvgpr_mov_b32 a35, a131
    v_accvgpr_mov_b32 a36, a132
    v_accvgpr_mov_b32 a37, a133
    v_accvgpr_mov_b32 a38, a134
    v_accvgpr_mov_b32 a39, a135
    v_accvgpr_mov_b32 a40, a136
    v_accvgpr_mov_b32 a41, a137
    v_accvgpr_mov_b32 a42, a138
    v_accvgpr_mov_b32 a43, a139
    v_accvgpr_mov_b32 a44, a140
    v_accvgpr_mov_b32 a45, a141
    v_accvgpr_mov_b32 a46, a142
    v_accvgpr_mov_b32 a47, a143
    v_accvgpr_mov_b32 a48, a144
    v_accvgpr_mov_b32 a49, a145
    v_accvgpr_mov_b32 a50, a146
    v_accvgpr_mov_b32 a51, a147
    v_accvgpr_mov_b32 a52, a148
    v_accvgpr_mov_b32 a53, a149
    v_accvgpr_mov_b32 a54, a150
    v_accvgpr_mov_b32 a55, a151
    v_accvgpr_mov_b32 a56, a152
    v_accvgpr_mov_b32 a57, a153
    v_accvgpr_mov_b32 a58, a154
    v_accvgpr_mov_b32 a59, a155
    v_accvgpr_mov_b32 a60, a156
    v_accvgpr_mov_b32 a61, a157
    v_accvgpr_mov_b32 a62, a158
    v_accvgpr_mov_b32 a63, a159
    v_mov_b32 v0, 0
    v_mov_b32 v1, 0
    v_mov_b32 v2, 0
    v_mov_b32 v3, 0
    v_mov_b32 v4, 0
    v_mov_b32 v5, 0
    v_mov_b32 v6, 0
    v_mov_b32 v7, 0
    v_mov_b32 v8, 0
    v_mov_b32 v9, 0
    v_mov_b32 v10, 0
    v_mov_b32 v11, 0
    v_mov_b32 v12, 0
    v_mov_b32 v13, 0
    v_mov_b32 v14, 0
    v_mov_b32 v15, 0
    v_mov_b32 v16, 0
    v_mov_b32 v17, 0
    v_mov_b32 v18, 0
    v_mov_b32 v19, 0
    v_mov_b32 v20, 0
    v_mov_b32 v21, 0
    v_mov_b32 v22, 0
    v_mov_b32 v23, 0
    v_mov_b32 v24, 0
    v_mov_b32 v25, 0
    v_mov_b32 v26, 0
    v_mov_b32 v27, 0
    v_mov_b32 v28, 0
    v_mov_b32 v29, 0
    v_mov_b32 v30, 0
    v_mov_b32 v31, 0
    v_mov_b32 v32, 0
    v_mov_b32 v33, 0
    v_mov_b32 v34, 0
    v_mov_b32 v35, 0
    v_mov_b32 v36, 0
    v_mov_b32 v37, 0
    v_mov_b32 v38, 0
    v_mov_b32 v39, 0
    v_mov_b32 v40, 0
    v_mov_b32 v41, 0
    v_mov_b32 v42, 0
    v_mov_b32 v43, 0
    v_mov_b32 v44, 0
    v_mov_b32 v45, 0
    v_mov_b32 v46, 0
    v_mov_b32 v47, 0
    v_mov_b32 v48, 0
    v_mov_b32 v49, 0
    v_mov_b32 v50, 0
    v_mov_b32 v51, 0
    v_mov_b32 v52, 0
    v_mov_b32 v53, 0
    v_mov_b32 v54, 0
    v_mov_b32 v55, 0
    v_mov_b32 v56, 0
    v_mov_b32 v57, 0
    v_mov_b32 v58, 0
    v_mov_b32 v59, 0
    v_mov_b32 v60, 0
    v_mov_b32 v61, 0
    v_mov_b32 v62, 0
    v_mov_b32 v63, 0
    v_mov_b32 v64, 0
    v_mov_b32 v65, 0
    v_mov_b32 v66, 0
    v_mov_b32 v67, 0
    v_mov_b32 v68, 0
    v_mov_b32 v69, 0
    v_mov_b32 v70, 0
    v_mov_b32 v71, 0
    v_mov_b32 v72, 0
    v_mov_b32 v73, 0
    v_mov_b32 v74, 0
    v_mov_b32 v75, 0
    v_mov_b32 v76, 0
    v_mov_b32 v77, 0
    v_mov_b32 v78, 0
    v_mov_b32 v79, 0
    v_mov_b32 v80, 0
    v_mov_b32 v81, 0
    v_mov_b32 v82, 0
    v_mov_b32 v83, 0
    v_mov_b32 v84, 0
    v_mov_b32 v85, 0
    v_mov_b32 v86, 0
    v_mov_b32 v87, 0
    v_mov_b32 v88, 0
    v_mov_b32 v89, 0
    v_mov_b32 v90, 0
    v_mov_b32 v91, 0
    v_mov_b32 v92, 0
    v_mov_b32 v93, 0
    v_mov_b32 v94, 0
    v_mov_b32 v95, 0
    v_mov_b32 v96, 0
    v_mov_b32 v97, 0
    v_mov_b32 v98, 0
    v_mov_b32 v99, 0
    v_mov_b32 v100, 0
    v_mov_b32 v101, 0
    v_mov_b32 v102, 0
    v_mov_b32 v103, 0
    v_mov_b32 v104, 0
    v_mov_b32 v105, 0
    v_mov_b32 v106, 0
    v_mov_b32 v107, 0
    v_mov_b32 v108, 0
    v_mov_b32 v109, 0
    v_mov_b32 v110, 0
    v_mov_b32 v111, 0
    v_mov_b32 v112, 0
    v_mov_b32 v113, 0
    v_mov_b32 v114, 0
    v_mov_b32 v115, 0
    v_mov_b32 v116, 0
    v_mov_b32 v117, 0
    v_mov_b32 v118, 0
    v_mov_b32 v119, 0
    v_mov_b32 v120, 0
    v_mov_b32 v121, 0
    v_mov_b32 v122, 0
    v_mov_b32 v123, 0
    v_mov_b32 v124, 0
    v_mov_b32 v125, 0
    v_mov_b32 v126, 0
    v_mov_b32 v127, 0
    s_waitcnt vmcnt(0)
    s_branch L_attn_go
L_attn_end:
    s_waitcnt vmcnt(0)
    s_barrier
    s_cmp_lg_u32 s24, 0
    s_cbranch_scc1 L_attn_sig
    s_load_dwordx2 s[46:47], s[0:1], 112
    s_waitcnt lgkmcnt(0)
    s_mov_b32 s88, s46
    s_and_b32 s89, s47, 0xffff
    s_mov_b32 s90, 0x100
    s_mov_b32 s91, 0x00020000
    v_mov_b32 v208, 1
    v_mov_b32 v209, 64
    s_mov_b64 exec, 1
    buffer_atomic_add v208, v209, s[88:91], 0 offen sc0
    s_waitcnt vmcnt(0)
    v_readfirstlane_b32 s46, v208
    s_nop 3
    s_cmp_lg_u32 s46, 479
    s_cbranch_scc1 L_attn_sig
    v_mov_b32 v208, 1
    v_mov_b32 v209, 160
    buffer_store_dword v208, v209, s[88:91], 0 offen sc1
L_attn_sig:
    s_endpgm
L_attn_rs1:
    v_max_f32 v208, v208, v220
    v_sub_f32 v209, v220, v208
    v_mul_f32 v209, s34, v209
    v_exp_f32 v209, v209
    v_mov_b32 v220, v208
    v_mul_f32 v255, s34, v208
    v_mul_f32 v221, v221, v209
    v_mul_f32 v0, v0, v209
    v_mul_f32 v1, v1, v209
    v_mul_f32 v2, v2, v209
    v_mul_f32 v3, v3, v209
    v_mul_f32 v4, v4, v209
    v_mul_f32 v5, v5, v209
    v_mul_f32 v6, v6, v209
    v_mul_f32 v7, v7, v209
    v_mul_f32 v8, v8, v209
    v_mul_f32 v9, v9, v209
    v_mul_f32 v10, v10, v209
    v_mul_f32 v11, v11, v209
    v_mul_f32 v12, v12, v209
    v_mul_f32 v13, v13, v209
    v_mul_f32 v14, v14, v209
    v_mul_f32 v15, v15, v209
    v_mul_f32 v16, v16, v209
    v_mul_f32 v17, v17, v209
    v_mul_f32 v18, v18, v209
    v_mul_f32 v19, v19, v209
    v_mul_f32 v20, v20, v209
    v_mul_f32 v21, v21, v209
    v_mul_f32 v22, v22, v209
    v_mul_f32 v23, v23, v209
    v_mul_f32 v24, v24, v209
    v_mul_f32 v25, v25, v209
    v_mul_f32 v26, v26, v209
    v_mul_f32 v27, v27, v209
    v_mul_f32 v28, v28, v209
    v_mul_f32 v29, v29, v209
    v_mul_f32 v30, v30, v209
    v_mul_f32 v31, v31, v209
    v_mul_f32 v32, v32, v209
    v_mul_f32 v33, v33, v209
    v_mul_f32 v34, v34, v209
    v_mul_f32 v35, v35, v209
    v_mul_f32 v36, v36, v209
    v_mul_f32 v37, v37, v209
    v_mul_f32 v38, v38, v209
    v_mul_f32 v39, v39, v209
    v_mul_f32 v40, v40, v209
    v_mul_f32 v41, v41, v209
    v_mul_f32 v42, v42, v209
    v_mul_f32 v43, v43, v209
    v_mul_f32 v44, v44, v209
    v_mul_f32 v45, v45, v209
    v_mul_f32 v46, v46, v209
    v_mul_f32 v47, v47, v209
    v_mul_f32 v48, v48, v209
    v_mul_f32 v49, v49, v209
    v_mul_f32 v50, v50, v209
    v_mul_f32 v51, v51, v209
    v_mul_f32 v52, v52, v209
    v_mul_f32 v53, v53, v209
    v_mul_f32 v54, v54, v209
    v_mul_f32 v55, v55, v209
    v_mul_f32 v56, v56, v209
    v_mul_f32 v57, v57, v209
    v_mul_f32 v58, v58, v209
    v_mul_f32 v59, v59, v209
    v_mul_f32 v60, v60, v209
    v_mul_f32 v61, v61, v209
    v_mul_f32 v62, v62, v209
    v_mul_f32 v63, v63, v209
    v_mul_f32 v64, v64, v209
    v_mul_f32 v65, v65, v209
    v_mul_f32 v66, v66, v209
    v_mul_f32 v67, v67, v209
    v_mul_f32 v68, v68, v209
    v_mul_f32 v69, v69, v209
    v_mul_f32 v70, v70, v209
    v_mul_f32 v71, v71, v209
    v_mul_f32 v72, v72, v209
    v_mul_f32 v73, v73, v209
    v_mul_f32 v74, v74, v209
    v_mul_f32 v75, v75, v209
    v_mul_f32 v76, v76, v209
    v_mul_f32 v77, v77, v209
    v_mul_f32 v78, v78, v209
    v_mul_f32 v79, v79, v209
    v_mul_f32 v80, v80, v209
    v_mul_f32 v81, v81, v209
    v_mul_f32 v82, v82, v209
    v_mul_f32 v83, v83, v209
    v_mul_f32 v84, v84, v209
    v_mul_f32 v85, v85, v209
    v_mul_f32 v86, v86, v209
    v_mul_f32 v87, v87, v209
    v_mul_f32 v88, v88, v209
    v_mul_f32 v89, v89, v209
    v_mul_f32 v90, v90, v209
    v_mul_f32 v91, v91, v209
    v_mul_f32 v92, v92, v209
    v_mul_f32 v93, v93, v209
    v_mul_f32 v94, v94, v209
    v_mul_f32 v95, v95, v209
    v_mul_f32 v96, v96, v209
    v_mul_f32 v97, v97, v209
    v_mul_f32 v98, v98, v209
    v_mul_f32 v99, v99, v209
    v_mul_f32 v100, v100, v209
    v_mul_f32 v101, v101, v209
    v_mul_f32 v102, v102, v209
    v_mul_f32 v103, v103, v209
    v_mul_f32 v104, v104, v209
    v_mul_f32 v105, v105, v209
    v_mul_f32 v106, v106, v209
    v_mul_f32 v107, v107, v209
    v_mul_f32 v108, v108, v209
    v_mul_f32 v109, v109, v209
    v_mul_f32 v110, v110, v209
    v_mul_f32 v111, v111, v209
    v_mul_f32 v112, v112, v209
    v_mul_f32 v113, v113, v209
    v_mul_f32 v114, v114, v209
    v_mul_f32 v115, v115, v209
    v_mul_f32 v116, v116, v209
    v_mul_f32 v117, v117, v209
    v_mul_f32 v118, v118, v209
    v_mul_f32 v119, v119, v209
    v_mul_f32 v120, v120, v209
    v_mul_f32 v121, v121, v209
    v_mul_f32 v122, v122, v209
    v_mul_f32 v123, v123, v209
    v_mul_f32 v124, v124, v209
    v_mul_f32 v125, v125, v209
    v_mul_f32 v126, v126, v209
    v_mul_f32 v127, v127, v209
    s_branch L_attn_rs1_ret
L_attn_rs2:
    v_max_f32 v208, v208, v220
    v_sub_f32 v209, v220, v208
    v_mul_f32 v209, s34, v209
    v_exp_f32 v209, v209
    v_mov_b32 v220, v208
    v_mul_f32 v255, s34, v208
    v_mul_f32 v221, v221, v209
    v_mul_f32 v0, v0, v209
    v_mul_f32 v1, v1, v209
    v_mul_f32 v2, v2, v209
    v_mul_f32 v3, v3, v209
    v_mul_f32 v4, v4, v209
    v_mul_f32 v5, v5, v209
    v_mul_f32 v6, v6, v209
    v_mul_f32 v7, v7, v209
    v_mul_f32 v8, v8, v209
    v_mul_f32 v9, v9, v209
    v_mul_f32 v10, v10, v209
    v_mul_f32 v11, v11, v209
    v_mul_f32 v12, v12, v209
    v_mul_f32 v13, v13, v209
    v_mul_f32 v14, v14, v209
    v_mul_f32 v15, v15, v209
    v_mul_f32 v16, v16, v209
    v_mul_f32 v17, v17, v209
    v_mul_f32 v18, v18, v209
    v_mul_f32 v19, v19, v209
    v_mul_f32 v20, v20, v209
    v_mul_f32 v21, v21, v209
    v_mul_f32 v22, v22, v209
    v_mul_f32 v23, v23, v209
    v_mul_f32 v24, v24, v209
    v_mul_f32 v25, v25, v209
    v_mul_f32 v26, v26, v209
    v_mul_f32 v27, v27, v209
    v_mul_f32 v28, v28, v209
    v_mul_f32 v29, v29, v209
    v_mul_f32 v30, v30, v209
    v_mul_f32 v31, v31, v209
    v_mul_f32 v32, v32, v209
    v_mul_f32 v33, v33, v209
    v_mul_f32 v34, v34, v209
    v_mul_f32 v35, v35, v209
    v_mul_f32 v36, v36, v209
    v_mul_f32 v37, v37, v209
    v_mul_f32 v38, v38, v209
    v_mul_f32 v39, v39, v209
    v_mul_f32 v40, v40, v209
    v_mul_f32 v41, v41, v209
    v_mul_f32 v42, v42, v209
    v_mul_f32 v43, v43, v209
    v_mul_f32 v44, v44, v209
    v_mul_f32 v45, v45, v209
    v_mul_f32 v46, v46, v209
    v_mul_f32 v47, v47, v209
    v_mul_f32 v48, v48, v209
    v_mul_f32 v49, v49, v209
    v_mul_f32 v50, v50, v209
    v_mul_f32 v51, v51, v209
    v_mul_f32 v52, v52, v209
    v_mul_f32 v53, v53, v209
    v_mul_f32 v54, v54, v209
    v_mul_f32 v55, v55, v209
    v_mul_f32 v56, v56, v209
    v_mul_f32 v57, v57, v209
    v_mul_f32 v58, v58, v209
    v_mul_f32 v59, v59, v209
    v_mul_f32 v60, v60, v209
    v_mul_f32 v61, v61, v209
    v_mul_f32 v62, v62, v209
    v_mul_f32 v63, v63, v209
    v_mul_f32 v64, v64, v209
    v_mul_f32 v65, v65, v209
    v_mul_f32 v66, v66, v209
    v_mul_f32 v67, v67, v209
    v_mul_f32 v68, v68, v209
    v_mul_f32 v69, v69, v209
    v_mul_f32 v70, v70, v209
    v_mul_f32 v71, v71, v209
    v_mul_f32 v72, v72, v209
    v_mul_f32 v73, v73, v209
    v_mul_f32 v74, v74, v209
    v_mul_f32 v75, v75, v209
    v_mul_f32 v76, v76, v209
    v_mul_f32 v77, v77, v209
    v_mul_f32 v78, v78, v209
    v_mul_f32 v79, v79, v209
    v_mul_f32 v80, v80, v209
    v_mul_f32 v81, v81, v209
    v_mul_f32 v82, v82, v209
    v_mul_f32 v83, v83, v209
    v_mul_f32 v84, v84, v209
    v_mul_f32 v85, v85, v209
    v_mul_f32 v86, v86, v209
    v_mul_f32 v87, v87, v209
    v_mul_f32 v88, v88, v209
    v_mul_f32 v89, v89, v209
    v_mul_f32 v90, v90, v209
    v_mul_f32 v91, v91, v209
    v_mul_f32 v92, v92, v209
    v_mul_f32 v93, v93, v209
    v_mul_f32 v94, v94, v209
    v_mul_f32 v95, v95, v209
    v_mul_f32 v96, v96, v209
    v_mul_f32 v97, v97, v209
    v_mul_f32 v98, v98, v209
    v_mul_f32 v99, v99, v209
    v_mul_f32 v100, v100, v209
    v_mul_f32 v101, v101, v209
    v_mul_f32 v102, v102, v209
    v_mul_f32 v103, v103, v209
    v_mul_f32 v104, v104, v209
    v_mul_f32 v105, v105, v209
    v_mul_f32 v106, v106, v209
    v_mul_f32 v107, v107, v209
    v_mul_f32 v108, v108, v209
    v_mul_f32 v109, v109, v209
    v_mul_f32 v110, v110, v209
    v_mul_f32 v111, v111, v209
    v_mul_f32 v112, v112, v209
    v_mul_f32 v113, v113, v209
    v_mul_f32 v114, v114, v209
    v_mul_f32 v115, v115, v209
    v_mul_f32 v116, v116, v209
    v_mul_f32 v117, v117, v209
    v_mul_f32 v118, v118, v209
    v_mul_f32 v119, v119, v209
    v_mul_f32 v120, v120, v209
    v_mul_f32 v121, v121, v209
    v_mul_f32 v122, v122, v209
    v_mul_f32 v123, v123, v209
    v_mul_f32 v124, v124, v209
    v_mul_f32 v125, v125, v209
    v_mul_f32 v126, v126, v209
    v_mul_f32 v127, v127, v209
    s_branch L_attn_rs2_ret
L_attn_rs3:
    v_max_f32 v208, v208, v220
    v_sub_f32 v209, v220, v208
    v_mul_f32 v209, s34, v209
    v_exp_f32 v209, v209
    v_mov_b32 v220, v208
    v_mul_f32 v255, s34, v208
    v_mul_f32 v221, v221, v209
    v_mul_f32 v0, v0, v209
    v_mul_f32 v1, v1, v209
    v_mul_f32 v2, v2, v209
    v_mul_f32 v3, v3, v209
    v_mul_f32 v4, v4, v209
    v_mul_f32 v5, v5, v209
    v_mul_f32 v6, v6, v209
    v_mul_f32 v7, v7, v209
    v_mul_f32 v8, v8, v209
    v_mul_f32 v9, v9, v209
    v_mul_f32 v10, v10, v209
    v_mul_f32 v11, v11, v209
    v_mul_f32 v12, v12, v209
    v_mul_f32 v13, v13, v209
    v_mul_f32 v14, v14, v209
    v_mul_f32 v15, v15, v209
    v_mul_f32 v16, v16, v209
    v_mul_f32 v17, v17, v209
    v_mul_f32 v18, v18, v209
    v_mul_f32 v19, v19, v209
    v_mul_f32 v20, v20, v209
    v_mul_f32 v21, v21, v209
    v_mul_f32 v22, v22, v209
    v_mul_f32 v23, v23, v209
    v_mul_f32 v24, v24, v209
    v_mul_f32 v25, v25, v209
    v_mul_f32 v26, v26, v209
    v_mul_f32 v27, v27, v209
    v_mul_f32 v28, v28, v209
    v_mul_f32 v29, v29, v209
    v_mul_f32 v30, v30, v209
    v_mul_f32 v31, v31, v209
    v_mul_f32 v32, v32, v209
    v_mul_f32 v33, v33, v209
    v_mul_f32 v34, v34, v209
    v_mul_f32 v35, v35, v209
    v_mul_f32 v36, v36, v209
    v_mul_f32 v37, v37, v209
    v_mul_f32 v38, v38, v209
    v_mul_f32 v39, v39, v209
    v_mul_f32 v40, v40, v209
    v_mul_f32 v41, v41, v209
    v_mul_f32 v42, v42, v209
    v_mul_f32 v43, v43, v209
    v_mul_f32 v44, v44, v209
    v_mul_f32 v45, v45, v209
    v_mul_f32 v46, v46, v209
    v_mul_f32 v47, v47, v209
    v_mul_f32 v48, v48, v209
    v_mul_f32 v49, v49, v209
    v_mul_f32 v50, v50, v209
    v_mul_f32 v51, v51, v209
    v_mul_f32 v52, v52, v209
    v_mul_f32 v53, v53, v209
    v_mul_f32 v54, v54, v209
    v_mul_f32 v55, v55, v209
    v_mul_f32 v56, v56, v209
    v_mul_f32 v57, v57, v209
    v_mul_f32 v58, v58, v209
    v_mul_f32 v59, v59, v209
    v_mul_f32 v60, v60, v209
    v_mul_f32 v61, v61, v209
    v_mul_f32 v62, v62, v209
    v_mul_f32 v63, v63, v209
    v_mul_f32 v64, v64, v209
    v_mul_f32 v65, v65, v209
    v_mul_f32 v66, v66, v209
    v_mul_f32 v67, v67, v209
    v_mul_f32 v68, v68, v209
    v_mul_f32 v69, v69, v209
    v_mul_f32 v70, v70, v209
    v_mul_f32 v71, v71, v209
    v_mul_f32 v72, v72, v209
    v_mul_f32 v73, v73, v209
    v_mul_f32 v74, v74, v209
    v_mul_f32 v75, v75, v209
    v_mul_f32 v76, v76, v209
    v_mul_f32 v77, v77, v209
    v_mul_f32 v78, v78, v209
    v_mul_f32 v79, v79, v209
    v_mul_f32 v80, v80, v209
    v_mul_f32 v81, v81, v209
    v_mul_f32 v82, v82, v209
    v_mul_f32 v83, v83, v209
    v_mul_f32 v84, v84, v209
    v_mul_f32 v85, v85, v209
    v_mul_f32 v86, v86, v209
    v_mul_f32 v87, v87, v209
    v_mul_f32 v88, v88, v209
    v_mul_f32 v89, v89, v209
    v_mul_f32 v90, v90, v209
    v_mul_f32 v91, v91, v209
    v_mul_f32 v92, v92, v209
    v_mul_f32 v93, v93, v209
    v_mul_f32 v94, v94, v209
    v_mul_f32 v95, v95, v209
    v_mul_f32 v96, v96, v209
    v_mul_f32 v97, v97, v209
    v_mul_f32 v98, v98, v209
    v_mul_f32 v99, v99, v209
    v_mul_f32 v100, v100, v209
    v_mul_f32 v101, v101, v209
    v_mul_f32 v102, v102, v209
    v_mul_f32 v103, v103, v209
    v_mul_f32 v104, v104, v209
    v_mul_f32 v105, v105, v209
    v_mul_f32 v106, v106, v209
    v_mul_f32 v107, v107, v209
    v_mul_f32 v108, v108, v209
    v_mul_f32 v109, v109, v209
    v_mul_f32 v110, v110, v209
    v_mul_f32 v111, v111, v209
    v_mul_f32 v112, v112, v209
    v_mul_f32 v113, v113, v209
    v_mul_f32 v114, v114, v209
    v_mul_f32 v115, v115, v209
    v_mul_f32 v116, v116, v209
    v_mul_f32 v117, v117, v209
    v_mul_f32 v118, v118, v209
    v_mul_f32 v119, v119, v209
    v_mul_f32 v120, v120, v209
    v_mul_f32 v121, v121, v209
    v_mul_f32 v122, v122, v209
    v_mul_f32 v123, v123, v209
    v_mul_f32 v124, v124, v209
    v_mul_f32 v125, v125, v209
    v_mul_f32 v126, v126, v209
    v_mul_f32 v127, v127, v209
    s_branch L_attn_rs3_ret
L_attn_rs4:
    v_max_f32 v208, v208, v220
    v_sub_f32 v209, v220, v208
    v_mul_f32 v209, s34, v209
    v_exp_f32 v209, v209
    v_mov_b32 v220, v208
    v_mul_f32 v255, s34, v208
    v_mul_f32 v221, v221, v209
    v_mul_f32 v0, v0, v209
    v_mul_f32 v1, v1, v209
    v_mul_f32 v2, v2, v209
    v_mul_f32 v3, v3, v209
    v_mul_f32 v4, v4, v209
    v_mul_f32 v5, v5, v209
    v_mul_f32 v6, v6, v209
    v_mul_f32 v7, v7, v209
    v_mul_f32 v8, v8, v209
    v_mul_f32 v9, v9, v209
    v_mul_f32 v10, v10, v209
    v_mul_f32 v11, v11, v209
    v_mul_f32 v12, v12, v209
    v_mul_f32 v13, v13, v209
    v_mul_f32 v14, v14, v209
    v_mul_f32 v15, v15, v209
    v_mul_f32 v16, v16, v209
    v_mul_f32 v17, v17, v209
    v_mul_f32 v18, v18, v209
    v_mul_f32 v19, v19, v209
    v_mul_f32 v20, v20, v209
    v_mul_f32 v21, v21, v209
    v_mul_f32 v22, v22, v209
    v_mul_f32 v23, v23, v209
    v_mul_f32 v24, v24, v209
    v_mul_f32 v25, v25, v209
    v_mul_f32 v26, v26, v209
    v_mul_f32 v27, v27, v209
    v_mul_f32 v28, v28, v209
    v_mul_f32 v29, v29, v209
    v_mul_f32 v30, v30, v209
    v_mul_f32 v31, v31, v209
    v_mul_f32 v32, v32, v209
    v_mul_f32 v33, v33, v209
    v_mul_f32 v34, v34, v209
    v_mul_f32 v35, v35, v209
    v_mul_f32 v36, v36, v209
    v_mul_f32 v37, v37, v209
    v_mul_f32 v38, v38, v209
    v_mul_f32 v39, v39, v209
    v_mul_f32 v40, v40, v209
    v_mul_f32 v41, v41, v209
    v_mul_f32 v42, v42, v209
    v_mul_f32 v43, v43, v209
    v_mul_f32 v44, v44, v209
    v_mul_f32 v45, v45, v209
    v_mul_f32 v46, v46, v209
    v_mul_f32 v47, v47, v209
    v_mul_f32 v48, v48, v209
    v_mul_f32 v49, v49, v209
    v_mul_f32 v50, v50, v209
    v_mul_f32 v51, v51, v209
    v_mul_f32 v52, v52, v209
    v_mul_f32 v53, v53, v209
    v_mul_f32 v54, v54, v209
    v_mul_f32 v55, v55, v209
    v_mul_f32 v56, v56, v209
    v_mul_f32 v57, v57, v209
    v_mul_f32 v58, v58, v209
    v_mul_f32 v59, v59, v209
    v_mul_f32 v60, v60, v209
    v_mul_f32 v61, v61, v209
    v_mul_f32 v62, v62, v209
    v_mul_f32 v63, v63, v209
    v_mul_f32 v64, v64, v209
    v_mul_f32 v65, v65, v209
    v_mul_f32 v66, v66, v209
    v_mul_f32 v67, v67, v209
    v_mul_f32 v68, v68, v209
    v_mul_f32 v69, v69, v209
    v_mul_f32 v70, v70, v209
    v_mul_f32 v71, v71, v209
    v_mul_f32 v72, v72, v209
    v_mul_f32 v73, v73, v209
    v_mul_f32 v74, v74, v209
    v_mul_f32 v75, v75, v209
    v_mul_f32 v76, v76, v209
    v_mul_f32 v77, v77, v209
    v_mul_f32 v78, v78, v209
    v_mul_f32 v79, v79, v209
    v_mul_f32 v80, v80, v209
    v_mul_f32 v81, v81, v209
    v_mul_f32 v82, v82, v209
    v_mul_f32 v83, v83, v209
    v_mul_f32 v84, v84, v209
    v_mul_f32 v85, v85, v209
    v_mul_f32 v86, v86, v209
    v_mul_f32 v87, v87, v209
    v_mul_f32 v88, v88, v209
    v_mul_f32 v89, v89, v209
    v_mul_f32 v90, v90, v209
    v_mul_f32 v91, v91, v209
    v_mul_f32 v92, v92, v209
    v_mul_f32 v93, v93, v209
    v_mul_f32 v94, v94, v209
    v_mul_f32 v95, v95, v209
    v_mul_f32 v96, v96, v209
    v_mul_f32 v97, v97, v209
    v_mul_f32 v98, v98, v209
    v_mul_f32 v99, v99, v209
    v_mul_f32 v100, v100, v209
    v_mul_f32 v101, v101, v209
    v_mul_f32 v102, v102, v209
    v_mul_f32 v103, v103, v209
    v_mul_f32 v104, v104, v209
    v_mul_f32 v105, v105, v209
    v_mul_f32 v106, v106, v209
    v_mul_f32 v107, v107, v209
    v_mul_f32 v108, v108, v209
    v_mul_f32 v109, v109, v209
    v_mul_f32 v110, v110, v209
    v_mul_f32 v111, v111, v209
    v_mul_f32 v112, v112, v209
    v_mul_f32 v113, v113, v209
    v_mul_f32 v114, v114, v209
    v_mul_f32 v115, v115, v209
    v_mul_f32 v116, v116, v209
    v_mul_f32 v117, v117, v209
    v_mul_f32 v118, v118, v209
    v_mul_f32 v119, v119, v209
    v_mul_f32 v120, v120, v209
    v_mul_f32 v121, v121, v209
    v_mul_f32 v122, v122, v209
    v_mul_f32 v123, v123, v209
    v_mul_f32 v124, v124, v209
    v_mul_f32 v125, v125, v209
    v_mul_f32 v126, v126, v209
    v_mul_f32 v127, v127, v209
    s_branch L_attn_rs4_ret
L_attn_conv:
    s_sub_u32 s2, s2, 256
    s_cmp_ge_u32 s2, 224
    s_cbranch_scc1 L_attn_final
    s_cmp_ge_u32 s2, 224
    s_cbranch_scc1 L_conv_end
    s_load_dwordx2 s[46:47], s[0:1], 32
    s_load_dwordx2 s[48:49], s[0:1], 40
    s_load_dwordx2 s[50:51], s[0:1], 120
    v_lshrrev_b32 v1, 6, v0
    s_nop 0
    v_readfirstlane_b32 s20, v1
    s_lshl_b32 s21, s2, 1
    s_waitcnt lgkmcnt(0)
    s_mov_b32 s12, s46
    s_and_b32 s13, s47, 0xffff
    s_mov_b32 s14, 0x1c0000
    s_mov_b32 s15, 0x00020000
    s_add_u32 s52, s50, 0xae00000
    s_addc_u32 s53, s51, 0
    s_mov_b32 s4, s52
    s_and_b32 s5, s53, 0xffff
    s_mov_b32 s6, 0x1c0000
    s_mov_b32 s7, 0x00020000
    s_add_u32 s50, s50, 0xa000000
    s_addc_u32 s51, s51, 0
    s_mov_b32 s16, s50
    s_and_b32 s17, s51, 0xffff
    s_mov_b32 s18, 0x1c0000
    s_mov_b32 s19, 0x00020000
    v_lshlrev_b32 v140, 4, v0
    s_lshl_b32 s22, s2, 2
    s_load_dword s56, s[48:49], s22
    v_subrev_u32 v141, 16, v140
    v_max_i32 v141, 0, v141
    s_add_u32 s23, s21, 0
    s_lshl_b32 s23, s23, 12
    buffer_load_dwordx4 v[144:147], v140, s[12:15], s23 offen
    buffer_load_dwordx4 v[152:155], v140, s[4:7], s23 offen
    buffer_load_dwordx4 v[160:163], v141, s[4:7], s23 offen
    s_add_u32 s23, s21, 1
    s_lshl_b32 s23, s23, 12
    buffer_load_dwordx4 v[148:151], v140, s[12:15], s23 offen
    buffer_load_dwordx4 v[156:159], v140, s[4:7], s23 offen
    buffer_load_dwordx4 v[164:167], v141, s[4:7], s23 offen
    v_mov_b32 v168, 0
    v_mov_b32 v169, 0
    v_mov_b32 v170, 0
    v_mov_b32 v171, 0
    v_add_u32 v142, 57344, v140
    ds_write_b128 v140, v[168:171] offset:0
    ds_write_b128 v140, v[168:171] offset:4096
    ds_write_b128 v140, v[168:171] offset:8192
    ds_write_b128 v140, v[168:171] offset:12288
    ds_write_b128 v140, v[168:171] offset:16384
    ds_write_b128 v140, v[168:171] offset:20480
    ds_write_b128 v140, v[168:171] offset:24576
    ds_write_b128 v140, v[168:171] offset:28672
    ds_write_b128 v140, v[168:171] offset:32768
    ds_write_b128 v140, v[168:171] offset:36864
    ds_write_b128 v140, v[168:171] offset:40960
    ds_write_b128 v140, v[168:171] offset:45056
    ds_write_b128 v140, v[168:171] offset:49152
    ds_write_b128 v140, v[168:171] offset:53248
    ds_write_b128 v142, v[168:171] offset:0
    ds_write_b128 v142, v[168:171] offset:4096
    ds_write_b128 v142, v[168:171] offset:8192
    ds_write_b128 v142, v[168:171] offset:12288
    ds_write_b128 v142, v[168:171] offset:16384
    ds_write_b128 v142, v[168:171] offset:20480
    ds_write_b128 v142, v[168:171] offset:24576
    ds_write_b128 v142, v[168:171] offset:28672
    ds_write_b128 v142, v[168:171] offset:32768
    ds_write_b128 v142, v[168:171] offset:36864
    ds_write_b128 v142, v[168:171] offset:40960
    ds_write_b128 v142, v[168:171] offset:45056
    ds_write_b128 v142, v[168:171] offset:49152
    ds_write_b128 v142, v[168:171] offset:53248
    s_waitcnt vmcnt(0) lgkmcnt(0)
    s_lshl_b32 s32, s56, 16
    s_and_b32 s33, s56, 0xffff0000
    s_barrier
    v_cmp_eq_u32 vcc, 0, v0
    s_nop 1
    v_cndmask_b32 v160, v160, 0, vcc
    v_cndmask_b32 v161, v161, 0, vcc
    v_cndmask_b32 v162, v162, 0, vcc
    v_cndmask_b32 v163, v163, 0, vcc
    v_cndmask_b32 v164, v164, 0, vcc
    v_cndmask_b32 v165, v165, 0, vcc
    v_cndmask_b32 v166, v166, 0, vcc
    v_cndmask_b32 v167, v167, 0, vcc
    v_add_u32 v142, 56576, v140
    ds_write_b128 v140, v[144:147] offset:48128
    ds_write_b128 v142, v[148:151] offset:48128
    v_lshlrev_b32 v104, 3, v0
    v_sub_u32 v104, 2048, v104
    v_lshrrev_b32 v105, 8, v104
    v_lshlrev_b32 v104, 1, v104
    v_lshl_add_u32 v104, v105, 4, v104
    v_add_u32 v105, 56576, v104
    s_mov_b32 s57, 0xffff
    v_bfi_b32 v112, s57, v152, v163
    v_bfi_b32 v113, s57, v163, v162
    v_bfi_b32 v114, s57, v162, v161
    v_bfi_b32 v115, s57, v161, v160
    ds_write_b128 v104, v[112:115] offset:0
    v_alignbit_b32 v116, v152, v152, 16
    v_alignbit_b32 v117, v163, v163, 16
    v_alignbit_b32 v118, v162, v162, 16
    v_alignbit_b32 v119, v161, v161, 16
    ds_write_b128 v104, v[116:119] offset:5952
    v_bfi_b32 v120, s57, v153, v152
    v_bfi_b32 v121, s57, v152, v163
    v_bfi_b32 v122, s57, v163, v162
    v_bfi_b32 v123, s57, v162, v161
    ds_write_b128 v104, v[120:123] offset:11904
    v_alignbit_b32 v124, v153, v153, 16
    v_alignbit_b32 v125, v152, v152, 16
    v_alignbit_b32 v126, v163, v163, 16
    v_alignbit_b32 v127, v162, v162, 16
    ds_write_b128 v104, v[124:127] offset:17856
    v_bfi_b32 v112, s57, v154, v153
    v_bfi_b32 v113, s57, v153, v152
    v_bfi_b32 v114, s57, v152, v163
    v_bfi_b32 v115, s57, v163, v162
    ds_write_b128 v104, v[112:115] offset:23808
    v_alignbit_b32 v116, v154, v154, 16
    v_alignbit_b32 v117, v153, v153, 16
    v_alignbit_b32 v118, v152, v152, 16
    v_alignbit_b32 v119, v163, v163, 16
    ds_write_b128 v104, v[116:119] offset:29760
    v_bfi_b32 v120, s57, v155, v154
    v_bfi_b32 v121, s57, v154, v153
    v_bfi_b32 v122, s57, v153, v152
    v_bfi_b32 v123, s57, v152, v163
    ds_write_b128 v104, v[120:123] offset:35712
    v_alignbit_b32 v124, v155, v155, 16
    v_alignbit_b32 v125, v154, v154, 16
    v_alignbit_b32 v126, v153, v153, 16
    v_alignbit_b32 v127, v152, v152, 16
    ds_write_b128 v104, v[124:127] offset:41664
    v_bfi_b32 v112, s57, v156, v167
    v_bfi_b32 v113, s57, v167, v166
    v_bfi_b32 v114, s57, v166, v165
    v_bfi_b32 v115, s57, v165, v164
    ds_write_b128 v105, v[112:115] offset:0
    v_alignbit_b32 v116, v156, v156, 16
    v_alignbit_b32 v117, v167, v167, 16
    v_alignbit_b32 v118, v166, v166, 16
    v_alignbit_b32 v119, v165, v165, 16
    ds_write_b128 v105, v[116:119] offset:5952
    v_bfi_b32 v120, s57, v157, v156
    v_bfi_b32 v121, s57, v156, v167
    v_bfi_b32 v122, s57, v167, v166
    v_bfi_b32 v123, s57, v166, v165
    ds_write_b128 v105, v[120:123] offset:11904
    v_alignbit_b32 v124, v157, v157, 16
    v_alignbit_b32 v125, v156, v156, 16
    v_alignbit_b32 v126, v167, v167, 16
    v_alignbit_b32 v127, v166, v166, 16
    ds_write_b128 v105, v[124:127] offset:17856
    v_bfi_b32 v112, s57, v158, v157
    v_bfi_b32 v113, s57, v157, v156
    v_bfi_b32 v114, s57, v156, v167
    v_bfi_b32 v115, s57, v167, v166
    ds_write_b128 v105, v[112:115] offset:23808
    v_alignbit_b32 v116, v158, v158, 16
    v_alignbit_b32 v117, v157, v157, 16
    v_alignbit_b32 v118, v156, v156, 16
    v_alignbit_b32 v119, v167, v167, 16
    ds_write_b128 v105, v[116:119] offset:29760
    v_bfi_b32 v120, s57, v159, v158
    v_bfi_b32 v121, s57, v158, v157
    v_bfi_b32 v122, s57, v157, v156
    v_bfi_b32 v123, s57, v156, v167
    ds_write_b128 v105, v[120:123] offset:35712
    v_alignbit_b32 v124, v159, v159, 16
    v_alignbit_b32 v125, v158, v158, 16
    v_alignbit_b32 v126, v157, v157, 16
    v_alignbit_b32 v127, v156, v156, 16
    ds_write_b128 v105, v[124:127] offset:41664
    v_cmp_eq_u32 vcc, 255, v0
    s_and_saveexec_b64 s[58:59], vcc
    v_mov_b32 v107, 0
    v_mov_b32 v108, 56576
    v_bfi_b32 v112, s57, v168, v155
    v_bfi_b32 v113, s57, v155, v154
    v_bfi_b32 v114, s57, v154, v153
    v_bfi_b32 v115, s57, v153, v152
    ds_write_b128 v107, v[112:115] offset:0
    v_alignbit_b32 v116, v168, v168, 16
    v_alignbit_b32 v117, v155, v155, 16
    v_alignbit_b32 v118, v154, v154, 16
    v_alignbit_b32 v119, v153, v153, 16
    ds_write_b128 v107, v[116:119] offset:5952
    v_bfi_b32 v120, s57, v169, v168
    v_bfi_b32 v121, s57, v168, v155
    v_bfi_b32 v122, s57, v155, v154
    v_bfi_b32 v123, s57, v154, v153
    ds_write_b128 v107, v[120:123] offset:11904
    v_alignbit_b32 v124, v169, v169, 16
    v_alignbit_b32 v125, v168, v168, 16
    v_alignbit_b32 v126, v155, v155, 16
    v_alignbit_b32 v127, v154, v154, 16
    ds_write_b128 v107, v[124:127] offset:17856
    v_bfi_b32 v112, s57, v170, v169
    v_bfi_b32 v113, s57, v169, v168
    v_bfi_b32 v114, s57, v168, v155
    v_bfi_b32 v115, s57, v155, v154
    ds_write_b128 v107, v[112:115] offset:23808
    v_alignbit_b32 v116, v170, v170, 16
    v_alignbit_b32 v117, v169, v169, 16
    v_alignbit_b32 v118, v168, v168, 16
    v_alignbit_b32 v119, v155, v155, 16
    ds_write_b128 v107, v[116:119] offset:29760
    v_bfi_b32 v120, s57, v171, v170
    v_bfi_b32 v121, s57, v170, v169
    v_bfi_b32 v122, s57, v169, v168
    v_bfi_b32 v123, s57, v168, v155
    ds_write_b128 v107, v[120:123] offset:35712
    v_bfi_b32 v124, s57, v168, v159
    v_bfi_b32 v125, s57, v159, v158
    v_bfi_b32 v126, s57, v158, v157
    v_bfi_b32 v127, s57, v157, v156
    ds_write_b128 v108, v[124:127] offset:0
    v_alignbit_b32 v112, v168, v168, 16
    v_alignbit_b32 v113, v159, v159, 16
    v_alignbit_b32 v114, v158, v158, 16
    v_alignbit_b32 v115, v157, v157, 16
    ds_write_b128 v108, v[112:115] offset:5952
    v_bfi_b32 v116, s57, v169, v168
    v_bfi_b32 v117, s57, v168, v159
    v_bfi_b32 v118, s57, v159, v158
    v_bfi_b32 v119, s57, v158, v157
    ds_write_b128 v108, v[116:119] offset:11904
    v_alignbit_b32 v120, v169, v169, 16
    v_alignbit_b32 v121, v168, v168, 16
    v_alignbit_b32 v122, v159, v159, 16
    v_alignbit_b32 v123, v158, v158, 16
    ds_write_b128 v108, v[120:123] offset:17856
    v_bfi_b32 v124, s57, v170, v169
    v_bfi_b32 v125, s57, v169, v168
    v_bfi_b32 v126, s57, v168, v159
    v_bfi_b32 v127, s57, v159, v158
    ds_write_b128 v108, v[124:127] offset:23808
    v_alignbit_b32 v112, v170, v170, 16
    v_alignbit_b32 v113, v169, v169, 16
    v_alignbit_b32 v114, v168, v168, 16
    v_alignbit_b32 v115, v159, v159, 16
    ds_write_b128 v108, v[112:115] offset:29760
    v_bfi_b32 v116, s57, v171, v170
    v_bfi_b32 v117, s57, v170, v169
    v_bfi_b32 v118, s57, v169, v168
    v_bfi_b32 v119, s57, v168, v159
    ds_write_b128 v108, v[116:119] offset:35712
    s_mov_b64 exec, s[58:59]
    s_waitcnt lgkmcnt(0)
    s_barrier
    v_and_b32 v128, 63, v0
    v_lshrrev_b32 v129, 5, v128
    v_and_b32 v130, 31, v128
    s_lshr_b32 s22, s20, 1
    s_mul_i32 s22, s22, 56576
    s_and_b32 s23, s20, 1
    v_add_u32 v131, v130, v129
    v_lshlrev_b32 v131, 4, v131
    v_add_u32 v131, s22, v131
    v_lshrrev_b32 v132, 2, v130
    v_mul_u32_u24 v132, 5952, v132
    v_and_b32 v104, 3, v130
    s_lshl_b32 s34, s23, 2
    v_add_u32 v104, s34, v104
    v_mul_u32_u24 v105, 528, v104
    v_sub_u32 v132, v132, v105
    v_lshl_add_u32 v132, v129, 4, v132
    s_add_u32 s35, s22, 3696
    v_add_u32 v132, s35, v132
    v_lshlrev_b32 v133, 8, v104
    v_lshl_add_u32 v133, v129, 5, v133
    v_lshrrev_b32 v105, 2, v130
    v_add_u32 v133, v133, v105
    v_lshlrev_b32 v133, 1, v133
    v_add_u32 v133, s22, v133
    v_mov_b32 v16, 0
    v_mov_b32 v17, 0
    v_mov_b32 v18, 0
    v_mov_b32 v19, 0
    v_mov_b32 v20, 0
    v_mov_b32 v21, 0
    v_mov_b32 v22, 0
    v_mov_b32 v23, 0
    v_mov_b32 v24, 0
    v_mov_b32 v25, 0
    v_mov_b32 v26, 0
    v_mov_b32 v27, 0
    v_mov_b32 v28, 0
    v_mov_b32 v29, 0
    v_mov_b32 v30, 0
    v_mov_b32 v31, 0
    ds_read_b128 v[32:35], v131 offset:47616
    ds_read_b128 v[64:67], v132 offset:0
    ds_read_b128 v[36:39], v131 offset:47648
    ds_read_b128 v[68:71], v132 offset:32
    ds_read_b128 v[40:43], v131 offset:47680
    ds_read_b128 v[72:75], v132 offset:64
    ds_read_b128 v[44:47], v131 offset:47712
    ds_read_b128 v[76:79], v132 offset:96
    ds_read_b128 v[48:51], v131 offset:47744
    ds_read_b128 v[80:83], v132 offset:128
    ds_read_b128 v[52:55], v131 offset:47776
    ds_read_b128 v[84:87], v132 offset:160
    s_lshl_b32 s34, s23, 2
    s_add_u32 s34, s34, 4
L_conv_loop:
    s_waitcnt lgkmcnt(10)
    v_mfma_f32_32x32x16_bf16 v[16:31], v[32:35], v[64:67], v[16:31]
    ds_read_b128 v[56:59], v131 offset:47808
    ds_read_b128 v[88:91], v132 offset:192
    s_waitcnt lgkmcnt(10)
    v_mfma_f32_32x32x16_bf16 v[16:31], v[36:39], v[68:71], v[16:31]
    ds_read_b128 v[60:63], v131 offset:47840
    ds_read_b128 v[92:95], v132 offset:224
    s_waitcnt lgkmcnt(10)
    v_mfma_f32_32x32x16_bf16 v[16:31], v[40:43], v[72:75], v[16:31]
    ds_read_b128 v[32:35], v131 offset:47872
    ds_read_b128 v[64:67], v132 offset:256
    s_waitcnt lgkmcnt(10)
    v_mfma_f32_32x32x16_bf16 v[16:31], v[44:47], v[76:79], v[16:31]
    ds_read_b128 v[36:39], v131 offset:47904
    ds_read_b128 v[68:71], v132 offset:288
    s_waitcnt lgkmcnt(10)
    v_mfma_f32_32x32x16_bf16 v[16:31], v[48:51], v[80:83], v[16:31]
    ds_read_b128 v[40:43], v131 offset:47936
    ds_read_b128 v[72:75], v132 offset:320
    s_waitcnt lgkmcnt(10)
    v_mfma_f32_32x32x16_bf16 v[16:31], v[52:55], v[84:87], v[16:31]
    ds_read_b128 v[44:47], v131 offset:47968
    ds_read_b128 v[76:79], v132 offset:352
    s_waitcnt lgkmcnt(10)
    v_mfma_f32_32x32x16_bf16 v[16:31], v[56:59], v[88:91], v[16:31]
    ds_read_b128 v[48:51], v131 offset:48000
    ds_read_b128 v[80:83], v132 offset:384
    s_waitcnt lgkmcnt(10)
    v_mfma_f32_32x32x16_bf16 v[16:31], v[60:63], v[92:95], v[16:31]
    ds_read_b128 v[52:55], v131 offset:48032
    ds_read_b128 v[84:87], v132 offset:416
    s_waitcnt lgkmcnt(10)
    v_mfma_f32_32x32x16_bf16 v[16:31], v[32:35], v[64:67], v[16:31]
    ds_read_b128 v[56:59], v131 offset:48064
    ds_read_b128 v[88:91], v132 offset:448
    s_waitcnt lgkmcnt(10)
    v_mfma_f32_32x32x16_bf16 v[16:31], v[36:39], v[68:71], v[16:31]
    ds_read_b128 v[60:63], v131 offset:48096
    ds_read_b128 v[92:95], v132 offset:480
    s_waitcnt lgkmcnt(10)
    v_mfma_f32_32x32x16_bf16 v[16:31], v[40:43], v[72:75], v[16:31]
    ds_read_b128 v[32:35], v131 offset:48128
    ds_read_b128 v[64:67], v132 offset:528
    s_waitcnt lgkmcnt(10)
    v_mfma_f32_32x32x16_bf16 v[16:31], v[44:47], v[76:79], v[16:31]
    ds_read_b128 v[36:39], v131 offset:48160
    ds_read_b128 v[68:71], v132 offset:560
    s_waitcnt lgkmcnt(10)
    v_mfma_f32_32x32x16_bf16 v[16:31], v[48:51], v[80:83], v[16:31]
    ds_read_b128 v[40:43], v131 offset:48192
    ds_read_b128 v[72:75], v132 offset:592
    s_waitcnt lgkmcnt(10)
    v_mfma_f32_32x32x16_bf16 v[16:31], v[52:55], v[84:87], v[16:31]
    ds_read_b128 v[44:47], v131 offset:48224
    ds_read_b128 v[76:79], v132 offset:624
    s_waitcnt lgkmcnt(10)
    v_mfma_f32_32x32x16_bf16 v[16:31], v[56:59], v[88:91], v[16:31]
    ds_read_b128 v[48:51], v131 offset:48256
    ds_read_b128 v[80:83], v132 offset:656
    s_waitcnt lgkmcnt(10)
    v_mfma_f32_32x32x16_bf16 v[16:31], v[60:63], v[92:95], v[16:31]
    ds_read_b128 v[52:55], v131 offset:48288
    ds_read_b128 v[84:87], v132 offset:688
    v_add_u32 v131, 512, v131
    v_add_u32 v132, 528, v132
    s_sub_u32 s34, s34, 1
    s_cmp_lg_u32 s34, 0
    s_cbranch_scc1 L_conv_loop
    s_waitcnt lgkmcnt(0)
    v_mfma_f32_32x32x16_bf16 v[16:31], v[32:35], v[64:67], v[16:31]
L_conv_join:
    s_nop 15
    v_cvt_pk_bf16_f32 v106, v16, v17
    ds_write_b16 v133, v106 offset:52256
    ds_write_b16_d16_hi v133, v106 offset:52272
    v_cvt_pk_bf16_f32 v106, v18, v19
    ds_write_b16 v133, v106 offset:52288
    ds_write_b16_d16_hi v133, v106 offset:52304
    v_cvt_pk_bf16_f32 v106, v20, v21
    ds_write_b16 v133, v106 offset:52384
    ds_write_b16_d16_hi v133, v106 offset:52400
    v_cvt_pk_bf16_f32 v106, v22, v23
    ds_write_b16 v133, v106 offset:52416
    ds_write_b16_d16_hi v133, v106 offset:52432
    v_cvt_pk_bf16_f32 v106, v24, v25
    ds_write_b16 v133, v106 offset:52512
    ds_write_b16_d16_hi v133, v106 offset:52528
    v_cvt_pk_bf16_f32 v106, v26, v27
    ds_write_b16 v133, v106 offset:52544
    ds_write_b16_d16_hi v133, v106 offset:52560
    v_cvt_pk_bf16_f32 v106, v28, v29
    ds_write_b16 v133, v106 offset:52640
    ds_write_b16_d16_hi v133, v106 offset:52656
    v_cvt_pk_bf16_f32 v106, v30, v31
    ds_write_b16 v133, v106 offset:52672
    ds_write_b16_d16_hi v133, v106 offset:52688
    s_waitcnt lgkmcnt(0)
    s_barrier
    ds_read_b128 v[64:67], v140 offset:52256
    ds_read_b128 v[72:75], v142 offset:52256
    s_waitcnt lgkmcnt(0)
    v_lshlrev_b32 v104, 16, v152
    v_and_b32 v105, 0xffff0000, v152
    v_mul_f32 v104, s32, v104
    v_mul_f32 v105, s32, v105
    v_cvt_pk_bf16_f32 v106, v104, v105
    v_lshlrev_b32 v104, 16, v106
    v_and_b32 v105, 0xffff0000, v106
    v_lshlrev_b32 v107, 16, v64
    v_and_b32 v108, 0xffff0000, v64
    v_add_f32 v104, v104, v107
    v_add_f32 v105, v105, v108
    v_cvt_pk_bf16_f32 v64, v104, v105
    v_lshlrev_b32 v104, 16, v153
    v_and_b32 v105, 0xffff0000, v153
    v_mul_f32 v104, s32, v104
    v_mul_f32 v105, s32, v105
    v_cvt_pk_bf16_f32 v106, v104, v105
    v_lshlrev_b32 v104, 16, v106
    v_and_b32 v105, 0xffff0000, v106
    v_lshlrev_b32 v107, 16, v65
    v_and_b32 v108, 0xffff0000, v65
    v_add_f32 v104, v104, v107
    v_add_f32 v105, v105, v108
    v_cvt_pk_bf16_f32 v65, v104, v105
    v_lshlrev_b32 v104, 16, v154
    v_and_b32 v105, 0xffff0000, v154
    v_mul_f32 v104, s32, v104
    v_mul_f32 v105, s32, v105
    v_cvt_pk_bf16_f32 v106, v104, v105
    v_lshlrev_b32 v104, 16, v106
    v_and_b32 v105, 0xffff0000, v106
    v_lshlrev_b32 v107, 16, v66
    v_and_b32 v108, 0xffff0000, v66
    v_add_f32 v104, v104, v107
    v_add_f32 v105, v105, v108
    v_cvt_pk_bf16_f32 v66, v104, v105
    v_lshlrev_b32 v104, 16, v155
    v_and_b32 v105, 0xffff0000, v155
    v_mul_f32 v104, s32, v104
    v_mul_f32 v105, s32, v105
    v_cvt_pk_bf16_f32 v106, v104, v105
    v_lshlrev_b32 v104, 16, v106
    v_and_b32 v105, 0xffff0000, v106
    v_lshlrev_b32 v107, 16, v67
    v_and_b32 v108, 0xffff0000, v67
    v_add_f32 v104, v104, v107
    v_add_f32 v105, v105, v108
    v_cvt_pk_bf16_f32 v67, v104, v105
    s_add_u32 s22, s21, 0
    s_lshl_b32 s22, s22, 12
    buffer_store_dwordx4 v[64:67], v140, s[16:19], s22 offen sc1
    v_lshlrev_b32 v104, 16, v156
    v_and_b32 v105, 0xffff0000, v156
    v_mul_f32 v104, s33, v104
    v_mul_f32 v105, s33, v105
    v_cvt_pk_bf16_f32 v106, v104, v105
    v_lshlrev_b32 v104, 16, v106
    v_and_b32 v105, 0xffff0000, v106
    v_lshlrev_b32 v107, 16, v72
    v_and_b32 v108, 0xffff0000, v72
    v_add_f32 v104, v104, v107
    v_add_f32 v105, v105, v108
    v_cvt_pk_bf16_f32 v72, v104, v105
    v_lshlrev_b32 v104, 16, v157
    v_and_b32 v105, 0xffff0000, v157
    v_mul_f32 v104, s33, v104
    v_mul_f32 v105, s33, v105
    v_cvt_pk_bf16_f32 v106, v104, v105
    v_lshlrev_b32 v104, 16, v106
    v_and_b32 v105, 0xffff0000, v106
    v_lshlrev_b32 v107, 16, v73
    v_and_b32 v108, 0xffff0000, v73
    v_add_f32 v104, v104, v107
    v_add_f32 v105, v105, v108
    v_cvt_pk_bf16_f32 v73, v104, v105
    v_lshlrev_b32 v104, 16, v158
    v_and_b32 v105, 0xffff0000, v158
    v_mul_f32 v104, s33, v104
    v_mul_f32 v105, s33, v105
    v_cvt_pk_bf16_f32 v106, v104, v105
    v_lshlrev_b32 v104, 16, v106
    v_and_b32 v105, 0xffff0000, v106
    v_lshlrev_b32 v107, 16, v74
    v_and_b32 v108, 0xffff0000, v74
    v_add_f32 v104, v104, v107
    v_add_f32 v105, v105, v108
    v_cvt_pk_bf16_f32 v74, v104, v105
    v_lshlrev_b32 v104, 16, v159
    v_and_b32 v105, 0xffff0000, v159
    v_mul_f32 v104, s33, v104
    v_mul_f32 v105, s33, v105
    v_cvt_pk_bf16_f32 v106, v104, v105
    v_lshlrev_b32 v104, 16, v106
    v_and_b32 v105, 0xffff0000, v106
    v_lshlrev_b32 v107, 16, v75
    v_and_b32 v108, 0xffff0000, v75
    v_add_f32 v104, v104, v107
    v_add_f32 v105, v105, v108
    v_cvt_pk_bf16_f32 v75, v104, v105
    s_add_u32 s22, s21, 1
    s_lshl_b32 s22, s22, 12
    buffer_store_dwordx4 v[72:75], v140, s[16:19], s22 offen sc1
    s_waitcnt vmcnt(0)
    s_barrier
    s_cmp_lg_u32 s20, 0
    s_cbranch_scc1 L_conv_sig
    s_load_dwordx2 s[46:47], s[0:1], 112
    s_waitcnt lgkmcnt(0)
    s_mov_b32 s88, s46
    s_and_b32 s89, s47, 0xffff
    s_mov_b32 s90, 0x100
    s_mov_b32 s91, 0x00020000
    v_mov_b32 v100, 1
    v_mov_b32 v101, 64
    s_mov_b64 exec, 1
    buffer_atomic_add v100, v101, s[88:91], 0 offen sc0
    s_waitcnt vmcnt(0)
    v_readfirstlane_b32 s46, v100
    s_nop 3
    s_cmp_lg_u32 s46, 479
    s_cbranch_scc1 L_conv_sig
    v_mov_b32 v100, 1
    v_mov_b32 v101, 160
    buffer_store_dword v100, v101, s[88:91], 0 offen sc1
L_conv_sig:
L_conv_end:
    s_endpgm
L_attn_final:
    s_sub_u32 s2, s2, 224
    s_cmp_ge_u32 s2, 224
    s_cbranch_scc1 L_fin_end
    s_load_dwordx2 s[40:41], s[0:1], 0
    s_load_dwordx2 s[44:45], s[0:1], 120
    s_load_dwordx2 s[46:47], s[0:1], 104
    s_load_dwordx2 s[50:51], s[0:1], 88
    v_lshrrev_b32 v1, 6, v0
    s_nop 0
    v_readfirstlane_b32 s24, v1
    s_and_b32 s27, s2, 7
    s_lshr_b32 s28, s2, 3
    s_and_b32 s25, s28, 3
    s_lshl_b32 s25, s25, 3
    s_add_u32 s25, s25, s27
    s_lshl_b32 s25, s25, 6
    s_lshr_b32 s26, s28, 2
    s_lshl_b32 s26, s26, 6
    s_waitcnt lgkmcnt(0)
    s_mov_b32 s4, s40
    s_and_b32 s5, s41, 0xffff
    s_mov_b32 s6, 0x1c0000
    s_mov_b32 s7, 0x00020000
    s_add_u32 s48, s44, 0x3000000
    s_addc_u32 s49, s45, 0
    s_mov_b32 s12, s48
    s_and_b32 s13, s49, 0xffff
    s_mov_b32 s14, 0x1000000
    s_mov_b32 s15, 0x00020000
    s_add_u32 s48, s44, 0xa000000
    s_addc_u32 s49, s45, 0
    s_mov_b32 s16, s48
    s_and_b32 s17, s49, 0xffff
    s_mov_b32 s18, 0x1c0000
    s_mov_b32 s19, 0x00020000
    s_add_u32 s48, s44, 0xac00000
    s_addc_u32 s49, s45, 0
    s_mov_b32 s8, s48
    s_and_b32 s9, s49, 0xffff
    s_mov_b32 s10, 0x4000
    s_mov_b32 s11, 0x00020000
    s_mov_b32 s20, s46
    s_and_b32 s21, s47, 0xffff
    s_mov_b32 s22, 0x1c0000
    s_mov_b32 s23, 0x00020000
    s_mov_b32 s36, s50
    s_and_b32 s37, s51, 0xffff
    s_mov_b32 s38, 0x380000
    s_mov_b32 s39, 0x00020000
    v_and_b32 v80, 63, v0
    v_lshrrev_b32 v81, 5, v80
    v_and_b32 v82, 31, v80
    v_lshrrev_b32 v84, 4, v80
    v_and_b32 v85, 15, v80
    s_lshl_b32 s27, s24, 4
    s_add_u32 s27, s27, s25
    v_add_u32 v86, 0, v84
    v_xor_b32 v87, v86, v85
    v_add_u32 v86, s27, v86
    v_lshlrev_b32 v86, 13, v86
    v_lshl_add_u32 v64, v87, 4, v86
    v_add_u32 v86, 4, v84
    v_xor_b32 v87, v86, v85
    v_add_u32 v86, s27, v86
    v_lshlrev_b32 v86, 13, v86
    v_lshl_add_u32 v65, v87, 4, v86
    v_add_u32 v86, 8, v84
    v_xor_b32 v87, v86, v85
    v_add_u32 v86, s27, v86
    v_lshlrev_b32 v86, 13, v86
    v_lshl_add_u32 v66, v87, 4, v86
    v_add_u32 v86, 12, v84
    v_xor_b32 v87, v86, v85
    v_add_u32 v86, s27, v86
    v_lshlrev_b32 v86, 13, v86
    v_lshl_add_u32 v67, v87, 4, v86
    v_lshrrev_b32 v84, 3, v80
    s_lshl_b32 s27, s24, 5
    v_add_u32 v84, s27, v84
    v_mul_u32_u24 v84, 896, v84
    v_bfe_u32 v85, v80, 4, 1
    v_lshlrev_b32 v85, 2, v85
    v_and_b32 v86, 7, v80
    v_xor_b32 v85, v85, v86
    v_lshl_add_u32 v84, v85, 4, v84
    s_lshl_b32 s27, s26, 1
    v_add_u32 v84, s27, v84
    v_add_u32 v68, 0, v84
    v_add_u32 v69, 7168, v84
    v_add_u32 v70, 14336, v84
    v_add_u32 v71, 21504, v84
    s_lshl_b32 s27, s24, 1
    v_add_u32 v84, s27, v81
    v_and_b32 v85, 15, v82
    v_xor_b32 v84, v84, v85
    v_lshlrev_b32 v86, 8, v82
    v_lshl_add_u32 v72, v84, 4, v86
    v_xor_b32 v84, 8, v84
    v_lshl_add_u32 v73, v84, 4, v86
    v_add_u32 v74, 0x10000, v72
    v_add_u32 v75, 0x10000, v73
    v_bfe_u32 v84, v80, 2, 2
    v_lshl_add_u32 v84, v81, 3, v84
    s_lshl_b32 s27, s24, 4
    v_add_u32 v84, s27, v84
    v_lshlrev_b32 v84, 7, v84
    v_bfe_u32 v85, v80, 3, 1
    v_lshl_add_u32 v84, v85, 6, v84
    v_bfe_u32 v85, v80, 4, 1
    v_lshl_add_u32 v84, v85, 5, v84
    v_and_b32 v85, 3, v80
    v_lshl_add_u32 v84, v85, 3, v84
    v_add_u32 v76, 0x4000, v84
    v_xor_b32 v77, 64, v76
    v_add_u32 v78, 0x10000, v76
    v_add_u32 v79, 0x10000, v77
    s_lshl_b32 s31, s24, 12
    s_mov_b32 s29, 0
    s_mov_b32 s30, 0
    s_add_u32 m0, s31, 16384
    s_nop 0
    buffer_load_dwordx4 v68, s[36:39], s30 offen lds
    s_add_u32 m0, s31, 17408
    s_nop 0
    buffer_load_dwordx4 v69, s[36:39], s30 offen lds
    s_add_u32 m0, s31, 18432
    s_nop 0
    buffer_load_dwordx4 v70, s[36:39], s30 offen lds
    s_add_u32 m0, s31, 19456
    s_nop 0
    buffer_load_dwordx4 v71, s[36:39], s30 offen lds
    s_add_u32 s30, s30, 114688
    s_add_u32 m0, s31, 49152
    s_nop 0
    buffer_load_dwordx4 v68, s[36:39], s30 offen lds
    s_add_u32 m0, s31, 50176
    s_nop 0
    buffer_load_dwordx4 v69, s[36:39], s30 offen lds
    s_add_u32 m0, s31, 51200
    s_nop 0
    buffer_load_dwordx4 v70, s[36:39], s30 offen lds
    s_add_u32 m0, s31, 52224
    s_nop 0
    buffer_load_dwordx4 v71, s[36:39], s30 offen lds
    s_add_u32 s30, s30, 114688
    s_add_u32 m0, s31, 81920
    s_nop 0
    buffer_load_dwordx4 v68, s[36:39], s30 offen lds
    s_add_u32 m0, s31, 82944
    s_nop 0
    buffer_load_dwordx4 v69, s[36:39], s30 offen lds
    s_add_u32 m0, s31, 83968
    s_nop 0
    buffer_load_dwordx4 v70, s[36:39], s30 offen lds
    s_add_u32 m0, s31, 84992
    s_nop 0
    buffer_load_dwordx4 v71, s[36:39], s30 offen lds
    s_add_u32 s30, s30, 114688
    s_lshr_b32 s27, s24, 1
    s_lshl_b32 s27, s27, 5
    s_add_u32 s27, s27, s26
    s_and_b32 s28, s24, 1
    s_lshl_b32 s28, s28, 5
    s_add_u32 s28, s28, s25
    v_add_u32 v84, s28, v82
    v_lshlrev_b32 v89, 3, v84
    buffer_load_dwordx2 v[120:121], v89, s[8:11], 0 offen
    v_mul_u32_u24 v85, 896, v84
    v_lshl_add_u32 v85, v81, 3, v85
    s_lshl_b32 s54, s27, 1
    buffer_load_dwordx2 v[96:97], v85, s[4:7], s54 offen offset:0
    buffer_load_dwordx2 v[98:99], v85, s[4:7], s54 offen offset:16
    buffer_load_dwordx2 v[100:101], v85, s[4:7], s54 offen offset:32
    buffer_load_dwordx2 v[102:103], v85, s[4:7], s54 offen offset:48
    v_lshlrev_b32 v86, 1, v84
    v_lshl_add_u32 v86, v81, 14, v86
    s_lshl_b32 s55, s27, 12
    s_cmp_lg_u32 s24, 0
    s_cbranch_scc1 L_fin_poll_done
    s_load_dwordx2 s[46:47], s[0:1], 112
    s_waitcnt lgkmcnt(0)
    s_mov_b32 s88, s46
    s_and_b32 s89, s47, 0xffff
    s_mov_b32 s90, 0x100
    s_mov_b32 s91, 0x00020000
    v_mov_b32 v91, 160
L_fin_poll:
    buffer_load_dword v90, v91, s[88:91], 0 offen sc1
    s_waitcnt vmcnt(0)
    v_readfirstlane_b32 s46, v90
    s_nop 3
    s_cmp_ge_u32 s46, 1
    s_cbranch_scc1 L_fin_poll_done
    s_sleep 16
    s_branch L_fin_poll
L_fin_poll_done:
    s_barrier
    s_add_u32 m0, s31, 0
    s_nop 0
    buffer_load_dwordx4 v64, s[12:15], s29 offen sc1 lds
    s_add_u32 m0, s31, 1024
    s_nop 0
    buffer_load_dwordx4 v65, s[12:15], s29 offen sc1 lds
    s_add_u32 m0, s31, 2048
    s_nop 0
    buffer_load_dwordx4 v66, s[12:15], s29 offen sc1 lds
    s_add_u32 m0, s31, 3072
    s_nop 0
    buffer_load_dwordx4 v67, s[12:15], s29 offen sc1 lds
    s_add_u32 s29, s29, 256
    s_add_u32 m0, s31, 32768
    s_nop 0
    buffer_load_dwordx4 v64, s[12:15], s29 offen sc1 lds
    s_add_u32 m0, s31, 33792
    s_nop 0
    buffer_load_dwordx4 v65, s[12:15], s29 offen sc1 lds
    s_add_u32 m0, s31, 34816
    s_nop 0
    buffer_load_dwordx4 v66, s[12:15], s29 offen sc1 lds
    s_add_u32 m0, s31, 35840
    s_nop 0
    buffer_load_dwordx4 v67, s[12:15], s29 offen sc1 lds
    s_add_u32 s29, s29, 256
    s_add_u32 m0, s31, 65536
    s_nop 0
    buffer_load_dwordx4 v64, s[12:15], s29 offen sc1 lds
    s_add_u32 m0, s31, 66560
    s_nop 0
    buffer_load_dwordx4 v65, s[12:15], s29 offen sc1 lds
    s_add_u32 m0, s31, 67584
    s_nop 0
    buffer_load_dwordx4 v66, s[12:15], s29 offen sc1 lds
    s_add_u32 m0, s31, 68608
    s_nop 0
    buffer_load_dwordx4 v67, s[12:15], s29 offen sc1 lds
    s_add_u32 s29, s29, 256
    s_add_u32 s53, s55, 0
    buffer_load_ushort v104, v86, s[16:19], s53 offen sc1
    s_add_u32 s53, s55, 4096
    buffer_load_ushort v105, v86, s[16:19], s53 offen sc1
    s_add_u32 s53, s55, 8192
    buffer_load_ushort v106, v86, s[16:19], s53 offen sc1
    s_add_u32 s53, s55, 12288
    buffer_load_ushort v107, v86, s[16:19], s53 offen sc1
    s_add_u32 s53, s55, 32768
    buffer_load_ushort v108, v86, s[16:19], s53 offen sc1
    s_add_u32 s53, s55, 36864
    buffer_load_ushort v109, v86, s[16:19], s53 offen sc1
    s_add_u32 s53, s55, 40960
    buffer_load_ushort v110, v86, s[16:19], s53 offen sc1
    s_add_u32 s53, s55, 45056
    buffer_load_ushort v111, v86, s[16:19], s53 offen sc1
    s_add_u32 s53, s55, 65536
    buffer_load_ushort v112, v86, s[16:19], s53 offen sc1
    s_add_u32 s53, s55, 69632
    buffer_load_ushort v113, v86, s[16:19], s53 offen sc1
    s_add_u32 s53, s55, 73728
    buffer_load_ushort v114, v86, s[16:19], s53 offen sc1
    s_add_u32 s53, s55, 77824
    buffer_load_ushort v115, v86, s[16:19], s53 offen sc1
    s_add_u32 s53, s55, 98304
    buffer_load_ushort v116, v86, s[16:19], s53 offen sc1
    s_add_u32 s53, s55, 102400
    buffer_load_ushort v117, v86, s[16:19], s53 offen sc1
    s_add_u32 s53, s55, 106496
    buffer_load_ushort v118, v86, s[16:19], s53 offen sc1
    s_add_u32 s53, s55, 110592
    buffer_load_ushort v119, v86, s[16:19], s53 offen sc1
    s_waitcnt vmcnt(24)
    s_barrier
    ds_read_b128 v[0:3], v72 offset:0
    ds_read_b128 v[4:7], v72 offset:8192
    ds_read_b64_tr_b16 v[16:17], v76 offset:0
    ds_read_b64_tr_b16 v[18:19], v76 offset:512
    ds_read_b64_tr_b16 v[20:21], v77 offset:0
    ds_read_b64_tr_b16 v[22:23], v77 offset:512
    ds_read_b128 v[8:11], v73 offset:0
    ds_read_b128 v[12:15], v73 offset:8192
    ds_read_b64_tr_b16 v[24:25], v76 offset:8192
    ds_read_b64_tr_b16 v[26:27], v76 offset:8704
    ds_read_b64_tr_b16 v[28:29], v77 offset:8192
    ds_read_b64_tr_b16 v[30:31], v77 offset:8704
    s_waitcnt lgkmcnt(0)
    s_waitcnt vmcnt(20)
    s_barrier
    v_mfma_f32_32x32x16_bf16 a[0:15], v[16:19], v[0:3], 0
    ds_read_b128 v[32:35], v72 offset:32768
    ds_read_b128 v[36:39], v72 offset:40960
    ds_read_b64_tr_b16 v[48:49], v76 offset:32768
    ds_read_b64_tr_b16 v[50:51], v76 offset:33280
    v_mfma_f32_32x32x16_bf16 a[16:31], v[16:19], v[4:7], 0
    ds_read_b64_tr_b16 v[52:53], v77 offset:32768
    ds_read_b64_tr_b16 v[54:55], v77 offset:33280
    ds_read_b128 v[40:43], v73 offset:32768
    ds_read_b128 v[44:47], v73 offset:40960
    v_mfma_f32_32x32x16_bf16 a[32:47], v[20:23], v[0:3], 0
    ds_read_b64_tr_b16 v[56:57], v76 offset:40960
    ds_read_b64_tr_b16 v[58:59], v76 offset:41472
    ds_read_b64_tr_b16 v[60:61], v77 offset:40960
    ds_read_b64_tr_b16 v[62:63], v77 offset:41472
    s_add_u32 m0, s31, 98304
    v_mfma_f32_32x32x16_bf16 a[48:63], v[20:23], v[4:7], 0
    buffer_load_dwordx4 v64, s[12:15], s29 offen sc1 lds
    s_add_u32 m0, s31, 99328
    s_nop 0
    buffer_load_dwordx4 v65, s[12:15], s29 offen sc1 lds
    s_add_u32 m0, s31, 100352
    v_mfma_f32_32x32x16_bf16 a[0:15], v[24:27], v[8:11], a[0:15]
    buffer_load_dwordx4 v66, s[12:15], s29 offen sc1 lds
    s_add_u32 m0, s31, 101376
    s_nop 0
    buffer_load_dwordx4 v67, s[12:15], s29 offen sc1 lds
    v_mfma_f32_32x32x16_bf16 a[16:31], v[24:27], v[12:15], a[16:31]
    s_add_u32 s29, s29, 256
    s_add_u32 m0, s31, 114688
    s_nop 0
    buffer_load_dwordx4 v68, s[36:39], s30 offen lds
    s_add_u32 m0, s31, 115712
    v_mfma_f32_32x32x16_bf16 a[32:47], v[28:31], v[8:11], a[32:47]
    buffer_load_dwordx4 v69, s[36:39], s30 offen lds
    s_add_u32 m0, s31, 116736
    s_nop 0
    buffer_load_dwordx4 v70, s[36:39], s30 offen lds
    s_add_u32 m0, s31, 117760
    v_mfma_f32_32x32x16_bf16 a[48:63], v[28:31], v[12:15], a[48:63]
    buffer_load_dwordx4 v71, s[36:39], s30 offen lds
    s_add_u32 s30, s30, 114688
    s_waitcnt lgkmcnt(0)
    s_waitcnt vmcnt(24)
    s_barrier
    v_mfma_f32_32x32x16_bf16 a[0:15], v[48:51], v[32:35], a[0:15]
    ds_read_b128 v[0:3], v74 offset:0
    ds_read_b128 v[4:7], v74 offset:8192
    ds_read_b64_tr_b16 v[16:17], v78 offset:0
    ds_read_b64_tr_b16 v[18:19], v78 offset:512
    v_mfma_f32_32x32x16_bf16 a[16:31], v[48:51], v[36:39], a[16:31]
    ds_read_b64_tr_b16 v[20:21], v79 offset:0
    ds_read_b64_tr_b16 v[22:23], v79 offset:512
    ds_read_b128 v[8:11], v75 offset:0
    ds_read_b128 v[12:15], v75 offset:8192
    v_mfma_f32_32x32x16_bf16 a[32:47], v[52:55], v[32:35], a[32:47]
    ds_read_b64_tr_b16 v[24:25], v78 offset:8192
    ds_read_b64_tr_b16 v[26:27], v78 offset:8704
    ds_read_b64_tr_b16 v[28:29], v79 offset:8192
    ds_read_b64_tr_b16 v[30:31], v79 offset:8704
    s_add_u32 m0, s31, 0
    v_mfma_f32_32x32x16_bf16 a[48:63], v[52:55], v[36:39], a[48:63]
    buffer_load_dwordx4 v64, s[12:15], s29 offen sc1 lds
    s_add_u32 m0, s31, 1024
    s_nop 0
    buffer_load_dwordx4 v65, s[12:15], s29 offen sc1 lds
    s_add_u32 m0, s31, 2048
    v_mfma_f32_32x32x16_bf16 a[0:15], v[56:59], v[40:43], a[0:15]
    buffer_load_dwordx4 v66, s[12:15], s29 offen sc1 lds
    s_add_u32 m0, s31, 3072
    s_nop 0
    buffer_load_dwordx4 v67, s[12:15], s29 offen sc1 lds
    v_mfma_f32_32x32x16_bf16 a[16:31], v[56:59], v[44:47], a[16:31]
    s_add_u32 s29, s29, 256
    s_add_u32 m0, s31, 16384
    s_nop 0
    buffer_load_dwordx4 v68, s[36:39], s30 offen lds
    s_add_u32 m0, s31, 17408
    v_mfma_f32_32x32x16_bf16 a[32:47], v[60:63], v[40:43], a[32:47]
    buffer_load_dwordx4 v69, s[36:39], s30 offen lds
    s_add_u32 m0, s31, 18432
    s_nop 0
    buffer_load_dwordx4 v70, s[36:39], s30 offen lds
    s_add_u32 m0, s31, 19456
    v_mfma_f32_32x32x16_bf16 a[48:63], v[60:63], v[44:47], a[48:63]
    buffer_load_dwordx4 v71, s[36:39], s30 offen lds
    s_add_u32 s30, s30, 114688
    s_waitcnt lgkmcnt(0)
    s_waitcnt vmcnt(8)
    s_barrier
    v_mfma_f32_32x32x16_bf16 a[0:15], v[16:19], v[0:3], a[0:15]
    ds_read_b128 v[32:35], v74 offset:32768
    ds_read_b128 v[36:39], v74 offset:40960
    ds_read_b64_tr_b16 v[48:49], v78 offset:32768
    ds_read_b64_tr_b16 v[50:51], v78 offset:33280
    v_mfma_f32_32x32x16_bf16 a[16:31], v[16:19], v[4:7], a[16:31]
    ds_read_b64_tr_b16 v[52:53], v79 offset:32768
    ds_read_b64_tr_b16 v[54:55], v79 offset:33280
    ds_read_b128 v[40:43], v75 offset:32768
    ds_read_b128 v[44:47], v75 offset:40960
    v_mfma_f32_32x32x16_bf16 a[32:47], v[20:23], v[0:3], a[32:47]
    ds_read_b64_tr_b16 v[56:57], v78 offset:40960
    ds_read_b64_tr_b16 v[58:59], v78 offset:41472
    ds_read_b64_tr_b16 v[60:61], v79 offset:40960
    ds_read_b64_tr_b16 v[62:63], v79 offset:41472
    s_add_u32 m0, s31, 32768
    v_mfma_f32_32x32x16_bf16 a[48:63], v[20:23], v[4:7], a[48:63]
    buffer_load_dwordx4 v64, s[12:15], s29 offen sc1 lds
    s_add_u32 m0, s31, 33792
    s_nop 0
    buffer_load_dwordx4 v65, s[12:15], s29 offen sc1 lds
    s_add_u32 m0, s31, 34816
    v_mfma_f32_32x32x16_bf16 a[0:15], v[24:27], v[8:11], a[0:15]
    buffer_load_dwordx4 v66, s[12:15], s29 offen sc1 lds
    s_add_u32 m0, s31, 35840
    s_nop 0
    buffer_load_dwordx4 v67, s[12:15], s29 offen sc1 lds
    v_mfma_f32_32x32x16_bf16 a[16:31], v[24:27], v[12:15], a[16:31]
    s_add_u32 s29, s29, 256
    s_add_u32 m0, s31, 49152
    s_nop 0
    buffer_load_dwordx4 v68, s[36:39], s30 offen lds
    s_add_u32 m0, s31, 50176
    v_mfma_f32_32x32x16_bf16 a[32:47], v[28:31], v[8:11], a[32:47]
    buffer_load_dwordx4 v69, s[36:39], s30 offen lds
    s_add_u32 m0, s31, 51200
    s_nop 0
    buffer_load_dwordx4 v70, s[36:39], s30 offen lds
    s_add_u32 m0, s31, 52224
    v_mfma_f32_32x32x16_bf16 a[48:63], v[28:31], v[12:15], a[48:63]
    buffer_load_dwordx4 v71, s[36:39], s30 offen lds
    s_add_u32 s30, s30, 114688
    s_waitcnt lgkmcnt(0)
    s_waitcnt vmcnt(8)
    s_barrier
    v_mfma_f32_32x32x16_bf16 a[0:15], v[48:51], v[32:35], a[0:15]
    ds_read_b128 v[0:3], v72 offset:0
    ds_read_b128 v[4:7], v72 offset:8192
    ds_read_b64_tr_b16 v[16:17], v76 offset:0
    ds_read_b64_tr_b16 v[18:19], v76 offset:512
    v_mfma_f32_32x32x16_bf16 a[16:31], v[48:51], v[36:39], a[16:31]
    ds_read_b64_tr_b16 v[20:21], v77 offset:0
    ds_read_b64_tr_b16 v[22:23], v77 offset:512
    ds_read_b128 v[8:11], v73 offset:0
    ds_read_b128 v[12:15], v73 offset:8192
    v_mfma_f32_32x32x16_bf16 a[32:47], v[52:55], v[32:35], a[32:47]
    ds_read_b64_tr_b16 v[24:25], v76 offset:8192
    ds_read_b64_tr_b16 v[26:27], v76 offset:8704
    ds_read_b64_tr_b16 v[28:29], v77 offset:8192
    ds_read_b64_tr_b16 v[30:31], v77 offset:8704
    s_add_u32 m0, s31, 65536
    v_mfma_f32_32x32x16_bf16 a[48:63], v[52:55], v[36:39], a[48:63]
    buffer_load_dwordx4 v64, s[12:15], s29 offen sc1 lds
    s_add_u32 m0, s31, 66560
    s_nop 0
    buffer_load_dwordx4 v65, s[12:15], s29 offen sc1 lds
    s_add_u32 m0, s31, 67584
    v_mfma_f32_32x32x16_bf16 a[0:15], v[56:59], v[40:43], a[0:15]
    buffer_load_dwordx4 v66, s[12:15], s29 offen sc1 lds
    s_add_u32 m0, s31, 68608
    s_nop 0
    buffer_load_dwordx4 v67, s[12:15], s29 offen sc1 lds
    v_mfma_f32_32x32x16_bf16 a[16:31], v[56:59], v[44:47], a[16:31]
    s_add_u32 s29, s29, 256
    s_add_u32 m0, s31, 81920
    s_nop 0
    buffer_load_dwordx4 v68, s[36:39], s30 offen lds
    s_add_u32 m0, s31, 82944
    v_mfma_f32_32x32x16_bf16 a[32:47], v[60:63], v[40:43], a[32:47]
    buffer_load_dwordx4 v69, s[36:39], s30 offen lds
    s_add_u32 m0, s31, 83968
    s_nop 0
    buffer_load_dwordx4 v70, s[36:39], s30 offen lds
    s_add_u32 m0, s31, 84992
    v_mfma_f32_32x32x16_bf16 a[48:63], v[60:63], v[44:47], a[48:63]
    buffer_load_dwordx4 v71, s[36:39], s30 offen lds
    s_add_u32 s30, s30, 114688
    s_mov_b32 s52, 6
L_fin_loop:
    s_waitcnt lgkmcnt(0)
    s_waitcnt vmcnt(8)
    s_barrier
    v_mfma_f32_32x32x16_bf16 a[0:15], v[16:19], v[0:3], a[0:15]
    ds_read_b128 v[32:35], v72 offset:32768
    ds_read_b128 v[36:39], v72 offset:40960
    ds_read_b64_tr_b16 v[48:49], v76 offset:32768
    ds_read_b64_tr_b16 v[50:51], v76 offset:33280
    v_mfma_f32_32x32x16_bf16 a[16:31], v[16:19], v[4:7], a[16:31]
    ds_read_b64_tr_b16 v[52:53], v77 offset:32768
    ds_read_b64_tr_b16 v[54:55], v77 offset:33280
    ds_read_b128 v[40:43], v73 offset:32768
    ds_read_b128 v[44:47], v73 offset:40960
    v_mfma_f32_32x32x16_bf16 a[32:47], v[20:23], v[0:3], a[32:47]
    ds_read_b64_tr_b16 v[56:57], v76 offset:40960
    ds_read_b64_tr_b16 v[58:59], v76 offset:41472
    ds_read_b64_tr_b16 v[60:61], v77 offset:40960
    ds_read_b64_tr_b16 v[62:63], v77 offset:41472
    s_add_u32 m0, s31, 98304
    v_mfma_f32_32x32x16_bf16 a[48:63], v[20:23], v[4:7], a[48:63]
    buffer_load_dwordx4 v64, s[12:15], s29 offen sc1 lds
    s_add_u32 m0, s31, 99328
    s_nop 0
    buffer_load_dwordx4 v65, s[12:15], s29 offen sc1 lds
    s_add_u32 m0, s31, 100352
    v_mfma_f32_32x32x16_bf16 a[0:15], v[24:27], v[8:11], a[0:15]
    buffer_load_dwordx4 v66, s[12:15], s29 offen sc1 lds
    s_add_u32 m0, s31, 101376
    s_nop 0
    buffer_load_dwordx4 v67, s[12:15], s29 offen sc1 lds
    v_mfma_f32_32x32x16_bf16 a[16:31], v[24:27], v[12:15], a[16:31]
    s_add_u32 s29, s29, 256
    s_add_u32 m0, s31, 114688
    s_nop 0
    buffer_load_dwordx4 v68, s[36:39], s30 offen lds
    s_add_u32 m0, s31, 115712
    v_mfma_f32_32x32x16_bf16 a[32:47], v[28:31], v[8:11], a[32:47]
    buffer_load_dwordx4 v69, s[36:39], s30 offen lds
    s_add_u32 m0, s31, 116736
    s_nop 0
    buffer_load_dwordx4 v70, s[36:39], s30 offen lds
    s_add_u32 m0, s31, 117760
    v_mfma_f32_32x32x16_bf16 a[48:63], v[28:31], v[12:15], a[48:63]
    buffer_load_dwordx4 v71, s[36:39], s30 offen lds
    s_add_u32 s30, s30, 114688
    s_waitcnt lgkmcnt(0)
    s_waitcnt vmcnt(8)
    s_barrier
    v_mfma_f32_32x32x16_bf16 a[0:15], v[48:51], v[32:35], a[0:15]
    ds_read_b128 v[0:3], v74 offset:0
    ds_read_b128 v[4:7], v74 offset:8192
    ds_read_b64_tr_b16 v[16:17], v78 offset:0
    ds_read_b64_tr_b16 v[18:19], v78 offset:512
    v_mfma_f32_32x32x16_bf16 a[16:31], v[48:51], v[36:39], a[16:31]
    ds_read_b64_tr_b16 v[20:21], v79 offset:0
    ds_read_b64_tr_b16 v[22:23], v79 offset:512
    ds_read_b128 v[8:11], v75 offset:0
    ds_read_b128 v[12:15], v75 offset:8192
    v_mfma_f32_32x32x16_bf16 a[32:47], v[52:55], v[32:35], a[32:47]
    ds_read_b64_tr_b16 v[24:25], v78 offset:8192
    ds_read_b64_tr_b16 v[26:27], v78 offset:8704
    ds_read_b64_tr_b16 v[28:29], v79 offset:8192
    ds_read_b64_tr_b16 v[30:31], v79 offset:8704
    s_add_u32 m0, s31, 0
    v_mfma_f32_32x32x16_bf16 a[48:63], v[52:55], v[36:39], a[48:63]
    buffer_load_dwordx4 v64, s[12:15], s29 offen sc1 lds
    s_add_u32 m0, s31, 1024
    s_nop 0
    buffer_load_dwordx4 v65, s[12:15], s29 offen sc1 lds
    s_add_u32 m0, s31, 2048
    v_mfma_f32_32x32x16_bf16 a[0:15], v[56:59], v[40:43], a[0:15]
    buffer_load_dwordx4 v66, s[12:15], s29 offen sc1 lds
    s_add_u32 m0, s31, 3072
    s_nop 0
    buffer_load_dwordx4 v67, s[12:15], s29 offen sc1 lds
    v_mfma_f32_32x32x16_bf16 a[16:31], v[56:59], v[44:47], a[16:31]
    s_add_u32 s29, s29, 256
    s_add_u32 m0, s31, 16384
    s_nop 0
    buffer_load_dwordx4 v68, s[36:39], s30 offen lds
    s_add_u32 m0, s31, 17408
    v_mfma_f32_32x32x16_bf16 a[32:47], v[60:63], v[40:43], a[32:47]
    buffer_load_dwordx4 v69, s[36:39], s30 offen lds
    s_add_u32 m0, s31, 18432
    s_nop 0
    buffer_load_dwordx4 v70, s[36:39], s30 offen lds
    s_add_u32 m0, s31, 19456
    v_mfma_f32_32x32x16_bf16 a[48:63], v[60:63], v[44:47], a[48:63]
    buffer_load_dwordx4 v71, s[36:39], s30 offen lds
    s_add_u32 s30, s30, 114688
    s_waitcnt lgkmcnt(0)
    s_waitcnt vmcnt(8)
    s_barrier
    v_mfma_f32_32x32x16_bf16 a[0:15], v[16:19], v[0:3], a[0:15]
    ds_read_b128 v[32:35], v74 offset:32768
    ds_read_b128 v[36:39], v74 offset:40960
    ds_read_b64_tr_b16 v[48:49], v78 offset:32768
    ds_read_b64_tr_b16 v[50:51], v78 offset:33280
    v_mfma_f32_32x32x16_bf16 a[16:31], v[16:19], v[4:7], a[16:31]
    ds_read_b64_tr_b16 v[52:53], v79 offset:32768
    ds_read_b64_tr_b16 v[54:55], v79 offset:33280
    ds_read_b128 v[40:43], v75 offset:32768
    ds_read_b128 v[44:47], v75 offset:40960
    v_mfma_f32_32x32x16_bf16 a[32:47], v[20:23], v[0:3], a[32:47]
    ds_read_b64_tr_b16 v[56:57], v78 offset:40960
    ds_read_b64_tr_b16 v[58:59], v78 offset:41472
    ds_read_b64_tr_b16 v[60:61], v79 offset:40960
    ds_read_b64_tr_b16 v[62:63], v79 offset:41472
    s_add_u32 m0, s31, 32768
    v_mfma_f32_32x32x16_bf16 a[48:63], v[20:23], v[4:7], a[48:63]
    buffer_load_dwordx4 v64, s[12:15], s29 offen sc1 lds
    s_add_u32 m0, s31, 33792
    s_nop 0
    buffer_load_dwordx4 v65, s[12:15], s29 offen sc1 lds
    s_add_u32 m0, s31, 34816
    v_mfma_f32_32x32x16_bf16 a[0:15], v[24:27], v[8:11], a[0:15]
    buffer_load_dwordx4 v66, s[12:15], s29 offen sc1 lds
    s_add_u32 m0, s31, 35840
    s_nop 0
    buffer_load_dwordx4 v67, s[12:15], s29 offen sc1 lds
    v_mfma_f32_32x32x16_bf16 a[16:31], v[24:27], v[12:15], a[16:31]
    s_add_u32 s29, s29, 256
    s_add_u32 m0, s31, 49152
    s_nop 0
    buffer_load_dwordx4 v68, s[36:39], s30 offen lds
    s_add_u32 m0, s31, 50176
    v_mfma_f32_32x32x16_bf16 a[32:47], v[28:31], v[8:11], a[32:47]
    buffer_load_dwordx4 v69, s[36:39], s30 offen lds
    s_add_u32 m0, s31, 51200
    s_nop 0
    buffer_load_dwordx4 v70, s[36:39], s30 offen lds
    s_add_u32 m0, s31, 52224
    v_mfma_f32_32x32x16_bf16 a[48:63], v[28:31], v[12:15], a[48:63]
    buffer_load_dwordx4 v71, s[36:39], s30 offen lds
    s_add_u32 s30, s30, 114688
    s_waitcnt lgkmcnt(0)
    s_waitcnt vmcnt(8)
    s_barrier
    v_mfma_f32_32x32x16_bf16 a[0:15], v[48:51], v[32:35], a[0:15]
    ds_read_b128 v[0:3], v72 offset:0
    ds_read_b128 v[4:7], v72 offset:8192
    ds_read_b64_tr_b16 v[16:17], v76 offset:0
    ds_read_b64_tr_b16 v[18:19], v76 offset:512
    v_mfma_f32_32x32x16_bf16 a[16:31], v[48:51], v[36:39], a[16:31]
    ds_read_b64_tr_b16 v[20:21], v77 offset:0
    ds_read_b64_tr_b16 v[22:23], v77 offset:512
    ds_read_b128 v[8:11], v73 offset:0
    ds_read_b128 v[12:15], v73 offset:8192
    v_mfma_f32_32x32x16_bf16 a[32:47], v[52:55], v[32:35], a[32:47]
    ds_read_b64_tr_b16 v[24:25], v76 offset:8192
    ds_read_b64_tr_b16 v[26:27], v76 offset:8704
    ds_read_b64_tr_b16 v[28:29], v77 offset:8192
    ds_read_b64_tr_b16 v[30:31], v77 offset:8704
    s_add_u32 m0, s31, 65536
    v_mfma_f32_32x32x16_bf16 a[48:63], v[52:55], v[36:39], a[48:63]
    buffer_load_dwordx4 v64, s[12:15], s29 offen sc1 lds
    s_add_u32 m0, s31, 66560
    s_nop 0
    buffer_load_dwordx4 v65, s[12:15], s29 offen sc1 lds
    s_add_u32 m0, s31, 67584
    v_mfma_f32_32x32x16_bf16 a[0:15], v[56:59], v[40:43], a[0:15]
    buffer_load_dwordx4 v66, s[12:15], s29 offen sc1 lds
    s_add_u32 m0, s31, 68608
    s_nop 0
    buffer_load_dwordx4 v67, s[12:15], s29 offen sc1 lds
    v_mfma_f32_32x32x16_bf16 a[16:31], v[56:59], v[44:47], a[16:31]
    s_add_u32 s29, s29, 256
    s_add_u32 m0, s31, 81920
    s_nop 0
    buffer_load_dwordx4 v68, s[36:39], s30 offen lds
    s_add_u32 m0, s31, 82944
    v_mfma_f32_32x32x16_bf16 a[32:47], v[60:63], v[40:43], a[32:47]
    buffer_load_dwordx4 v69, s[36:39], s30 offen lds
    s_add_u32 m0, s31, 83968
    s_nop 0
    buffer_load_dwordx4 v70, s[36:39], s30 offen lds
    s_add_u32 m0, s31, 84992
    v_mfma_f32_32x32x16_bf16 a[48:63], v[60:63], v[44:47], a[48:63]
    buffer_load_dwordx4 v71, s[36:39], s30 offen lds
    s_add_u32 s30, s30, 114688
    s_sub_u32 s52, s52, 1
    s_cmp_lg_u32 s52, 0
    s_cbranch_scc1 L_fin_loop
    s_waitcnt lgkmcnt(0)
    s_waitcnt vmcnt(8)
    s_barrier
    v_mfma_f32_32x32x16_bf16 a[0:15], v[16:19], v[0:3], a[0:15]
    ds_read_b128 v[32:35], v72 offset:32768
    ds_read_b128 v[36:39], v72 offset:40960
    ds_read_b64_tr_b16 v[48:49], v76 offset:32768
    ds_read_b64_tr_b16 v[50:51], v76 offset:33280
    v_mfma_f32_32x32x16_bf16 a[16:31], v[16:19], v[4:7], a[16:31]
    ds_read_b64_tr_b16 v[52:53], v77 offset:32768
    ds_read_b64_tr_b16 v[54:55], v77 offset:33280
    ds_read_b128 v[40:43], v73 offset:32768
    ds_read_b128 v[44:47], v73 offset:40960
    v_mfma_f32_32x32x16_bf16 a[32:47], v[20:23], v[0:3], a[32:47]
    ds_read_b64_tr_b16 v[56:57], v76 offset:40960
    ds_read_b64_tr_b16 v[58:59], v76 offset:41472
    ds_read_b64_tr_b16 v[60:61], v77 offset:40960
    ds_read_b64_tr_b16 v[62:63], v77 offset:41472
    s_add_u32 m0, s31, 98304
    v_mfma_f32_32x32x16_bf16 a[48:63], v[20:23], v[4:7], a[48:63]
    buffer_load_dwordx4 v64, s[12:15], s29 offen sc1 lds
    s_add_u32 m0, s31, 99328
    s_nop 0
    buffer_load_dwordx4 v65, s[12:15], s29 offen sc1 lds
    s_add_u32 m0, s31, 100352
    v_mfma_f32_32x32x16_bf16 a[0:15], v[24:27], v[8:11], a[0:15]
    buffer_load_dwordx4 v66, s[12:15], s29 offen sc1 lds
    s_add_u32 m0, s31, 101376
    s_nop 0
    buffer_load_dwordx4 v67, s[12:15], s29 offen sc1 lds
    v_mfma_f32_32x32x16_bf16 a[16:31], v[24:27], v[12:15], a[16:31]
    s_add_u32 s29, s29, 256
    s_add_u32 m0, s31, 114688
    s_nop 0
    buffer_load_dwordx4 v68, s[36:39], s30 offen lds
    s_add_u32 m0, s31, 115712
    v_mfma_f32_32x32x16_bf16 a[32:47], v[28:31], v[8:11], a[32:47]
    buffer_load_dwordx4 v69, s[36:39], s30 offen lds
    s_add_u32 m0, s31, 116736
    s_nop 0
    buffer_load_dwordx4 v70, s[36:39], s30 offen lds
    s_add_u32 m0, s31, 117760
    v_mfma_f32_32x32x16_bf16 a[48:63], v[28:31], v[12:15], a[48:63]
    buffer_load_dwordx4 v71, s[36:39], s30 offen lds
    s_add_u32 s30, s30, 114688
    s_waitcnt lgkmcnt(0)
    s_waitcnt vmcnt(8)
    s_barrier
    v_mfma_f32_32x32x16_bf16 a[0:15], v[48:51], v[32:35], a[0:15]
    ds_read_b128 v[0:3], v74 offset:0
    ds_read_b128 v[4:7], v74 offset:8192
    ds_read_b64_tr_b16 v[16:17], v78 offset:0
    ds_read_b64_tr_b16 v[18:19], v78 offset:512
    v_mfma_f32_32x32x16_bf16 a[16:31], v[48:51], v[36:39], a[16:31]
    ds_read_b64_tr_b16 v[20:21], v79 offset:0
    ds_read_b64_tr_b16 v[22:23], v79 offset:512
    ds_read_b128 v[8:11], v75 offset:0
    ds_read_b128 v[12:15], v75 offset:8192
    v_mfma_f32_32x32x16_bf16 a[32:47], v[52:55], v[32:35], a[32:47]
    ds_read_b64_tr_b16 v[24:25], v78 offset:8192
    ds_read_b64_tr_b16 v[26:27], v78 offset:8704
    ds_read_b64_tr_b16 v[28:29], v79 offset:8192
    ds_read_b64_tr_b16 v[30:31], v79 offset:8704
    v_mfma_f32_32x32x16_bf16 a[48:63], v[52:55], v[36:39], a[48:63]
    v_mfma_f32_32x32x16_bf16 a[0:15], v[56:59], v[40:43], a[0:15]
    v_mfma_f32_32x32x16_bf16 a[16:31], v[56:59], v[44:47], a[16:31]
    v_mfma_f32_32x32x16_bf16 a[32:47], v[60:63], v[40:43], a[32:47]
    v_mfma_f32_32x32x16_bf16 a[48:63], v[60:63], v[44:47], a[48:63]
    s_waitcnt lgkmcnt(0)
    s_waitcnt vmcnt(0)
    s_barrier
    v_mfma_f32_32x32x16_bf16 a[0:15], v[16:19], v[0:3], a[0:15]
    ds_read_b128 v[32:35], v74 offset:32768
    ds_read_b128 v[36:39], v74 offset:40960
    ds_read_b64_tr_b16 v[48:49], v78 offset:32768
    ds_read_b64_tr_b16 v[50:51], v78 offset:33280
    v_mfma_f32_32x32x16_bf16 a[16:31], v[16:19], v[4:7], a[16:31]
    ds_read_b64_tr_b16 v[52:53], v79 offset:32768
    ds_read_b64_tr_b16 v[54:55], v79 offset:33280
    ds_read_b128 v[40:43], v75 offset:32768
    ds_read_b128 v[44:47], v75 offset:40960
    v_mfma_f32_32x32x16_bf16 a[32:47], v[20:23], v[0:3], a[32:47]
    ds_read_b64_tr_b16 v[56:57], v78 offset:40960
    ds_read_b64_tr_b16 v[58:59], v78 offset:41472
    ds_read_b64_tr_b16 v[60:61], v79 offset:40960
    ds_read_b64_tr_b16 v[62:63], v79 offset:41472
    v_mfma_f32_32x32x16_bf16 a[48:63], v[20:23], v[4:7], a[48:63]
    v_mfma_f32_32x32x16_bf16 a[0:15], v[24:27], v[8:11], a[0:15]
    v_mfma_f32_32x32x16_bf16 a[16:31], v[24:27], v[12:15], a[16:31]
    v_mfma_f32_32x32x16_bf16 a[32:47], v[28:31], v[8:11], a[32:47]
    v_mfma_f32_32x32x16_bf16 a[48:63], v[28:31], v[12:15], a[48:63]
    s_waitcnt lgkmcnt(0)
    v_mfma_f32_32x32x16_bf16 a[0:15], v[48:51], v[32:35], a[0:15]
    v_mfma_f32_32x32x16_bf16 a[16:31], v[48:51], v[36:39], a[16:31]
    v_mfma_f32_32x32x16_bf16 a[32:47], v[52:55], v[32:35], a[32:47]
    v_mfma_f32_32x32x16_bf16 a[48:63], v[52:55], v[36:39], a[48:63]
    v_mfma_f32_32x32x16_bf16 a[0:15], v[56:59], v[40:43], a[0:15]
    v_mfma_f32_32x32x16_bf16 a[16:31], v[56:59], v[44:47], a[16:31]
    v_mfma_f32_32x32x16_bf16 a[32:47], v[60:63], v[40:43], a[32:47]
    v_mfma_f32_32x32x16_bf16 a[48:63], v[60:63], v[44:47], a[48:63]
    s_barrier
    s_nop 7
    s_lshl_b32 s27, s24, 14
    v_lshlrev_b32 v87, 4, v80
    v_add_u32 v88, s27, v87
    ds_write_b128 v88, a[0:3] offset:0
    ds_write_b128 v88, a[4:7] offset:1024
    ds_write_b128 v88, a[8:11] offset:2048
    ds_write_b128 v88, a[12:15] offset:3072
    ds_write_b128 v88, a[16:19] offset:4096
    ds_write_b128 v88, a[20:23] offset:5120
    ds_write_b128 v88, a[24:27] offset:6144
    ds_write_b128 v88, a[28:31] offset:7168
    ds_write_b128 v88, a[32:35] offset:8192
    ds_write_b128 v88, a[36:39] offset:9216
    ds_write_b128 v88, a[40:43] offset:10240
    ds_write_b128 v88, a[44:47] offset:11264
    ds_write_b128 v88, a[48:51] offset:12288
    ds_write_b128 v88, a[52:55] offset:13312
    ds_write_b128 v88, a[56:59] offset:14336
    ds_write_b128 v88, a[60:63] offset:15360
    s_waitcnt lgkmcnt(0)
    s_barrier
    s_lshl_b32 s27, s24, 12
    v_add_u32 v88, s27, v87
    ds_read_b128 v[0:3], v88 offset:0
    ds_read_b128 v[4:7], v88 offset:1024
    ds_read_b128 v[8:11], v88 offset:2048
    ds_read_b128 v[12:15], v88 offset:3072
    ds_read_b128 v[16:19], v88 offset:16384
    ds_read_b128 v[20:23], v88 offset:17408
    ds_read_b128 v[24:27], v88 offset:18432
    ds_read_b128 v[28:31], v88 offset:19456
    ds_read_b128 v[32:35], v88 offset:32768
    ds_read_b128 v[36:39], v88 offset:33792
    ds_read_b128 v[40:43], v88 offset:34816
    ds_read_b128 v[44:47], v88 offset:35840
    ds_read_b128 v[48:51], v88 offset:49152
    ds_read_b128 v[52:55], v88 offset:50176
    ds_read_b128 v[56:59], v88 offset:51200
    ds_read_b128 v[60:63], v88 offset:52224
    s_waitcnt lgkmcnt(0)
    v_add_f32 v0, v0, v16
    v_add_f32 v32, v32, v48
    v_add_f32 v0, v0, v32
    v_add_f32 v1, v1, v17
    v_add_f32 v33, v33, v49
    v_add_f32 v1, v1, v33
    v_add_f32 v2, v2, v18
    v_add_f32 v34, v34, v50
    v_add_f32 v2, v2, v34
    v_add_f32 v3, v3, v19
    v_add_f32 v35, v35, v51
    v_add_f32 v3, v3, v35
    v_add_f32 v4, v4, v20
    v_add_f32 v36, v36, v52
    v_add_f32 v4, v4, v36
    v_add_f32 v5, v5, v21
    v_add_f32 v37, v37, v53
    v_add_f32 v5, v5, v37
    v_add_f32 v6, v6, v22
    v_add_f32 v38, v38, v54
    v_add_f32 v6, v6, v38
    v_add_f32 v7, v7, v23
    v_add_f32 v39, v39, v55
    v_add_f32 v7, v7, v39
    v_add_f32 v8, v8, v24
    v_add_f32 v40, v40, v56
    v_add_f32 v8, v8, v40
    v_add_f32 v9, v9, v25
    v_add_f32 v41, v41, v57
    v_add_f32 v9, v9, v41
    v_add_f32 v10, v10, v26
    v_add_f32 v42, v42, v58
    v_add_f32 v10, v10, v42
    v_add_f32 v11, v11, v27
    v_add_f32 v43, v43, v59
    v_add_f32 v11, v11, v43
    v_add_f32 v12, v12, v28
    v_add_f32 v44, v44, v60
    v_add_f32 v12, v12, v44
    v_add_f32 v13, v13, v29
    v_add_f32 v45, v45, v61
    v_add_f32 v13, v13, v45
    v_add_f32 v14, v14, v30
    v_add_f32 v46, v46, v62
    v_add_f32 v14, v14, v46
    v_add_f32 v15, v15, v31
    v_add_f32 v47, v47, v63
    v_add_f32 v15, v15, v47
    v_lshlrev_b32 v122, 16, v96
    v_lshlrev_b32 v123, 16, v97
    v_lshlrev_b32 v124, 16, v98
    v_lshlrev_b32 v125, 16, v99
    v_lshlrev_b32 v126, 16, v100
    v_lshlrev_b32 v127, 16, v101
    v_lshlrev_b32 v128, 16, v102
    v_lshlrev_b32 v129, 16, v103
    v_and_b32 v130, 0xffff0000, v96
    v_and_b32 v131, 0xffff0000, v97
    v_and_b32 v132, 0xffff0000, v98
    v_and_b32 v133, 0xffff0000, v99
    v_and_b32 v134, 0xffff0000, v100
    v_and_b32 v135, 0xffff0000, v101
    v_and_b32 v136, 0xffff0000, v102
    v_and_b32 v137, 0xffff0000, v103
    v_lshlrev_b32 v146, 16, v104
    v_lshlrev_b32 v147, 16, v106
    v_lshlrev_b32 v148, 16, v108
    v_lshlrev_b32 v149, 16, v110
    v_lshlrev_b32 v150, 16, v112
    v_lshlrev_b32 v151, 16, v114
    v_lshlrev_b32 v152, 16, v116
    v_lshlrev_b32 v153, 16, v118
    v_lshlrev_b32 v154, 16, v105
    v_lshlrev_b32 v155, 16, v107
    v_lshlrev_b32 v156, 16, v109
    v_lshlrev_b32 v157, 16, v111
    v_lshlrev_b32 v158, 16, v113
    v_lshlrev_b32 v159, 16, v115
    v_lshlrev_b32 v160, 16, v117
    v_lshlrev_b32 v161, 16, v119
    v_mul_f32 v122, v122, v146
    v_mul_f32 v123, v123, v147
    v_mul_f32 v124, v124, v148
    v_mul_f32 v125, v125, v149
    v_mul_f32 v126, v126, v150
    v_mul_f32 v127, v127, v151
    v_mul_f32 v128, v128, v152
    v_mul_f32 v129, v129, v153
    v_mul_f32 v130, v130, v154
    v_mul_f32 v131, v131, v155
    v_mul_f32 v132, v132, v156
    v_mul_f32 v133, v133, v157
    v_mul_f32 v134, v134, v158
    v_mul_f32 v135, v135, v159
    v_mul_f32 v136, v136, v160
    v_mul_f32 v137, v137, v161
    v_cvt_pk_bf16_f32 v138, v122, v130
    v_cvt_pk_bf16_f32 v139, v123, v131
    v_cvt_pk_bf16_f32 v140, v124, v132
    v_cvt_pk_bf16_f32 v141, v125, v133
    v_cvt_pk_bf16_f32 v142, v126, v134
    v_cvt_pk_bf16_f32 v143, v127, v135
    v_cvt_pk_bf16_f32 v144, v128, v136
    v_cvt_pk_bf16_f32 v145, v129, v137
    v_lshlrev_b32 v122, 16, v138
    v_lshlrev_b32 v123, 16, v139
    v_lshlrev_b32 v124, 16, v140
    v_lshlrev_b32 v125, 16, v141
    v_lshlrev_b32 v126, 16, v142
    v_lshlrev_b32 v127, 16, v143
    v_lshlrev_b32 v128, 16, v144
    v_lshlrev_b32 v129, 16, v145
    v_and_b32 v130, 0xffff0000, v138
    v_and_b32 v131, 0xffff0000, v139
    v_and_b32 v132, 0xffff0000, v140
    v_and_b32 v133, 0xffff0000, v141
    v_and_b32 v134, 0xffff0000, v142
    v_and_b32 v135, 0xffff0000, v143
    v_and_b32 v136, 0xffff0000, v144
    v_and_b32 v137, 0xffff0000, v145
    v_mul_f32 v122, v122, v120
    v_mul_f32 v123, v123, v120
    v_mul_f32 v124, v124, v120
    v_mul_f32 v125, v125, v120
    v_mul_f32 v126, v126, v120
    v_mul_f32 v127, v127, v120
    v_mul_f32 v128, v128, v120
    v_mul_f32 v129, v129, v120
    v_mul_f32 v130, v130, v120
    v_mul_f32 v131, v131, v120
    v_mul_f32 v132, v132, v120
    v_mul_f32 v133, v133, v120
    v_mul_f32 v134, v134, v120
    v_mul_f32 v135, v135, v120
    v_mul_f32 v136, v136, v120
    v_mul_f32 v137, v137, v120
    v_cvt_pk_bf16_f32 v138, v122, v130
    v_cvt_pk_bf16_f32 v139, v123, v131
    v_cvt_pk_bf16_f32 v140, v124, v132
    v_cvt_pk_bf16_f32 v141, v125, v133
    v_cvt_pk_bf16_f32 v142, v126, v134
    v_cvt_pk_bf16_f32 v143, v127, v135
    v_cvt_pk_bf16_f32 v144, v128, v136
    v_cvt_pk_bf16_f32 v145, v129, v137
    v_lshlrev_b32 v146, 16, v138
    v_lshlrev_b32 v147, 16, v139
    v_lshlrev_b32 v148, 16, v140
    v_lshlrev_b32 v149, 16, v141
    v_lshlrev_b32 v150, 16, v142
    v_lshlrev_b32 v151, 16, v143
    v_lshlrev_b32 v152, 16, v144
    v_lshlrev_b32 v153, 16, v145
    v_and_b32 v154, 0xffff0000, v138
    v_and_b32 v155, 0xffff0000, v139
    v_and_b32 v156, 0xffff0000, v140
    v_and_b32 v157, 0xffff0000, v141
    v_and_b32 v158, 0xffff0000, v142
    v_and_b32 v159, 0xffff0000, v143
    v_and_b32 v160, 0xffff0000, v144
    v_and_b32 v161, 0xffff0000, v145
    v_cvt_pk_bf16_f32 v138, v0, v1
    v_cvt_pk_bf16_f32 v139, v2, v3
    v_cvt_pk_bf16_f32 v140, v4, v5
    v_cvt_pk_bf16_f32 v141, v6, v7
    v_cvt_pk_bf16_f32 v142, v8, v9
    v_cvt_pk_bf16_f32 v143, v10, v11
    v_cvt_pk_bf16_f32 v144, v12, v13
    v_cvt_pk_bf16_f32 v145, v14, v15
    v_lshlrev_b32 v122, 16, v138
    v_lshlrev_b32 v123, 16, v139
    v_lshlrev_b32 v124, 16, v140
    v_lshlrev_b32 v125, 16, v141
    v_lshlrev_b32 v126, 16, v142
    v_lshlrev_b32 v127, 16, v143
    v_lshlrev_b32 v128, 16, v144
    v_lshlrev_b32 v129, 16, v145
    v_and_b32 v130, 0xffff0000, v138
    v_and_b32 v131, 0xffff0000, v139
    v_and_b32 v132, 0xffff0000, v140
    v_and_b32 v133, 0xffff0000, v141
    v_and_b32 v134, 0xffff0000, v142
    v_and_b32 v135, 0xffff0000, v143
    v_and_b32 v136, 0xffff0000, v144
    v_and_b32 v137, 0xffff0000, v145
    v_mul_f32 v122, v122, v121
    v_mul_f32 v123, v123, v121
    v_mul_f32 v124, v124, v121
    v_mul_f32 v125, v125, v121
    v_mul_f32 v126, v126, v121
    v_mul_f32 v127, v127, v121
    v_mul_f32 v128, v128, v121
    v_mul_f32 v129, v129, v121
    v_mul_f32 v130, v130, v121
    v_mul_f32 v131, v131, v121
    v_mul_f32 v132, v132, v121
    v_mul_f32 v133, v133, v121
    v_mul_f32 v134, v134, v121
    v_mul_f32 v135, v135, v121
    v_mul_f32 v136, v136, v121
    v_mul_f32 v137, v137, v121
    v_cvt_pk_bf16_f32 v138, v122, v130
    v_cvt_pk_bf16_f32 v139, v123, v131
    v_cvt_pk_bf16_f32 v140, v124, v132
    v_cvt_pk_bf16_f32 v141, v125, v133
    v_cvt_pk_bf16_f32 v142, v126, v134
    v_cvt_pk_bf16_f32 v143, v127, v135
    v_cvt_pk_bf16_f32 v144, v128, v136
    v_cvt_pk_bf16_f32 v145, v129, v137
    v_lshlrev_b32 v122, 16, v138
    v_lshlrev_b32 v123, 16, v139
    v_lshlrev_b32 v124, 16, v140
    v_lshlrev_b32 v125, 16, v141
    v_lshlrev_b32 v126, 16, v142
    v_lshlrev_b32 v127, 16, v143
    v_lshlrev_b32 v128, 16, v144
    v_lshlrev_b32 v129, 16, v145
    v_and_b32 v130, 0xffff0000, v138
    v_and_b32 v131, 0xffff0000, v139
    v_and_b32 v132, 0xffff0000, v140
    v_and_b32 v133, 0xffff0000, v141
    v_and_b32 v134, 0xffff0000, v142
    v_and_b32 v135, 0xffff0000, v143
    v_and_b32 v136, 0xffff0000, v144
    v_and_b32 v137, 0xffff0000, v145
    v_add_f32 v122, v122, v146
    v_add_f32 v123, v123, v147
    v_add_f32 v124, v124, v148
    v_add_f32 v125, v125, v149
    v_add_f32 v126, v126, v150
    v_add_f32 v127, v127, v151
    v_add_f32 v128, v128, v152
    v_add_f32 v129, v129, v153
    v_add_f32 v130, v130, v154
    v_add_f32 v131, v131, v155
    v_add_f32 v132, v132, v156
    v_add_f32 v133, v133, v157
    v_add_f32 v134, v134, v158
    v_add_f32 v135, v135, v159
    v_add_f32 v136, v136, v160
    v_add_f32 v137, v137, v161
    v_cvt_pk_bf16_f32 v138, v122, v130
    v_cvt_pk_bf16_f32 v139, v123, v131
    v_cvt_pk_bf16_f32 v140, v124, v132
    v_cvt_pk_bf16_f32 v141, v125, v133
    v_cvt_pk_bf16_f32 v142, v126, v134
    v_cvt_pk_bf16_f32 v143, v127, v135
    v_cvt_pk_bf16_f32 v144, v128, v136
    v_cvt_pk_bf16_f32 v145, v129, v137
    buffer_store_dwordx2 v[138:139], v85, s[20:23], s54 offen offset:0
    buffer_store_dwordx2 v[140:141], v85, s[20:23], s54 offen offset:16
    buffer_store_dwordx2 v[142:143], v85, s[20:23], s54 offen offset:32
    buffer_store_dwordx2 v[144:145], v85, s[20:23], s54 offen offset:48
L_fin_end:
    s_endpgm
L_end_attn:
.section .rodata,"a"
.p2align 6
.amdhsa_kernel proj_kernel
  .amdhsa_next_free_vgpr 512
  .amdhsa_next_free_sgpr 102
  .amdhsa_accum_offset 256
  .amdhsa_group_segment_fixed_size 0
  .amdhsa_kernarg_size 128
  .amdhsa_user_sgpr_count 2
  .amdhsa_user_sgpr_kernarg_segment_ptr 1
  .amdhsa_system_sgpr_workgroup_id_x 1
.end_amdhsa_kernel
.section .rodata,"a"
.p2align 6
.amdhsa_kernel attn_kernel
  .amdhsa_next_free_vgpr 512
  .amdhsa_next_free_sgpr 102
  .amdhsa_accum_offset 256
  .amdhsa_group_segment_fixed_size 0
  .amdhsa_kernarg_size 128
  .amdhsa_user_sgpr_count 2
  .amdhsa_user_sgpr_kernarg_segment_ptr 1
  .amdhsa_system_sgpr_workgroup_id_x 1
.end_amdhsa_kernel
```
